```python
import torch

def _softmax(x, axis=-1):
    return torch.softmax(x, dim=axis)
def _gelu(x):
    return torch.nn.functional.gelu(x, approximate="tanh")
def _silu(x):
    return torch.nn.functional.silu(x)
def _sigmoid(x):
    return torch.sigmoid(x)
def _layernorm(x, axis=-1, eps=1e-5):
    m = x.mean(dim=axis, keepdim=True)
    v = x.var(dim=axis, keepdim=True, unbiased=False)
    return (x - m) / torch.sqrt(v + eps)
def _scatter_add(tgt, idx, src, axis=0):
    return tgt.clone().index_add_(axis, idx, src)
def _segment_sum(src, seg, n):
    out = torch.zeros((n,) + src.shape[1:], dtype=src.dtype)
    return out.index_add_(0, seg, src)
def _pad(x, pw):
    flat = tuple(v for pair in reversed(pw) for v in pair)
    return torch.nn.functional.pad(x, flat)

kernel_name = 'interleave_layers__spectral_fnet__glu_gated_glu__prompt'

def setup_inputs():

    _w = (lambda a: (lambda t: t.to(torch.bfloat16) if t.is_floating_point() else t)(torch.as_tensor(a)))
    def _A_setup():
        B, S, D = 1, 2048, 512
        ns = torch.arange(S)[:, None] * torch.arange(S)[None, :]
        nd = torch.arange(D)[:, None] * torch.arange(D)[None, :]
        Ws_re = torch.cos(-2.0 * torch.pi * ns / S).to(float)
        Ws_im = torch.sin(-2.0 * torch.pi * ns / S).to(float)
        Wd_re = torch.cos(-2.0 * torch.pi * nd / D).to(float)
        Wd_im = torch.sin(-2.0 * torch.pi * nd / D).to(float)
        return {
            "x": _w((lambda *s: torch.randn(*s, dtype=torch.bfloat16) * 0.05)(B, S, D)),
            "dft_seq_re": _w(Ws_re),
            "dft_seq_im": _w(Ws_im),
            "dft_hid_re": _w(Wd_re),
            "dft_hid_im": _w(Wd_im),
        }
    _A_in = _A_setup()

    def _B_setup():
        B, S, D, F = 1, 2048, 512, 1792
        return {
            "x": _w((lambda *s: torch.randn(*s, dtype=torch.bfloat16) * 0.05)(B, S, D)),
            "w_gate": _w((lambda *s: torch.randn(*s, dtype=torch.bfloat16) * 1.6)(D, F)),
            "w_up": _w((lambda *s: torch.randn(*s, dtype=torch.bfloat16) * 0.8)(D, F)),
            "w_down": _w((lambda *s: torch.randn(*s, dtype=torch.bfloat16) * 0.8)(F, D)),
        }
    _B_in = _B_setup()

    return {
        "A_x": _A_in["x"],
        "A_dft_seq_re": _A_in["dft_seq_re"],
        "A_dft_seq_im": _A_in["dft_seq_im"],
        "A_dft_hid_re": _A_in["dft_hid_re"],
        "A_dft_hid_im": _A_in["dft_hid_im"],
        "B_x": _B_in["x"],
        "B_w_gate": _B_in["w_gate"],
        "B_w_up": _B_in["w_up"],
        "B_w_down": _B_in["w_down"],
    }

def reference(A_x, A_dft_seq_re, A_dft_seq_im, A_dft_hid_re, A_dft_hid_im, B_x, B_w_gate, B_w_up, B_w_down):
    def _A_ref(x, dft_seq_re, dft_seq_im, dft_hid_re, dft_hid_im):
        a = torch.einsum("bsd,ed->bse", x, dft_hid_re)
        b = torch.einsum("bsd,ed->bse", x, dft_hid_im)
        y = torch.einsum("ts,bse->bte", dft_seq_re, a) - torch.einsum("ts,bse->bte", dft_seq_im, b)
        return y

    def _B_ref(x, w_gate, w_up, w_down):
        g = torch.einsum("bsd,df->bsf", x, w_gate)
        u = torch.einsum("bsd,df->bsf", x, w_up)
        h = _sigmoid(g) * u
        return torch.einsum("bsf,fd->bsd", h, w_down)

    x = A_x
    x = x + _A_ref(_layernorm(x, axis=-1), A_dft_seq_re, A_dft_seq_im, A_dft_hid_re, A_dft_hid_im)
    x = x + _B_ref(_layernorm(x, axis=-1), B_w_gate, B_w_up, B_w_down)
    x = x + _A_ref(_layernorm(x, axis=-1), A_dft_seq_re, A_dft_seq_im, A_dft_hid_re, A_dft_hid_im)
    x = x + _B_ref(_layernorm(x, axis=-1), B_w_gate, B_w_up, B_w_down)
    return x
```

```asm
; @launch grid=(256,1,1) block=(256,1,1) lds=163840
.amdgcn_target "amdgcn-amd-amdhsa--gfx950"
.text
.globl interleave_layers__spectral_fnet__glu_gated_glu__prompt_kernel
.p2align 8
.type interleave_layers__spectral_fnet__glu_gated_glu__prompt_kernel,@function
interleave_layers__spectral_fnet__glu_gated_glu__prompt_kernel:
  s_load_dwordx2 s[4:5], s[0:1], 0
  s_load_dwordx2 s[20:21], s[0:1], 88
  s_load_dwordx2 s[8:9], s[0:1], 48
  s_load_dwordx2 s[12:13], s[0:1], 56
  s_load_dwordx2 s[16:17], s[0:1], 64
  s_load_dwordx2 s[24:25], s[0:1], 72
  s_cmp_ge_u32 s2, 256
  s_cbranch_scc1 L_end
  s_getpc_b64 s[60:61]
L_pc:
  s_sub_u32 s60, s60, L_pc-interleave_layers__spectral_fnet__glu_gated_glu__prompt_kernel
  s_subb_u32 s61, s61, 0
  s_lshr_b32 s54, s2, 3
  s_and_b32 s54, s54, 7
  s_lshl_b32 s54, s54, 13
  v_and_b32 v12, 63, v0
  v_lshlrev_b32 v12, 7, v12
  v_add_u32 v12, s54, v12
  v_min_u32 v12, L_codeend-interleave_layers__spectral_fnet__glu_gated_glu__prompt_kernel, v12
  v_readfirstlane_b32 s55, v0
  s_nop 0
  s_cmp_ge_u32 s55, 64
  s_cbranch_scc1 L_nopf
  global_load_dword v255, v12, s[60:61]
L_nopf:
  v_and_b32 v1, 63, v0
  v_lshrrev_b32 v13, 6, v0
  v_lshlrev_b32 v2, 4, v1
  v_readfirstlane_b32 s30, v13
  s_mov_b32 s6, 2097152
  s_mov_b32 s7, 0x20000
  s_mov_b32 s10, 1835008
  s_mov_b32 s11, 0x20000
  s_mov_b32 s14, 1835008
  s_mov_b32 s15, 0x20000
  s_mov_b32 s18, 1835008
  s_mov_b32 s19, 0x20000
  s_mov_b32 s22, 18874368
  s_mov_b32 s23, 0x20000
  s_mov_b32 s26, 2097152
  s_mov_b32 s27, 0x20000
  s_and_b32 s28, s2, 7
  s_lshl_b32 s28, s28, 1
  s_bfe_u32 s54, s2, 0x10003
  s_add_u32 s28, s28, s54
  s_lshr_b32 s29, s2, 4
  s_mov_b32 s36, s28
  s_sub_u32 s37, 32, s28
  s_cmp_eq_u32 s28, 0
  s_cselect_b32 s37, 16, s37
  s_bitcmp1_b32 s29, 3
  s_cselect_b32 s38, s37, s36
  s_and_b32 s54, s29, 4
  s_lshl_b32 s54, s54, 3
  s_add_u32 s34, s38, s54
  s_and_b32 s35, s29, 3
  s_and_b32 s39, s29, 7
  s_and_b32 s49, s29, 7
  s_sub_u32 s54, 32, s38
  s_and_b32 s54, s54, 31
  s_sub_u32 s55, 15, s39
  s_and_b32 s56, s30, 1
  s_cmp_eq_u32 s38, 0
  s_cselect_b32 s57, 64, 63
  s_sub_u32 s57, s57, s56
  s_cmp_ge_u32 s30, 2
  s_cselect_b32 s40, s54, s38
  s_cselect_b32 s41, s55, s39
  s_cselect_b32 s42, s57, s56
  s_lshl_b32 s56, s56, 5
  s_add_u32 s40, s40, s56
  s_mov_b32 s33, 0
  s_mov_b32 s32, 0
  s_mov_b32 s43, 1048576
  s_mov_b32 s44, 5242880
  s_mov_b32 s45, 11534336
  s_mov_b32 s46, 65536
  s_getreg_b32 s48, hwreg(HW_REG_XCC_ID, 0, 4)
  s_mov_b32 s74, 9437184
  v_bfe_u32 v12, v1, 4, 1
  v_lshlrev_b32 v12, 20, v12
  v_lshrrev_b32 v13, 5, v1
  v_lshl_add_u32 v12, v13, 8, v12
  v_and_b32 v13, 15, v1
  v_lshl_add_u32 v12, v13, 4, v12
  s_and_b32 s54, s30, 1
  s_lshl_b32 s55, s54, 7
  v_xor_b32 v12, s55, v12
  s_lshl_b32 s54, s54, 19
  s_lshl_b32 s55, s34, 10
  s_add_u32 s54, s54, s55
  s_lshr_b32 s55, s30, 1
  s_lshl_b32 s55, s55, 9
  s_add_u32 s54, s54, s55
  s_lshl_b32 s55, s30, 13
  v_and_b32 v14, 31, v1
  v_lshlrev_b32 v14, 16, v14
  v_lshrrev_b32 v15, 5, v1
  v_lshl_add_u32 v14, v15, 4, v14
  s_lshl_b32 s56, s40, 10
  s_lshl_b32 s57, s41, 6
  s_add_u32 s56, s56, s57
  s_waitcnt lgkmcnt(0)
  s_load_dword s31, s[20:21], 0
  buffer_load_dwordx4 v[200:203], v14, s[4:7], s56 offen
  buffer_load_dwordx4 v[204:207], v14, s[4:7], s56 offen offset:32
  s_mov_b32 m0, s55
  v_xor_b32 v13, 0, v12
  buffer_load_dwordx4 v13, s[4:7], s54 offen lds
  s_add_u32 s54, s54, 65536
  s_add_u32 s55, s55, 1024
  s_mov_b32 m0, s55
  v_xor_b32 v13, 16, v12
  buffer_load_dwordx4 v13, s[4:7], s54 offen lds
  s_add_u32 s54, s54, 65536
  s_add_u32 s55, s55, 1024
  s_mov_b32 m0, s55
  v_xor_b32 v13, 32, v12
  buffer_load_dwordx4 v13, s[4:7], s54 offen lds
  s_add_u32 s54, s54, 65536
  s_add_u32 s55, s55, 1024
  s_mov_b32 m0, s55
  v_xor_b32 v13, 48, v12
  buffer_load_dwordx4 v13, s[4:7], s54 offen lds
  s_add_u32 s54, s54, 65536
  s_add_u32 s55, s55, 1024
  s_mov_b32 m0, s55
  v_xor_b32 v13, 64, v12
  buffer_load_dwordx4 v13, s[4:7], s54 offen lds
  s_add_u32 s54, s54, 65536
  s_add_u32 s55, s55, 1024
  s_mov_b32 m0, s55
  v_xor_b32 v13, 80, v12
  buffer_load_dwordx4 v13, s[4:7], s54 offen lds
  s_add_u32 s54, s54, 65536
  s_add_u32 s55, s55, 1024
  s_mov_b32 m0, s55
  v_xor_b32 v13, 96, v12
  buffer_load_dwordx4 v13, s[4:7], s54 offen lds
  s_add_u32 s54, s54, 65536
  s_add_u32 s55, s55, 1024
  s_mov_b32 m0, s55
  v_xor_b32 v13, 112, v12
  buffer_load_dwordx4 v13, s[4:7], s54 offen lds
  v_lshrrev_b32 v12, 4, v1
  v_and_b32 v13, 15, v1
  v_lshlrev_b32 v14, 2, v12
  v_xor_b32 v13, v13, v14
  v_mul_u32_u24 v12, 3584, v12
  v_lshl_add_u32 v12, v13, 4, v12
  s_lshl_b32 s54, s29, 8
  v_add_u32 v253, s54, v12
  s_and_b32 s85, s28, 1
  s_mul_i32 s85, s85, 0
  s_xor_b32 s85, s85, s2
  s_and_b32 s85, s85, 3
  s_lshl_b32 s85, s85, 3
  s_lshl_b32 s86, s85, 10
  v_and_b32 v12, 15, v1
  s_lshl_b32 s54, s35, 6
  s_lshl_b32 s55, s30, 4
  s_add_u32 s54, s54, s55
  v_add_u32 v12, s54, v12
  v_mov_b32 v13, 256
  v_cmp_eq_u32 vcc, 0, v12
  s_nop 1
  v_cndmask_b32 v12, v12, v13, vcc
  v_and_b32 v13, 1, v12
  v_lshlrev_b32 v13, 31, v13
  v_or_b32 v184, 1.0, v13
  v_cvt_f32_u32 v12, v12
  v_mul_f32 v12, 0x3b000000, v12
  v_lshrrev_b32 v13, 4, v1
  s_lshl_b32 s54, s30, 3
  v_add_u32 v13, s54, v13
  v_cvt_f32_u32 v13, v13
  v_mul_f32 v13, 0x41000000, v13
  v_mul_f32 v13, v13, v12
  v_mul_f32 v14, 0x42000000, v12
  v_mul_f32 v15, 0x43000000, v12
  v_cos_f32 v136, v13
  v_sin_f32 v137, v13
  v_cos_f32 v188, v14
  v_sin_f32 v189, v14
  v_cos_f32 v186, v12
  v_sin_f32 v187, v12
  v_cos_f32 v190, v15
  v_sin_f32 v191, v15
  v_pk_mul_f32 v[196:197], v[136:137], v[188:189] op_sel:[0,0] op_sel_hi:[1,0]
  v_pk_fma_f32 v[144:145], v[136:137], v[188:189], v[196:197] op_sel:[1,1,0] op_sel_hi:[0,1,1] neg_lo:[1,0,0]
  v_add_f32 v192, v188, v188
  v_add_f32 v198, v186, v186
  v_pk_fma_f32 v[152:153], v[144:145], v[192:193], v[136:137] op_sel_hi:[1,0,1] neg_lo:[0,0,1] neg_hi:[0,0,1]
  v_pk_fma_f32 v[160:161], v[152:153], v[192:193], v[144:145] op_sel_hi:[1,0,1] neg_lo:[0,0,1] neg_hi:[0,0,1]
  v_pk_mul_f32 v[142:143], v[136:137], v[186:187] op_sel:[0,0] op_sel_hi:[1,0]
  v_pk_mul_f32 v[150:151], v[144:145], v[186:187] op_sel:[0,0] op_sel_hi:[1,0]
  v_pk_mul_f32 v[158:159], v[152:153], v[186:187] op_sel:[0,0] op_sel_hi:[1,0]
  v_pk_mul_f32 v[166:167], v[160:161], v[186:187] op_sel:[0,0] op_sel_hi:[1,0]
  v_pk_fma_f32 v[138:139], v[136:137], v[186:187], v[142:143] op_sel:[1,1,0] op_sel_hi:[0,1,1] neg_lo:[1,0,0]
  v_pk_fma_f32 v[146:147], v[144:145], v[186:187], v[150:151] op_sel:[1,1,0] op_sel_hi:[0,1,1] neg_lo:[1,0,0]
  v_pk_fma_f32 v[154:155], v[152:153], v[186:187], v[158:159] op_sel:[1,1,0] op_sel_hi:[0,1,1] neg_lo:[1,0,0]
  v_pk_fma_f32 v[162:163], v[160:161], v[186:187], v[166:167] op_sel:[1,1,0] op_sel_hi:[0,1,1] neg_lo:[1,0,0]
  v_cvt_pk_bf16_f32 v16, v136, v138
  v_cvt_pk_bf16_f32 v20, v137, v139
  v_cvt_pk_bf16_f32 v24, v144, v146
  v_cvt_pk_bf16_f32 v28, v145, v147
  v_cvt_pk_bf16_f32 v32, v152, v154
  v_cvt_pk_bf16_f32 v36, v153, v155
  v_cvt_pk_bf16_f32 v40, v160, v162
  v_cvt_pk_bf16_f32 v44, v161, v163
  v_pk_fma_f32 v[140:141], v[138:139], v[198:199], v[136:137] op_sel_hi:[1,0,1] neg_lo:[0,0,1] neg_hi:[0,0,1]
  v_pk_fma_f32 v[148:149], v[146:147], v[198:199], v[144:145] op_sel_hi:[1,0,1] neg_lo:[0,0,1] neg_hi:[0,0,1]
  v_pk_fma_f32 v[156:157], v[154:155], v[198:199], v[152:153] op_sel_hi:[1,0,1] neg_lo:[0,0,1] neg_hi:[0,0,1]
  v_pk_fma_f32 v[164:165], v[162:163], v[198:199], v[160:161] op_sel_hi:[1,0,1] neg_lo:[0,0,1] neg_hi:[0,0,1]
  v_pk_fma_f32 v[138:139], v[140:141], v[198:199], v[138:139] op_sel_hi:[1,0,1] neg_lo:[0,0,1] neg_hi:[0,0,1]
  v_pk_fma_f32 v[146:147], v[148:149], v[198:199], v[146:147] op_sel_hi:[1,0,1] neg_lo:[0,0,1] neg_hi:[0,0,1]
  v_pk_fma_f32 v[154:155], v[156:157], v[198:199], v[154:155] op_sel_hi:[1,0,1] neg_lo:[0,0,1] neg_hi:[0,0,1]
  v_pk_fma_f32 v[162:163], v[164:165], v[198:199], v[162:163] op_sel_hi:[1,0,1] neg_lo:[0,0,1] neg_hi:[0,0,1]
  v_cvt_pk_bf16_f32 v17, v140, v138
  v_cvt_pk_bf16_f32 v21, v141, v139
  v_cvt_pk_bf16_f32 v25, v148, v146
  v_cvt_pk_bf16_f32 v29, v149, v147
  v_cvt_pk_bf16_f32 v33, v156, v154
  v_cvt_pk_bf16_f32 v37, v157, v155
  v_cvt_pk_bf16_f32 v41, v164, v162
  v_cvt_pk_bf16_f32 v45, v165, v163
  v_pk_fma_f32 v[142:143], v[138:139], v[198:199], v[140:141] op_sel_hi:[1,0,1] neg_lo:[0,0,1] neg_hi:[0,0,1]
  v_pk_fma_f32 v[150:151], v[146:147], v[198:199], v[148:149] op_sel_hi:[1,0,1] neg_lo:[0,0,1] neg_hi:[0,0,1]
  v_pk_fma_f32 v[158:159], v[154:155], v[198:199], v[156:157] op_sel_hi:[1,0,1] neg_lo:[0,0,1] neg_hi:[0,0,1]
  v_pk_fma_f32 v[166:167], v[162:163], v[198:199], v[164:165] op_sel_hi:[1,0,1] neg_lo:[0,0,1] neg_hi:[0,0,1]
  v_pk_fma_f32 v[138:139], v[142:143], v[198:199], v[138:139] op_sel_hi:[1,0,1] neg_lo:[0,0,1] neg_hi:[0,0,1]
  v_pk_fma_f32 v[146:147], v[150:151], v[198:199], v[146:147] op_sel_hi:[1,0,1] neg_lo:[0,0,1] neg_hi:[0,0,1]
  v_pk_fma_f32 v[154:155], v[158:159], v[198:199], v[154:155] op_sel_hi:[1,0,1] neg_lo:[0,0,1] neg_hi:[0,0,1]
  v_pk_fma_f32 v[162:163], v[166:167], v[198:199], v[162:163] op_sel_hi:[1,0,1] neg_lo:[0,0,1] neg_hi:[0,0,1]
  v_cvt_pk_bf16_f32 v18, v142, v138
  v_cvt_pk_bf16_f32 v22, v143, v139
  v_cvt_pk_bf16_f32 v26, v150, v146
  v_cvt_pk_bf16_f32 v30, v151, v147
  v_cvt_pk_bf16_f32 v34, v158, v154
  v_cvt_pk_bf16_f32 v38, v159, v155
  v_cvt_pk_bf16_f32 v42, v166, v162
  v_cvt_pk_bf16_f32 v46, v167, v163
  v_pk_fma_f32 v[140:141], v[138:139], v[198:199], v[142:143] op_sel_hi:[1,0,1] neg_lo:[0,0,1] neg_hi:[0,0,1]
  v_pk_fma_f32 v[148:149], v[146:147], v[198:199], v[150:151] op_sel_hi:[1,0,1] neg_lo:[0,0,1] neg_hi:[0,0,1]
  v_pk_fma_f32 v[156:157], v[154:155], v[198:199], v[158:159] op_sel_hi:[1,0,1] neg_lo:[0,0,1] neg_hi:[0,0,1]
  v_pk_fma_f32 v[164:165], v[162:163], v[198:199], v[166:167] op_sel_hi:[1,0,1] neg_lo:[0,0,1] neg_hi:[0,0,1]
  v_pk_fma_f32 v[138:139], v[140:141], v[198:199], v[138:139] op_sel_hi:[1,0,1] neg_lo:[0,0,1] neg_hi:[0,0,1]
  v_pk_fma_f32 v[146:147], v[148:149], v[198:199], v[146:147] op_sel_hi:[1,0,1] neg_lo:[0,0,1] neg_hi:[0,0,1]
  v_pk_fma_f32 v[154:155], v[156:157], v[198:199], v[154:155] op_sel_hi:[1,0,1] neg_lo:[0,0,1] neg_hi:[0,0,1]
  v_pk_fma_f32 v[162:163], v[164:165], v[198:199], v[162:163] op_sel_hi:[1,0,1] neg_lo:[0,0,1] neg_hi:[0,0,1]
  v_cvt_pk_bf16_f32 v19, v140, v138
  v_cvt_pk_bf16_f32 v23, v141, v139
  v_cvt_pk_bf16_f32 v27, v148, v146
  v_cvt_pk_bf16_f32 v31, v149, v147
  v_cvt_pk_bf16_f32 v35, v156, v154
  v_cvt_pk_bf16_f32 v39, v157, v155
  v_cvt_pk_bf16_f32 v43, v164, v162
  v_cvt_pk_bf16_f32 v47, v165, v163
  v_pk_mul_f32 v[142:143], v[136:137], v[190:191] op_sel:[0,0] op_sel_hi:[1,0]
  v_pk_mul_f32 v[150:151], v[144:145], v[190:191] op_sel:[0,0] op_sel_hi:[1,0]
  v_pk_mul_f32 v[158:159], v[152:153], v[190:191] op_sel:[0,0] op_sel_hi:[1,0]
  v_pk_mul_f32 v[166:167], v[160:161], v[190:191] op_sel:[0,0] op_sel_hi:[1,0]
  v_pk_fma_f32 v[136:137], v[136:137], v[190:191], v[142:143] op_sel:[1,1,0] op_sel_hi:[0,1,1] neg_lo:[1,0,0]
  v_pk_fma_f32 v[144:145], v[144:145], v[190:191], v[150:151] op_sel:[1,1,0] op_sel_hi:[0,1,1] neg_lo:[1,0,0]
  v_pk_fma_f32 v[152:153], v[152:153], v[190:191], v[158:159] op_sel:[1,1,0] op_sel_hi:[0,1,1] neg_lo:[1,0,0]
  v_pk_fma_f32 v[160:161], v[160:161], v[190:191], v[166:167] op_sel:[1,1,0] op_sel_hi:[0,1,1] neg_lo:[1,0,0]
  v_pk_mul_f32 v[142:143], v[136:137], v[186:187] op_sel:[0,0] op_sel_hi:[1,0]
  v_pk_mul_f32 v[150:151], v[144:145], v[186:187] op_sel:[0,0] op_sel_hi:[1,0]
  v_pk_mul_f32 v[158:159], v[152:153], v[186:187] op_sel:[0,0] op_sel_hi:[1,0]
  v_pk_mul_f32 v[166:167], v[160:161], v[186:187] op_sel:[0,0] op_sel_hi:[1,0]
  v_pk_fma_f32 v[138:139], v[136:137], v[186:187], v[142:143] op_sel:[1,1,0] op_sel_hi:[0,1,1] neg_lo:[1,0,0]
  v_pk_fma_f32 v[146:147], v[144:145], v[186:187], v[150:151] op_sel:[1,1,0] op_sel_hi:[0,1,1] neg_lo:[1,0,0]
  v_pk_fma_f32 v[154:155], v[152:153], v[186:187], v[158:159] op_sel:[1,1,0] op_sel_hi:[0,1,1] neg_lo:[1,0,0]
  v_pk_fma_f32 v[162:163], v[160:161], v[186:187], v[166:167] op_sel:[1,1,0] op_sel_hi:[0,1,1] neg_lo:[1,0,0]
  v_cvt_pk_bf16_f32 v48, v136, v138
  v_cvt_pk_bf16_f32 v52, v137, v139
  v_cvt_pk_bf16_f32 v56, v144, v146
  v_cvt_pk_bf16_f32 v60, v145, v147
  v_cvt_pk_bf16_f32 v64, v152, v154
  v_cvt_pk_bf16_f32 v68, v153, v155
  v_cvt_pk_bf16_f32 v72, v160, v162
  v_cvt_pk_bf16_f32 v76, v161, v163
  v_pk_fma_f32 v[140:141], v[138:139], v[198:199], v[136:137] op_sel_hi:[1,0,1] neg_lo:[0,0,1] neg_hi:[0,0,1]
  v_pk_fma_f32 v[148:149], v[146:147], v[198:199], v[144:145] op_sel_hi:[1,0,1] neg_lo:[0,0,1] neg_hi:[0,0,1]
  v_pk_fma_f32 v[156:157], v[154:155], v[198:199], v[152:153] op_sel_hi:[1,0,1] neg_lo:[0,0,1] neg_hi:[0,0,1]
  v_pk_fma_f32 v[164:165], v[162:163], v[198:199], v[160:161] op_sel_hi:[1,0,1] neg_lo:[0,0,1] neg_hi:[0,0,1]
  v_pk_fma_f32 v[138:139], v[140:141], v[198:199], v[138:139] op_sel_hi:[1,0,1] neg_lo:[0,0,1] neg_hi:[0,0,1]
  v_pk_fma_f32 v[146:147], v[148:149], v[198:199], v[146:147] op_sel_hi:[1,0,1] neg_lo:[0,0,1] neg_hi:[0,0,1]
  v_pk_fma_f32 v[154:155], v[156:157], v[198:199], v[154:155] op_sel_hi:[1,0,1] neg_lo:[0,0,1] neg_hi:[0,0,1]
  v_pk_fma_f32 v[162:163], v[164:165], v[198:199], v[162:163] op_sel_hi:[1,0,1] neg_lo:[0,0,1] neg_hi:[0,0,1]
  v_cvt_pk_bf16_f32 v49, v140, v138
  v_cvt_pk_bf16_f32 v53, v141, v139
  v_cvt_pk_bf16_f32 v57, v148, v146
  v_cvt_pk_bf16_f32 v61, v149, v147
  v_cvt_pk_bf16_f32 v65, v156, v154
  v_cvt_pk_bf16_f32 v69, v157, v155
  v_cvt_pk_bf16_f32 v73, v164, v162
  v_cvt_pk_bf16_f32 v77, v165, v163
  v_pk_fma_f32 v[142:143], v[138:139], v[198:199], v[140:141] op_sel_hi:[1,0,1] neg_lo:[0,0,1] neg_hi:[0,0,1]
  v_pk_fma_f32 v[150:151], v[146:147], v[198:199], v[148:149] op_sel_hi:[1,0,1] neg_lo:[0,0,1] neg_hi:[0,0,1]
  v_pk_fma_f32 v[158:159], v[154:155], v[198:199], v[156:157] op_sel_hi:[1,0,1] neg_lo:[0,0,1] neg_hi:[0,0,1]
  v_pk_fma_f32 v[166:167], v[162:163], v[198:199], v[164:165] op_sel_hi:[1,0,1] neg_lo:[0,0,1] neg_hi:[0,0,1]
  v_pk_fma_f32 v[138:139], v[142:143], v[198:199], v[138:139] op_sel_hi:[1,0,1] neg_lo:[0,0,1] neg_hi:[0,0,1]
  v_pk_fma_f32 v[146:147], v[150:151], v[198:199], v[146:147] op_sel_hi:[1,0,1] neg_lo:[0,0,1] neg_hi:[0,0,1]
  v_pk_fma_f32 v[154:155], v[158:159], v[198:199], v[154:155] op_sel_hi:[1,0,1] neg_lo:[0,0,1] neg_hi:[0,0,1]
  v_pk_fma_f32 v[162:163], v[166:167], v[198:199], v[162:163] op_sel_hi:[1,0,1] neg_lo:[0,0,1] neg_hi:[0,0,1]
  v_cvt_pk_bf16_f32 v50, v142, v138
  v_cvt_pk_bf16_f32 v54, v143, v139
  v_cvt_pk_bf16_f32 v58, v150, v146
  v_cvt_pk_bf16_f32 v62, v151, v147
  v_cvt_pk_bf16_f32 v66, v158, v154
  v_cvt_pk_bf16_f32 v70, v159, v155
  v_cvt_pk_bf16_f32 v74, v166, v162
  v_cvt_pk_bf16_f32 v78, v167, v163
  v_pk_fma_f32 v[140:141], v[138:139], v[198:199], v[142:143] op_sel_hi:[1,0,1] neg_lo:[0,0,1] neg_hi:[0,0,1]
  v_pk_fma_f32 v[148:149], v[146:147], v[198:199], v[150:151] op_sel_hi:[1,0,1] neg_lo:[0,0,1] neg_hi:[0,0,1]
  v_pk_fma_f32 v[156:157], v[154:155], v[198:199], v[158:159] op_sel_hi:[1,0,1] neg_lo:[0,0,1] neg_hi:[0,0,1]
  v_pk_fma_f32 v[164:165], v[162:163], v[198:199], v[166:167] op_sel_hi:[1,0,1] neg_lo:[0,0,1] neg_hi:[0,0,1]
  v_pk_fma_f32 v[138:139], v[140:141], v[198:199], v[138:139] op_sel_hi:[1,0,1] neg_lo:[0,0,1] neg_hi:[0,0,1]
  v_pk_fma_f32 v[146:147], v[148:149], v[198:199], v[146:147] op_sel_hi:[1,0,1] neg_lo:[0,0,1] neg_hi:[0,0,1]
  v_pk_fma_f32 v[154:155], v[156:157], v[198:199], v[154:155] op_sel_hi:[1,0,1] neg_lo:[0,0,1] neg_hi:[0,0,1]
  v_pk_fma_f32 v[162:163], v[164:165], v[198:199], v[162:163] op_sel_hi:[1,0,1] neg_lo:[0,0,1] neg_hi:[0,0,1]
  v_cvt_pk_bf16_f32 v51, v140, v138
  v_cvt_pk_bf16_f32 v55, v141, v139
  v_cvt_pk_bf16_f32 v59, v148, v146
  v_cvt_pk_bf16_f32 v63, v149, v147
  v_cvt_pk_bf16_f32 v67, v156, v154
  v_cvt_pk_bf16_f32 v71, v157, v155
  v_cvt_pk_bf16_f32 v75, v164, v162
  v_cvt_pk_bf16_f32 v79, v165, v163
  s_cmp_eq_u32 s30, 3
  s_cbranch_scc0 Lc_1
  v_min_u32 v12, 55, v1
  v_lshlrev_b32 v12, 7, v12
  s_mul_i32 s54, s2, 7168
  buffer_load_dword v255, v12, s[8:11], s54 offen
  buffer_load_dword v255, v12, s[12:15], s54 offen
  s_sub_u32 s54, 32, s38
  s_and_b32 s54, s54, 31
  s_lshl_b32 s54, s54, 4
  s_add_u32 s54, s54, 15
  s_sub_u32 s54, s54, s39
  s_lshl_b32 s55, s38, 4
  s_add_u32 s55, s55, s39
  v_mov_b32 v12, s55
  v_mov_b32 v13, s54
  v_cmp_lt_u32 vcc, 31, v1
  s_nop 1
  v_cndmask_b32 v12, v12, v13, vcc
  v_bfe_u32 v13, v1, 4, 1
  v_lshl_add_u32 v12, v13, 9, v12
  v_and_b32 v13, 15, v1
  v_lshlrev_b32 v13, 7, v13
  v_lshl_add_u32 v14, v12, 11, v13
  buffer_load_dword v255, v14, s[20:23], s44 offen offset:0 sc1
  v_and_b32 v13, 128, v13
  v_lshl_add_u32 v14, v12, 8, v13
  buffer_load_dword v255, v14, s[20:23], s74 offen offset:0 sc1
  v_and_b32 v12, 15, v1
  v_lshlrev_b32 v12, 7, v12
  v_lshrrev_b32 v13, 4, v1
  v_lshl_add_u32 v12, v13, 15, v12
  s_lshl_b32 s55, s28, 11
  s_add_u32 s55, s55, 98304
  buffer_load_dword v255, v12, s[20:23], s55 offen offset:0 sc1
Lc_1:
  v_lshrrev_b32 v13, 4, v1
  v_lshlrev_b32 v13, 8, v13
  v_add_u32 v13, s34, v13
  v_cvt_f32_u32 v13, v13
  v_and_b32 v12, 15, v1
  v_cvt_f32_u32 v12, v12
  v_mul_f32 v12, 0x3a000000, v12
  v_mul_f32 v14, v13, v12
  v_mul_f32 v15, 0x42800000, v12
  v_cos_f32 v108, v14
  v_sin_f32 v109, v14
  v_cos_f32 v104, v15
  v_sin_f32 v105, v15
  s_nop 0
  v_pk_mul_f32 v[112:113], v[108:109], v[104:105] op_sel:[0,0] op_sel_hi:[1,0]
  v_pk_fma_f32 v[110:111], v[108:109], v[104:105], v[112:113] op_sel:[1,1,0] op_sel_hi:[0,1,1] neg_lo:[1,0,0]
  v_cvt_pk_bf16_f32 v80, v108, v110
  v_cvt_pk_bf16_f32 v84, v109, v111
  v_pk_mul_f32 v[112:113], v[110:111], v[104:105] op_sel:[0,0] op_sel_hi:[1,0]
  v_pk_fma_f32 v[108:109], v[110:111], v[104:105], v[112:113] op_sel:[1,1,0] op_sel_hi:[0,1,1] neg_lo:[1,0,0]
  v_pk_mul_f32 v[112:113], v[108:109], v[104:105] op_sel:[0,0] op_sel_hi:[1,0]
  v_pk_fma_f32 v[110:111], v[108:109], v[104:105], v[112:113] op_sel:[1,1,0] op_sel_hi:[0,1,1] neg_lo:[1,0,0]
  v_cvt_pk_bf16_f32 v81, v108, v110
  v_cvt_pk_bf16_f32 v85, v109, v111
  v_and_b32 v106, 1, v1
  v_mul_u32_u24 v106, 0x8000, v106
  v_lshl_or_b32 v106, v106, 16, v106
  v_xor_b32 v82, v106, v80
  v_xor_b32 v86, v106, v84
  v_xor_b32 v83, v106, v81
  v_xor_b32 v87, v106, v85
  v_xor_b32 v88, 0x80008000, v84
  v_xor_b32 v89, 0x80008000, v85
  v_xor_b32 v90, 0x80008000, v86
  v_xor_b32 v91, 0x80008000, v87
  v_and_b32 v12, 15, v1
  v_add_u32 v12, 16, v12
  v_cvt_f32_u32 v12, v12
  v_mul_f32 v12, 0x3a000000, v12
  v_mul_f32 v14, v13, v12
  v_mul_f32 v15, 0x42800000, v12
  v_cos_f32 v108, v14
  v_sin_f32 v109, v14
  v_cos_f32 v104, v15
  v_sin_f32 v105, v15
  s_nop 0
  v_pk_mul_f32 v[112:113], v[108:109], v[104:105] op_sel:[0,0] op_sel_hi:[1,0]
  v_pk_fma_f32 v[110:111], v[108:109], v[104:105], v[112:113] op_sel:[1,1,0] op_sel_hi:[0,1,1] neg_lo:[1,0,0]
  v_cvt_pk_bf16_f32 v92, v108, v110
  v_cvt_pk_bf16_f32 v96, v109, v111
  v_pk_mul_f32 v[112:113], v[110:111], v[104:105] op_sel:[0,0] op_sel_hi:[1,0]
  v_pk_fma_f32 v[108:109], v[110:111], v[104:105], v[112:113] op_sel:[1,1,0] op_sel_hi:[0,1,1] neg_lo:[1,0,0]
  v_pk_mul_f32 v[112:113], v[108:109], v[104:105] op_sel:[0,0] op_sel_hi:[1,0]
  v_pk_fma_f32 v[110:111], v[108:109], v[104:105], v[112:113] op_sel:[1,1,0] op_sel_hi:[0,1,1] neg_lo:[1,0,0]
  v_cvt_pk_bf16_f32 v93, v108, v110
  v_cvt_pk_bf16_f32 v97, v109, v111
  v_xor_b32 v94, v106, v92
  v_xor_b32 v98, v106, v96
  v_xor_b32 v95, v106, v93
  v_xor_b32 v99, v106, v97
  v_xor_b32 v100, 0x80008000, v96
  v_xor_b32 v101, 0x80008000, v97
  v_xor_b32 v102, 0x80008000, v98
  v_xor_b32 v103, 0x80008000, v99
  v_and_b32 v12, 15, v1
  v_lshrrev_b32 v13, 4, v1
  s_lshl_b32 s56, s30, 1
  s_add_u32 s54, s56, 0
  s_and_b32 s54, s54, 3
  s_lshl_b32 s54, s54, 2
  v_add_u32 v14, s54, v13
  v_xor_b32 v14, v14, v12
  v_lshlrev_b32 v14, 4, v14
  v_lshl_add_u32 v190, v12, 10, v14
  s_add_u32 s54, s56, 1
  s_and_b32 s54, s54, 3
  s_lshl_b32 s54, s54, 2
  v_add_u32 v14, s54, v13
  v_xor_b32 v14, v14, v12
  v_lshlrev_b32 v14, 4, v14
  v_lshl_add_u32 v191, v12, 10, v14
  s_add_u32 s54, s56, 2
  s_and_b32 s54, s54, 3
  s_lshl_b32 s54, s54, 2
  v_add_u32 v14, s54, v13
  v_xor_b32 v14, v14, v12
  v_lshlrev_b32 v14, 4, v14
  v_lshl_add_u32 v192, v12, 10, v14
  s_add_u32 s54, s56, 3
  s_and_b32 s54, s54, 3
  s_lshl_b32 s54, s54, 2
  v_add_u32 v14, s54, v13
  v_xor_b32 v14, v14, v12
  v_lshlrev_b32 v14, 4, v14
  v_lshl_add_u32 v193, v12, 10, v14
  s_add_u32 s54, s56, 0
  s_bfe_u32 s55, s54, 0x10002
  s_lshl_b32 s55, s55, 9
  s_and_b32 s54, s54, 8
  s_lshl_b32 s54, s54, 11
  s_add_u32 s54, s54, s55
  v_add_u32 v168, s54, v190
  v_xor_b32 v176, 0x4000, v168
  s_add_u32 s54, s56, 1
  s_bfe_u32 s55, s54, 0x10002
  s_lshl_b32 s55, s55, 9
  s_and_b32 s54, s54, 8
  s_lshl_b32 s54, s54, 11
  s_add_u32 s54, s54, s55
  v_add_u32 v169, s54, v191
  v_xor_b32 v177, 0x4000, v169
  s_add_u32 s54, s56, 2
  s_bfe_u32 s55, s54, 0x10002
  s_lshl_b32 s55, s55, 9
  s_and_b32 s54, s54, 8
  s_lshl_b32 s54, s54, 11
  s_add_u32 s54, s54, s55
  v_add_u32 v170, s54, v192
  v_xor_b32 v178, 0x4000, v170
  s_add_u32 s54, s56, 3
  s_bfe_u32 s55, s54, 0x10002
  s_lshl_b32 s55, s55, 9
  s_and_b32 s54, s54, 8
  s_lshl_b32 s54, s54, 11
  s_add_u32 s54, s54, s55
  v_add_u32 v171, s54, v193
  v_xor_b32 v179, 0x4000, v171
  s_add_u32 s54, s56, 4
  s_bfe_u32 s55, s54, 0x10002
  s_lshl_b32 s55, s55, 9
  s_and_b32 s54, s54, 8
  s_lshl_b32 s54, s54, 11
  s_add_u32 s54, s54, s55
  v_add_u32 v172, s54, v190
  v_xor_b32 v180, 0x4000, v172
  s_add_u32 s54, s56, 5
  s_bfe_u32 s55, s54, 0x10002
  s_lshl_b32 s55, s55, 9
  s_and_b32 s54, s54, 8
  s_lshl_b32 s54, s54, 11
  s_add_u32 s54, s54, s55
  v_add_u32 v173, s54, v191
  v_xor_b32 v181, 0x4000, v173
  s_add_u32 s54, s56, 6
  s_bfe_u32 s55, s54, 0x10002
  s_lshl_b32 s55, s55, 9
  s_and_b32 s54, s54, 8
  s_lshl_b32 s54, s54, 11
  s_add_u32 s54, s54, s55
  v_add_u32 v174, s54, v192
  v_xor_b32 v182, 0x4000, v174
  s_add_u32 s54, s56, 7
  s_bfe_u32 s55, s54, 0x10002
  s_lshl_b32 s55, s55, 9
  s_and_b32 s54, s54, 8
  s_lshl_b32 s54, s54, 11
  s_add_u32 s54, s54, s55
  v_add_u32 v175, s54, v193
  v_xor_b32 v183, 0x4000, v175
  s_waitcnt lgkmcnt(0)
  s_mul_i32 s31, s31, 0x9E3779B1
  s_add_u32 s31, s31, 0x7F4A7C15
  s_cmp_lt_u32 s30, 3
  s_cbranch_scc0 Lc_2
  s_waitcnt vmcnt(0)
Lc_2:
  s_waitcnt vmcnt(5)
  s_cmp_lg_u32 s30, 0
  s_cbranch_scc1 Lw_3
  s_lshl_b32 s55, s28, 4
  s_add_u32 s55, s55, s29
  s_lshl_b32 s55, s55, 7
  s_add_u32 s55, s55, 4096
  v_mov_b32 v14, s31
  v_mov_b32 v15, s48
  v_mov_b32 v12, 0
  s_mov_b64 exec, 1
  buffer_store_dwordx2 v[14:15], v12, s[20:23], s55 offen sc1
  s_mov_b64 exec, -1
Lw_3:
  s_barrier
  v_mov_b32 v224, 0x3f803f80
  v_mov_b32 v225, 0x3f803f80
  v_mov_b32 v226, 0x3f803f80
  v_mov_b32 v227, 0x3f803f80
  ds_read_b128 v[136:139], v168 offset:0
  ds_read_b128 v[140:143], v168 offset:256
  ds_read_b128 v[144:147], v169 offset:0
  ds_read_b128 v[148:151], v169 offset:256
  ds_read_b128 v[152:155], v176 offset:0
  ds_read_b128 v[156:159], v176 offset:256
  s_waitcnt lgkmcnt(4)
  v_mfma_f32_16x16x32_bf16 v[104:107], v[136:139], v[16:19], 0
  ds_read_b128 v[160:163], v177 offset:0
  v_mfma_f32_16x16x32_bf16 v[112:115], v[136:139], v[20:23], 0
  v_mfma_f32_16x16x32_bf16 v[208:211], v[136:139], v[224:227], 0
  v_mfma_f32_16x16x32_bf16 v[216:219], v[136:139], v[136:139], 0
  v_mfma_f32_16x16x32_bf16 v[108:111], v[140:143], v[16:19], 0
  ds_read_b128 v[164:167], v177 offset:256
  v_mfma_f32_16x16x32_bf16 v[116:119], v[140:143], v[20:23], 0
  v_mfma_f32_16x16x32_bf16 v[212:215], v[140:143], v[224:227], 0
  v_mfma_f32_16x16x32_bf16 v[220:223], v[140:143], v[140:143], 0
  s_waitcnt lgkmcnt(4)
  v_mfma_f32_16x16x32_bf16 v[104:107], v[144:147], v[24:27], v[104:107]
  ds_read_b128 v[136:139], v170 offset:0
  v_mfma_f32_16x16x32_bf16 v[112:115], v[144:147], v[28:31], v[112:115]
  v_mfma_f32_16x16x32_bf16 v[208:211], v[144:147], v[224:227], v[208:211]
  v_mfma_f32_16x16x32_bf16 v[216:219], v[144:147], v[144:147], v[216:219]
  v_mfma_f32_16x16x32_bf16 v[108:111], v[148:151], v[24:27], v[108:111]
  ds_read_b128 v[140:143], v170 offset:256
  v_mfma_f32_16x16x32_bf16 v[116:119], v[148:151], v[28:31], v[116:119]
  v_mfma_f32_16x16x32_bf16 v[212:215], v[148:151], v[224:227], v[212:215]
  v_mfma_f32_16x16x32_bf16 v[220:223], v[148:151], v[148:151], v[220:223]
  s_waitcnt lgkmcnt(4)
  v_mfma_f32_16x16x32_bf16 v[120:123], v[152:155], v[16:19], 0
  ds_read_b128 v[144:147], v171 offset:0
  v_mfma_f32_16x16x32_bf16 v[128:131], v[152:155], v[20:23], 0
  v_mfma_f32_16x16x32_bf16 v[208:211], v[152:155], v[224:227], v[208:211]
  v_mfma_f32_16x16x32_bf16 v[216:219], v[152:155], v[152:155], v[216:219]
  v_mfma_f32_16x16x32_bf16 v[124:127], v[156:159], v[16:19], 0
  ds_read_b128 v[148:151], v171 offset:256
  v_mfma_f32_16x16x32_bf16 v[132:135], v[156:159], v[20:23], 0
  v_mfma_f32_16x16x32_bf16 v[212:215], v[156:159], v[224:227], v[212:215]
  v_mfma_f32_16x16x32_bf16 v[220:223], v[156:159], v[156:159], v[220:223]
  s_waitcnt lgkmcnt(4)
  v_mfma_f32_16x16x32_bf16 v[120:123], v[160:163], v[24:27], v[120:123]
  ds_read_b128 v[152:155], v178 offset:0
  v_mfma_f32_16x16x32_bf16 v[128:131], v[160:163], v[28:31], v[128:131]
  v_mfma_f32_16x16x32_bf16 v[208:211], v[160:163], v[224:227], v[208:211]
  v_mfma_f32_16x16x32_bf16 v[216:219], v[160:163], v[160:163], v[216:219]
  v_mfma_f32_16x16x32_bf16 v[124:127], v[164:167], v[24:27], v[124:127]
  ds_read_b128 v[156:159], v178 offset:256
  v_mfma_f32_16x16x32_bf16 v[132:135], v[164:167], v[28:31], v[132:135]
  v_mfma_f32_16x16x32_bf16 v[212:215], v[164:167], v[224:227], v[212:215]
  v_mfma_f32_16x16x32_bf16 v[220:223], v[164:167], v[164:167], v[220:223]
  s_waitcnt lgkmcnt(4)
  v_mfma_f32_16x16x32_bf16 v[104:107], v[136:139], v[32:35], v[104:107]
  ds_read_b128 v[160:163], v179 offset:0
  v_and_b32 v14, 15, v1
  v_mfma_f32_16x16x32_bf16 v[112:115], v[136:139], v[36:39], v[112:115]
  v_lshrrev_b32 v15, 4, v1
  v_lshlrev_b32 v236, 16, v15
  v_mfma_f32_16x16x32_bf16 v[108:111], v[140:143], v[32:35], v[108:111]
  ds_read_b128 v[164:167], v179 offset:256
  v_lshl_add_u32 v236, v14, 4, v236
  v_mfma_f32_16x16x32_bf16 v[116:119], v[140:143], v[36:39], v[116:119]
  s_lshl_b32 s90, s34, 10
  s_lshl_b32 s91, s35, 8
  s_add_u32 s90, s90, s91
  s_lshl_b32 s91, s30, 19
  s_add_u32 s90, s90, s91
  s_add_u32 s90, s90, s43
  s_add_u32 s91, s90, 262144
  s_lshl_b32 s93, s30, 6
  s_add_u32 s93, s93, 32768
  s_mul_i32 s94, s30, 2176
  s_add_u32 s94, s94, 32768
  v_mul_u32_u24 v237, 272, v14
  v_lshl_add_u32 v237, v15, 4, v237
  s_waitcnt lgkmcnt(4)
  v_mfma_f32_16x16x32_bf16 v[104:107], v[144:147], v[40:43], v[104:107]
  ds_read_b128 v[136:139], v172 offset:0
  v_mfma_f32_16x16x32_bf16 v[112:115], v[144:147], v[44:47], v[112:115]
  v_mfma_f32_16x16x32_bf16 v[108:111], v[148:151], v[40:43], v[108:111]
  ds_read_b128 v[140:143], v172 offset:256
  v_mfma_f32_16x16x32_bf16 v[116:119], v[148:151], v[44:47], v[116:119]
  s_mov_b32 vcc_lo, 0xaaaaaaaa
  s_mov_b32 vcc_hi, 0xaaaaaaaa
  s_mov_b32 s62, 0xcccccccc
  s_mov_b32 s63, 0xcccccccc
  v_cndmask_b32 v208, v208, v209, vcc
  v_cndmask_b32 v210, v210, v211, vcc
  v_cndmask_b32 v212, v212, v213, vcc
  v_cndmask_b32 v214, v214, v215, vcc
  v_cndmask_b32 v216, v216, v217, vcc
  v_cndmask_b32 v218, v218, v219, vcc
  v_cndmask_b32 v220, v220, v221, vcc
  v_cndmask_b32 v222, v222, v223, vcc
  v_cndmask_b32 v208, v208, v210, s[62:63]
  v_cndmask_b32 v212, v212, v214, s[62:63]
  v_cndmask_b32 v216, v216, v218, s[62:63]
  v_cndmask_b32 v220, v220, v222, s[62:63]
  s_lshl_b32 s54, s30, 8
  s_add_u32 s54, s54, 155648
  v_and_b32 v187, 15, v1
  v_lshlrev_b32 v187, 2, v187
  v_add_u32 v187, s54, v187
  s_mov_b32 exec_lo, 0x00f0000f
  s_mov_b32 exec_hi, 0xf0000f00
  ds_write_b32 v187, v208 offset:0
  ds_write_b32 v187, v212 offset:64
  ds_write_b32 v187, v216 offset:128
  ds_write_b32 v187, v220 offset:192
  s_mov_b64 exec, -1
  v_lshlrev_b32 v186, 2, v1
  v_add_u32 v186, 155648, v186
  s_waitcnt lgkmcnt(8)
  v_mfma_f32_16x16x32_bf16 v[120:123], v[152:155], v[32:35], v[120:123]
  ds_read_b128 v[144:147], v173 offset:0
  v_mfma_f32_16x16x32_bf16 v[128:131], v[152:155], v[36:39], v[128:131]
  v_mfma_f32_16x16x32_bf16 v[124:127], v[156:159], v[32:35], v[124:127]
  ds_read_b128 v[148:151], v173 offset:256
  v_mfma_f32_16x16x32_bf16 v[132:135], v[156:159], v[36:39], v[132:135]
  s_waitcnt lgkmcnt(8)
  v_mfma_f32_16x16x32_bf16 v[120:123], v[160:163], v[40:43], v[120:123]
  ds_read_b128 v[152:155], v180 offset:0
  v_mfma_f32_16x16x32_bf16 v[128:131], v[160:163], v[44:47], v[128:131]
  v_mfma_f32_16x16x32_bf16 v[124:127], v[164:167], v[40:43], v[124:127]
  ds_read_b128 v[156:159], v180 offset:256
  v_mfma_f32_16x16x32_bf16 v[132:135], v[164:167], v[44:47], v[132:135]
  s_waitcnt lgkmcnt(4)
  s_barrier
  ds_read2st64_b32 v[188:189], v186 offset0:0 offset1:1
  ds_read2st64_b32 v[190:191], v186 offset0:2 offset1:3
  v_mfma_f32_16x16x32_bf16 v[104:107], v[136:139], v[48:51], v[104:107]
  ds_read_b128 v[160:163], v181 offset:0
  v_mfma_f32_16x16x32_bf16 v[112:115], v[136:139], v[52:55], v[112:115]
  v_mfma_f32_16x16x32_bf16 v[108:111], v[140:143], v[48:51], v[108:111]
  ds_read_b128 v[164:167], v181 offset:256
  v_mfma_f32_16x16x32_bf16 v[116:119], v[140:143], v[52:55], v[116:119]
  s_waitcnt lgkmcnt(6)
  v_mfma_f32_16x16x32_bf16 v[104:107], v[144:147], v[56:59], v[104:107]
  ds_read_b128 v[136:139], v174 offset:0
  v_mfma_f32_16x16x32_bf16 v[112:115], v[144:147], v[60:63], v[112:115]
  v_mfma_f32_16x16x32_bf16 v[108:111], v[148:151], v[56:59], v[108:111]
  ds_read_b128 v[140:143], v174 offset:256
  v_mfma_f32_16x16x32_bf16 v[116:119], v[148:151], v[60:63], v[116:119]
  s_waitcnt lgkmcnt(4)
  v_add_f32 v188, v188, v189
  v_add_f32 v190, v190, v191
  v_add_f32 v188, v188, v190
  v_mov_b32 v189, v188
  s_nop 1
  v_permlane32_swap_b32 v188, v189
  v_mul_f32 v188, 0x3b000000, v188
  v_mul_f32 v189, 0x3b000000, v189
  v_fma_f32 v189, -v188, v188, v189
  v_max_f32 v189, 0, v189
  v_add_f32 v189, 0x3727c5ac, v189
  v_rsq_f32 v189, v189
  s_lshl_b32 s54, s30, 7
  s_add_u32 s54, s54, 156672
  v_and_b32 v186, 31, v1
  v_lshlrev_b32 v186, 2, v186
  v_add_u32 v186, s54, v186
  ds_write_b32 v186, v189
  v_lshrrev_b32 v186, 4, v1
  v_lshlrev_b32 v186, 4, v186
  v_add_u32 v186, s54, v186
  v_mfma_f32_16x16x32_bf16 v[120:123], v[152:155], v[48:51], v[120:123]
  ds_read_b128 v[144:147], v175 offset:0
  v_add_u32 v237, s93, v237
  v_mfma_f32_16x16x32_bf16 v[128:131], v[152:155], v[52:55], v[128:131]
  v_mul_u32_u24 v238, 272, v15
  v_lshl_add_u32 v238, v14, 4, v238
  v_mfma_f32_16x16x32_bf16 v[124:127], v[156:159], v[48:51], v[124:127]
  ds_read_b128 v[148:151], v175 offset:256
  v_add_u32 v238, s94, v238
  v_mfma_f32_16x16x32_bf16 v[132:135], v[156:159], v[52:55], v[132:135]
  s_lshl_b32 s93, s39, 7
  s_lshl_b32 s94, s30, 4
  s_lshl_b32 s92, s38, 16
  s_add_u32 s92, s92, s43
  v_add_u32 v12, 0, v1
  v_min_u32 v12, 143, v12
  s_waitcnt lgkmcnt(5)
  v_mfma_f32_16x16x32_bf16 v[120:123], v[160:163], v[56:59], v[120:123]
  ds_read_b128 v[152:155], v182 offset:0
  v_mul_u32_u24 v13, 57, v12
  v_mfma_f32_16x16x32_bf16 v[128:131], v[160:163], v[60:63], v[128:131]
  v_lshrrev_b32 v13, 9, v13
  v_mul_u32_u24 v14, 9, v13
  v_mfma_f32_16x16x32_bf16 v[124:127], v[164:167], v[56:59], v[124:127]
  ds_read_b128 v[156:159], v182 offset:256
  v_sub_u32 v12, v12, v14
  v_mfma_f32_16x16x32_bf16 v[132:135], v[164:167], v[60:63], v[132:135]
  v_lshlrev_b32 v12, 4, v12
  v_add_u32 v13, s94, v13
  s_waitcnt lgkmcnt(5)
  v_mfma_f32_16x16x32_bf16 v[104:107], v[136:139], v[64:67], v[104:107]
  ds_read_b128 v[160:163], v183 offset:0
  v_lshl_add_u32 v231, v13, 8, v12
  v_mfma_f32_16x16x32_bf16 v[112:115], v[136:139], v[68:71], v[112:115]
  v_add_u32 v231, 45056, v231
  v_add_u32 v12, s93, v12
  v_mfma_f32_16x16x32_bf16 v[108:111], v[140:143], v[64:67], v[108:111]
  ds_read_b128 v[164:167], v183 offset:256
  v_and_b32 v12, 0x3ff, v12
  v_mfma_f32_16x16x32_bf16 v[116:119], v[140:143], v[68:71], v[116:119]
  v_lshl_add_u32 v228, v13, 10, v12
  v_add_u32 v12, 64, v1
  s_waitcnt lgkmcnt(6)
  ds_read_b128 v[188:191], v186
  ds_read_b128 v[192:195], v186 offset:64
  s_waitcnt lgkmcnt(6)
  v_mfma_f32_16x16x32_bf16 v[104:107], v[144:147], v[72:75], v[104:107]
  v_min_u32 v12, 143, v12
  v_mul_u32_u24 v13, 57, v12
  v_mfma_f32_16x16x32_bf16 v[112:115], v[144:147], v[76:79], v[112:115]
  v_lshrrev_b32 v13, 9, v13
  v_mul_u32_u24 v14, 9, v13
  v_mfma_f32_16x16x32_bf16 v[108:111], v[148:151], v[72:75], v[108:111]
  v_sub_u32 v12, v12, v14
  v_lshlrev_b32 v12, 4, v12
  v_mfma_f32_16x16x32_bf16 v[116:119], v[148:151], v[76:79], v[116:119]
  v_add_u32 v13, s94, v13
  v_lshl_add_u32 v232, v13, 8, v12
  s_waitcnt lgkmcnt(4)
  v_mfma_f32_16x16x32_bf16 v[120:123], v[152:155], v[64:67], v[120:123]
  v_add_u32 v232, 45056, v232
  v_add_u32 v12, s93, v12
  v_mfma_f32_16x16x32_bf16 v[128:131], v[152:155], v[68:71], v[128:131]
  v_and_b32 v12, 0x3ff, v12
  v_lshl_add_u32 v229, v13, 10, v12
  v_mfma_f32_16x16x32_bf16 v[124:127], v[156:159], v[64:67], v[124:127]
  v_add_u32 v12, 128, v1
  v_min_u32 v12, 143, v12
  v_mfma_f32_16x16x32_bf16 v[132:135], v[156:159], v[68:71], v[132:135]
  v_mul_u32_u24 v13, 57, v12
  v_lshrrev_b32 v13, 9, v13
  s_waitcnt lgkmcnt(2)
  v_mfma_f32_16x16x32_bf16 v[120:123], v[160:163], v[72:75], v[120:123]
  v_mul_u32_u24 v14, 9, v13
  v_sub_u32 v12, v12, v14
  v_mfma_f32_16x16x32_bf16 v[128:131], v[160:163], v[76:79], v[128:131]
  v_lshlrev_b32 v12, 4, v12
  v_add_u32 v13, s94, v13
  v_mfma_f32_16x16x32_bf16 v[124:127], v[164:167], v[72:75], v[124:127]
  v_lshl_add_u32 v233, v13, 8, v12
  v_add_u32 v233, 45056, v233
  v_mfma_f32_16x16x32_bf16 v[132:135], v[164:167], v[76:79], v[132:135]
  v_add_u32 v12, s93, v12
  v_and_b32 v12, 0x3ff, v12
  v_lshl_add_u32 v230, v13, 10, v12
  v_bfe_u32 v12, v1, 2, 1
  v_lshlrev_b32 v12, 5, v12
  v_mov_b32 v13, s36
  v_mov_b32 v14, s37
  s_mov_b32 s96, 0xff000000
  s_mov_b32 s97, 0
  v_cndmask_b32 v13, v13, v14, s[96:97]
  v_add_u32 v12, v12, v13
  v_and_b32 v13, 3, v1
  v_lshlrev_b32 v13, 8, v13
  v_lshl_add_u32 v12, v12, 10, v13
  s_mov_b32 s96, 0xffff0000
  v_mov_b32 v13, 45296
  v_cndmask_b32 v230, v230, v12, s[96:97]
  v_cndmask_b32 v233, v233, v13, s[96:97]
  s_waitcnt lgkmcnt(0)
  s_branch L_join
L_layer:
  s_barrier
  ds_read_b128 v[136:139], v168 offset:0
  ds_read_b128 v[140:143], v168 offset:256
  ds_read_b128 v[144:147], v169 offset:0
  ds_read_b128 v[148:151], v169 offset:256
  ds_read_b128 v[152:155], v176 offset:0
  ds_read_b128 v[156:159], v176 offset:256
  s_waitcnt lgkmcnt(4)
  v_mfma_f32_16x16x32_bf16 v[104:107], v[136:139], v[16:19], 0
  ds_read_b128 v[160:163], v177 offset:0
  v_mfma_f32_16x16x32_bf16 v[112:115], v[136:139], v[20:23], 0
  v_mfma_f32_16x16x32_bf16 v[108:111], v[140:143], v[16:19], 0
  ds_read_b128 v[164:167], v177 offset:256
  v_mfma_f32_16x16x32_bf16 v[116:119], v[140:143], v[20:23], 0
  s_waitcnt lgkmcnt(4)
  v_mfma_f32_16x16x32_bf16 v[104:107], v[144:147], v[24:27], v[104:107]
  ds_read_b128 v[136:139], v170 offset:0
  v_and_b32 v14, 15, v1
  v_mfma_f32_16x16x32_bf16 v[112:115], v[144:147], v[28:31], v[112:115]
  v_lshrrev_b32 v15, 4, v1
  v_lshlrev_b32 v236, 16, v15
  v_mfma_f32_16x16x32_bf16 v[108:111], v[148:151], v[24:27], v[108:111]
  ds_read_b128 v[140:143], v170 offset:256
  v_lshl_add_u32 v236, v14, 4, v236
  v_mfma_f32_16x16x32_bf16 v[116:119], v[148:151], v[28:31], v[116:119]
  s_lshl_b32 s90, s34, 10
  s_lshl_b32 s91, s35, 8
  s_add_u32 s90, s90, s91
  s_lshl_b32 s91, s30, 19
  s_add_u32 s90, s90, s91
  s_add_u32 s90, s90, s43
  s_add_u32 s91, s90, 262144
  s_lshl_b32 s93, s30, 6
  s_add_u32 s93, s93, 32768
  s_mul_i32 s94, s30, 2176
  s_add_u32 s94, s94, 32768
  v_mul_u32_u24 v237, 272, v14
  v_lshl_add_u32 v237, v15, 4, v237
  s_waitcnt lgkmcnt(4)
  v_mfma_f32_16x16x32_bf16 v[120:123], v[152:155], v[16:19], 0
  ds_read_b128 v[144:147], v171 offset:0
  v_add_u32 v237, s93, v237
  v_mfma_f32_16x16x32_bf16 v[128:131], v[152:155], v[20:23], 0
  v_mul_u32_u24 v238, 272, v15
  v_lshl_add_u32 v238, v14, 4, v238
  v_mfma_f32_16x16x32_bf16 v[124:127], v[156:159], v[16:19], 0
  ds_read_b128 v[148:151], v171 offset:256
  v_add_u32 v238, s94, v238
  v_mfma_f32_16x16x32_bf16 v[132:135], v[156:159], v[20:23], 0
  s_lshl_b32 s93, s39, 7
  s_lshl_b32 s94, s30, 4
  s_lshl_b32 s92, s38, 16
  s_add_u32 s92, s92, s43
  v_add_u32 v12, 0, v1
  v_min_u32 v12, 143, v12
  s_waitcnt lgkmcnt(4)
  v_mfma_f32_16x16x32_bf16 v[120:123], v[160:163], v[24:27], v[120:123]
  ds_read_b128 v[152:155], v178 offset:0
  v_mul_u32_u24 v13, 57, v12
  v_mfma_f32_16x16x32_bf16 v[128:131], v[160:163], v[28:31], v[128:131]
  v_lshrrev_b32 v13, 9, v13
  v_mul_u32_u24 v14, 9, v13
  v_mfma_f32_16x16x32_bf16 v[124:127], v[164:167], v[24:27], v[124:127]
  ds_read_b128 v[156:159], v178 offset:256
  v_sub_u32 v12, v12, v14
  v_mfma_f32_16x16x32_bf16 v[132:135], v[164:167], v[28:31], v[132:135]
  v_lshlrev_b32 v12, 4, v12
  v_add_u32 v13, s94, v13
  s_waitcnt lgkmcnt(4)
  v_mfma_f32_16x16x32_bf16 v[104:107], v[136:139], v[32:35], v[104:107]
  ds_read_b128 v[160:163], v179 offset:0
  v_lshl_add_u32 v231, v13, 8, v12
  v_mfma_f32_16x16x32_bf16 v[112:115], v[136:139], v[36:39], v[112:115]
  v_add_u32 v231, 45056, v231
  v_add_u32 v12, s93, v12
  v_mfma_f32_16x16x32_bf16 v[108:111], v[140:143], v[32:35], v[108:111]
  ds_read_b128 v[164:167], v179 offset:256
  v_and_b32 v12, 0x3ff, v12
  v_mfma_f32_16x16x32_bf16 v[116:119], v[140:143], v[36:39], v[116:119]
  v_lshl_add_u32 v228, v13, 10, v12
  v_add_u32 v12, 64, v1
  s_waitcnt lgkmcnt(4)
  v_mfma_f32_16x16x32_bf16 v[104:107], v[144:147], v[40:43], v[104:107]
  ds_read_b128 v[136:139], v172 offset:0
  v_min_u32 v12, 143, v12
  v_mfma_f32_16x16x32_bf16 v[112:115], v[144:147], v[44:47], v[112:115]
  v_mul_u32_u24 v13, 57, v12
  v_lshrrev_b32 v13, 9, v13
  v_mfma_f32_16x16x32_bf16 v[108:111], v[148:151], v[40:43], v[108:111]
  ds_read_b128 v[140:143], v172 offset:256
  v_mul_u32_u24 v14, 9, v13
  v_mfma_f32_16x16x32_bf16 v[116:119], v[148:151], v[44:47], v[116:119]
  v_sub_u32 v12, v12, v14
  v_lshlrev_b32 v12, 4, v12
  s_waitcnt lgkmcnt(4)
  v_mfma_f32_16x16x32_bf16 v[120:123], v[152:155], v[32:35], v[120:123]
  ds_read_b128 v[144:147], v173 offset:0
  v_add_u32 v13, s94, v13
  v_mfma_f32_16x16x32_bf16 v[128:131], v[152:155], v[36:39], v[128:131]
  v_lshl_add_u32 v232, v13, 8, v12
  v_add_u32 v232, 45056, v232
  v_mfma_f32_16x16x32_bf16 v[124:127], v[156:159], v[32:35], v[124:127]
  ds_read_b128 v[148:151], v173 offset:256
  v_add_u32 v12, s93, v12
  v_mfma_f32_16x16x32_bf16 v[132:135], v[156:159], v[36:39], v[132:135]
  v_and_b32 v12, 0x3ff, v12
  v_lshl_add_u32 v229, v13, 10, v12
  s_waitcnt lgkmcnt(4)
  v_mfma_f32_16x16x32_bf16 v[120:123], v[160:163], v[40:43], v[120:123]
  ds_read_b128 v[152:155], v180 offset:0
  v_add_u32 v12, 128, v1
  v_mfma_f32_16x16x32_bf16 v[128:131], v[160:163], v[44:47], v[128:131]
  v_min_u32 v12, 143, v12
  v_mul_u32_u24 v13, 57, v12
  v_mfma_f32_16x16x32_bf16 v[124:127], v[164:167], v[40:43], v[124:127]
  ds_read_b128 v[156:159], v180 offset:256
  v_lshrrev_b32 v13, 9, v13
  v_mfma_f32_16x16x32_bf16 v[132:135], v[164:167], v[44:47], v[132:135]
  v_mul_u32_u24 v14, 9, v13
  v_sub_u32 v12, v12, v14
  s_waitcnt lgkmcnt(4)
  v_mfma_f32_16x16x32_bf16 v[104:107], v[136:139], v[48:51], v[104:107]
  ds_read_b128 v[160:163], v181 offset:0
  v_lshlrev_b32 v12, 4, v12
  v_mfma_f32_16x16x32_bf16 v[112:115], v[136:139], v[52:55], v[112:115]
  v_add_u32 v13, s94, v13
  v_lshl_add_u32 v233, v13, 8, v12
  v_mfma_f32_16x16x32_bf16 v[108:111], v[140:143], v[48:51], v[108:111]
  ds_read_b128 v[164:167], v181 offset:256
  v_add_u32 v233, 45056, v233
  v_mfma_f32_16x16x32_bf16 v[116:119], v[140:143], v[52:55], v[116:119]
  v_add_u32 v12, s93, v12
  v_and_b32 v12, 0x3ff, v12
  s_waitcnt lgkmcnt(4)
  v_mfma_f32_16x16x32_bf16 v[104:107], v[144:147], v[56:59], v[104:107]
  ds_read_b128 v[136:139], v174 offset:0
  v_lshl_add_u32 v230, v13, 10, v12
  v_mfma_f32_16x16x32_bf16 v[112:115], v[144:147], v[60:63], v[112:115]
  v_bfe_u32 v12, v1, 2, 1
  v_lshlrev_b32 v12, 5, v12
  v_mfma_f32_16x16x32_bf16 v[108:111], v[148:151], v[56:59], v[108:111]
  ds_read_b128 v[140:143], v174 offset:256
  v_mov_b32 v13, s36
  v_mfma_f32_16x16x32_bf16 v[116:119], v[148:151], v[60:63], v[116:119]
  v_mov_b32 v14, s37
  s_mov_b32 s96, 0xff000000
  s_mov_b32 s97, 0
  v_cndmask_b32 v13, v13, v14, s[96:97]
  s_waitcnt lgkmcnt(4)
  v_mfma_f32_16x16x32_bf16 v[120:123], v[152:155], v[48:51], v[120:123]
  ds_read_b128 v[144:147], v175 offset:0
  v_add_u32 v12, v12, v13
  v_mfma_f32_16x16x32_bf16 v[128:131], v[152:155], v[52:55], v[128:131]
  v_and_b32 v13, 3, v1
  v_lshlrev_b32 v13, 8, v13
  v_mfma_f32_16x16x32_bf16 v[124:127], v[156:159], v[48:51], v[124:127]
  ds_read_b128 v[148:151], v175 offset:256
  v_lshl_add_u32 v12, v12, 10, v13
  v_mfma_f32_16x16x32_bf16 v[132:135], v[156:159], v[52:55], v[132:135]
  s_mov_b32 s96, 0xffff0000
  v_mov_b32 v13, 45296
  v_cndmask_b32 v230, v230, v12, s[96:97]
  s_waitcnt lgkmcnt(4)
  v_mfma_f32_16x16x32_bf16 v[120:123], v[160:163], v[56:59], v[120:123]
  ds_read_b128 v[152:155], v182 offset:0
  v_cndmask_b32 v233, v233, v13, s[96:97]
  v_mfma_f32_16x16x32_bf16 v[128:131], v[160:163], v[60:63], v[128:131]
  v_mfma_f32_16x16x32_bf16 v[124:127], v[164:167], v[56:59], v[124:127]
  ds_read_b128 v[156:159], v182 offset:256
  v_mfma_f32_16x16x32_bf16 v[132:135], v[164:167], v[60:63], v[132:135]
  s_waitcnt lgkmcnt(4)
  v_mfma_f32_16x16x32_bf16 v[104:107], v[136:139], v[64:67], v[104:107]
  ds_read_b128 v[160:163], v183 offset:0
  v_mfma_f32_16x16x32_bf16 v[112:115], v[136:139], v[68:71], v[112:115]
  v_mfma_f32_16x16x32_bf16 v[108:111], v[140:143], v[64:67], v[108:111]
  ds_read_b128 v[164:167], v183 offset:256
  v_mfma_f32_16x16x32_bf16 v[116:119], v[140:143], v[68:71], v[116:119]
  s_waitcnt lgkmcnt(4)
  v_mfma_f32_16x16x32_bf16 v[104:107], v[144:147], v[72:75], v[104:107]
  v_mfma_f32_16x16x32_bf16 v[112:115], v[144:147], v[76:79], v[112:115]
  v_mfma_f32_16x16x32_bf16 v[108:111], v[148:151], v[72:75], v[108:111]
  v_mfma_f32_16x16x32_bf16 v[116:119], v[148:151], v[76:79], v[116:119]
  s_waitcnt lgkmcnt(2)
  v_mfma_f32_16x16x32_bf16 v[120:123], v[152:155], v[64:67], v[120:123]
  v_mfma_f32_16x16x32_bf16 v[128:131], v[152:155], v[68:71], v[128:131]
  v_mfma_f32_16x16x32_bf16 v[124:127], v[156:159], v[64:67], v[124:127]
  v_mfma_f32_16x16x32_bf16 v[132:135], v[156:159], v[68:71], v[132:135]
  s_waitcnt lgkmcnt(0)
  v_mfma_f32_16x16x32_bf16 v[120:123], v[160:163], v[72:75], v[120:123]
  v_mfma_f32_16x16x32_bf16 v[128:131], v[160:163], v[76:79], v[128:131]
  v_mfma_f32_16x16x32_bf16 v[124:127], v[164:167], v[72:75], v[124:127]
  v_mfma_f32_16x16x32_bf16 v[132:135], v[164:167], v[76:79], v[132:135]
  s_waitcnt lgkmcnt(0)
  s_waitcnt vmcnt(0)
L_join:
  s_nop 2
  v_fma_f32 v104, v120, v184, v104
  v_fma_f32 v105, v121, v184, v105
  v_fma_f32 v106, v122, v184, v106
  v_fma_f32 v107, v123, v184, v107
  v_mul_f32 v104, v104, v188
  v_mul_f32 v105, v105, v189
  v_mul_f32 v106, v106, v190
  v_mul_f32 v107, v107, v191
  v_cvt_pk_bf16_f32 v136, v104, v105
  v_cvt_pk_bf16_f32 v137, v106, v107
  v_fma_f32 v108, v124, v184, v108
  v_fma_f32 v109, v125, v184, v109
  v_fma_f32 v110, v126, v184, v110
  v_fma_f32 v111, v127, v184, v111
  v_mul_f32 v108, v108, v192
  v_mul_f32 v109, v109, v193
  v_mul_f32 v110, v110, v194
  v_mul_f32 v111, v111, v195
  v_cvt_pk_bf16_f32 v138, v108, v109
  v_cvt_pk_bf16_f32 v139, v110, v111
  v_fma_f32 v112, v128, v184, v112
  v_fma_f32 v113, v129, v184, v113
  v_fma_f32 v114, v130, v184, v114
  v_fma_f32 v115, v131, v184, v115
  v_mul_f32 v112, -v112, v188
  v_mul_f32 v113, -v113, v189
  v_mul_f32 v114, -v114, v190
  v_mul_f32 v115, -v115, v191
  v_cvt_pk_bf16_f32 v140, v112, v113
  v_cvt_pk_bf16_f32 v141, v114, v115
  v_fma_f32 v116, v132, v184, v116
  v_fma_f32 v117, v133, v184, v117
  v_fma_f32 v118, v134, v184, v118
  v_fma_f32 v119, v135, v184, v119
  v_mul_f32 v116, -v116, v192
  v_mul_f32 v117, -v117, v193
  v_mul_f32 v118, -v118, v194
  v_mul_f32 v119, -v119, v195
  v_cvt_pk_bf16_f32 v142, v116, v117
  v_cvt_pk_bf16_f32 v143, v118, v119
  v_mfma_f32_16x16x32_bf16 v[120:123], v[136:139], v[80:83], 0
  s_nop 0
  v_mfma_f32_16x16x32_bf16 v[124:127], v[140:143], v[80:83], 0
  v_mfma_f32_16x16x32_bf16 v[128:131], v[136:139], v[92:95], 0
  v_mfma_f32_16x16x32_bf16 v[132:135], v[140:143], v[92:95], 0
  v_mfma_f32_16x16x32_bf16 v[120:123], v[140:143], v[84:87], v[120:123]
  v_mfma_f32_16x16x32_bf16 v[124:127], v[136:139], v[88:91], v[124:127]
  v_mfma_f32_16x16x32_bf16 v[128:131], v[140:143], v[96:99], v[128:131]
  v_mfma_f32_16x16x32_bf16 v[132:135], v[136:139], v[100:103], v[132:135]
  s_nop 5
  v_cvt_pk_bf16_f32 v104, v120, v124
  v_cvt_pk_bf16_f32 v105, v121, v125
  v_cvt_pk_bf16_f32 v106, v122, v126
  v_cvt_pk_bf16_f32 v107, v123, v127
  ds_write_b128 v237, v[104:107] offset:0
  v_cvt_pk_bf16_f32 v108, v128, v132
  v_cvt_pk_bf16_f32 v109, v129, v133
  v_cvt_pk_bf16_f32 v110, v130, v134
  v_cvt_pk_bf16_f32 v111, v131, v135
  ds_write_b128 v237, v[108:111] offset:4352
  s_waitcnt lgkmcnt(0)
  s_barrier
  s_cmp_eq_u32 s33, 0
  s_cbranch_scc1 Lo_4
Lob_5:
  ds_read_b128 v[112:115], v238 offset:0
  ds_read_b128 v[116:119], v238 offset:1088
  s_waitcnt lgkmcnt(1)
  buffer_store_dwordx4 v[112:115], v236, s[20:23], s90 offen sc1
  s_waitcnt lgkmcnt(0)
  buffer_store_dwordx4 v[116:119], v236, s[20:23], s91 offen sc1
  v_and_b32 v12, 31, v1
  v_lshlrev_b32 v12, 1, v12
  v_add_u32 v13, s42, v12
  v_sub_u32 v14, s42, v12
  s_cmp_ge_u32 s30, 2
  s_cselect_b64 vcc, -1, 0
  v_cndmask_b32 v12, v13, v14, vcc
  v_cvt_f32_u32 v12, v12
  v_mul_f32 v12, 0x3c800000, v12
  v_lshrrev_b32 v13, 5, v1
  v_lshlrev_b32 v13, 2, v13
  v_cvt_f32_u32 v13, v13
  v_mul_f32 v13, v13, v12
  v_mul_f32 v14, 0x41000000, v12
  s_and_b32 s57, s42, 1
  s_mul_i32 s57, s57, 0x80008000
  v_cos_f32 v168, v13
  v_sin_f32 v169, v13
  v_cos_f32 v114, v14
  v_sin_f32 v115, v14
  v_cos_f32 v112, v12
  v_sin_f32 v113, v12
  v_pk_mul_f32 v[118:119], v[168:169], v[114:115] op_sel:[0,0] op_sel_hi:[1,0]
  v_pk_fma_f32 v[176:177], v[168:169], v[114:115], v[118:119] op_sel:[1,1,0] op_sel_hi:[0,1,1] neg_lo:[1,0,0]
  v_add_f32 v118, v114, v114
  v_add_f32 v122, v112, v112
  v_pk_fma_f32 v[184:185], v[176:177], v[118:119], v[168:169] op_sel_hi:[1,0,1] neg_lo:[0,0,1] neg_hi:[0,0,1]
  v_pk_fma_f32 v[192:193], v[184:185], v[118:119], v[176:177] op_sel_hi:[1,0,1] neg_lo:[0,0,1] neg_hi:[0,0,1]
  v_pk_mul_f32 v[174:175], v[168:169], v[112:113] op_sel:[0,0] op_sel_hi:[1,0]
  v_pk_mul_f32 v[182:183], v[176:177], v[112:113] op_sel:[0,0] op_sel_hi:[1,0]
  v_pk_mul_f32 v[190:191], v[184:185], v[112:113] op_sel:[0,0] op_sel_hi:[1,0]
  v_pk_mul_f32 v[198:199], v[192:193], v[112:113] op_sel:[0,0] op_sel_hi:[1,0]
  v_pk_fma_f32 v[170:171], v[168:169], v[112:113], v[174:175] op_sel:[1,1,0] op_sel_hi:[0,1,1] neg_lo:[1,0,0]
  v_pk_fma_f32 v[178:179], v[176:177], v[112:113], v[182:183] op_sel:[1,1,0] op_sel_hi:[0,1,1] neg_lo:[1,0,0]
  v_pk_fma_f32 v[186:187], v[184:185], v[112:113], v[190:191] op_sel:[1,1,0] op_sel_hi:[0,1,1] neg_lo:[1,0,0]
  v_pk_fma_f32 v[194:195], v[192:193], v[112:113], v[198:199] op_sel:[1,1,0] op_sel_hi:[0,1,1] neg_lo:[1,0,0]
  v_cvt_pk_bf16_f32 v16, v168, v169
  v_cvt_pk_bf16_f32 v20, v176, v177
  v_cvt_pk_bf16_f32 v24, v184, v185
  v_cvt_pk_bf16_f32 v28, v192, v193
  v_pk_fma_f32 v[172:173], v[170:171], v[122:123], v[168:169] op_sel_hi:[1,0,1] neg_lo:[0,0,1] neg_hi:[0,0,1]
  v_pk_fma_f32 v[180:181], v[178:179], v[122:123], v[176:177] op_sel_hi:[1,0,1] neg_lo:[0,0,1] neg_hi:[0,0,1]
  v_pk_fma_f32 v[188:189], v[186:187], v[122:123], v[184:185] op_sel_hi:[1,0,1] neg_lo:[0,0,1] neg_hi:[0,0,1]
  v_pk_fma_f32 v[196:197], v[194:195], v[122:123], v[192:193] op_sel_hi:[1,0,1] neg_lo:[0,0,1] neg_hi:[0,0,1]
  v_cvt_pk_bf16_f32 v17, v170, v171
  v_cvt_pk_bf16_f32 v21, v178, v179
  v_cvt_pk_bf16_f32 v25, v186, v187
  v_cvt_pk_bf16_f32 v29, v194, v195
  v_pk_fma_f32 v[174:175], v[172:173], v[122:123], v[170:171] op_sel_hi:[1,0,1] neg_lo:[0,0,1] neg_hi:[0,0,1]
  v_pk_fma_f32 v[182:183], v[180:181], v[122:123], v[178:179] op_sel_hi:[1,0,1] neg_lo:[0,0,1] neg_hi:[0,0,1]
  v_pk_fma_f32 v[190:191], v[188:189], v[122:123], v[186:187] op_sel_hi:[1,0,1] neg_lo:[0,0,1] neg_hi:[0,0,1]
  v_pk_fma_f32 v[198:199], v[196:197], v[122:123], v[194:195] op_sel_hi:[1,0,1] neg_lo:[0,0,1] neg_hi:[0,0,1]
  v_cvt_pk_bf16_f32 v18, v172, v173
  v_cvt_pk_bf16_f32 v22, v180, v181
  v_cvt_pk_bf16_f32 v26, v188, v189
  v_cvt_pk_bf16_f32 v30, v196, v197
  v_cvt_pk_bf16_f32 v19, v174, v175
  v_cvt_pk_bf16_f32 v23, v182, v183
  v_cvt_pk_bf16_f32 v27, v190, v191
  v_cvt_pk_bf16_f32 v31, v198, v199
  s_cmp_eq_u32 s33, 0
  s_cbranch_scc0 Lc_7
  s_waitcnt vmcnt(0)
  s_barrier
  s_lshl_b32 s55, s35, 6
  s_add_u32 s55, s55, s34
  s_cmp_lg_u32 s30, 0
  s_cbranch_scc1 Lw_8
  s_lshl_b32 s54, s55, 7
  s_add_u32 s54, s54, s46
  v_mov_b32 v14, s31
  v_mov_b32 v15, 0
  s_mov_b64 exec, 1
  buffer_store_dword v14, v15, s[20:23], s54 offen sc1
  s_mov_b64 exec, -1
Lw_8:
  s_cmp_eq_u32 s30, 3
  s_cbranch_scc0 Lc_9
  v_min_u32 v12, 55, v1
  v_lshlrev_b32 v12, 7, v12
  s_mul_i32 s54, s2, 7168
  buffer_load_dword v255, v12, s[16:19], s54 offen
Lc_9:
  s_cmp_lt_u32 s29, 14
  s_cbranch_scc0 Lc_10
  s_cmp_eq_u32 s30, 0
  s_cbranch_scc1 Lw_11
  s_lshr_b32 s54, s29, 3
  s_lshl_b32 s54, s54, 5
  s_add_u32 s51, s36, s54
  s_sub_u32 s53, s37, s54
  s_add_u32 s53, s53, 32
  s_cmp_ge_u32 s30, 2
  s_cselect_b32 s50, s53, s51
  s_and_b32 s52, s30, 1
  v_mov_b32 v4, 0
  v_mov_b32 v5, 0
  v_mov_b32 v6, 0
  v_mov_b32 v7, 0
  v_mov_b32 v8, 0
  v_mov_b32 v9, 0
  v_mov_b32 v10, 0
  v_mov_b32 v11, 0
  v_lshrrev_b32 v12, 3, v1
  v_bfe_u32 v13, v1, 4, 1
  v_lshlrev_b32 v13, 2, v13
  v_and_b32 v14, 7, v1
  v_xor_b32 v13, v13, v14
  v_lshlrev_b32 v12, 10, v12
  v_lshl_add_u32 v12, v13, 4, v12
  s_lshl_b32 s54, s49, 7
  v_add_u32 v254, s54, v12
  s_mul_i32 s81, s30, 8192
  s_mul_i32 s82, s30, 4096
  s_add_u32 s82, s82, 32768
  s_lshl_b32 s83, s30, 11
  s_add_u32 s83, s83, 155648
  s_mul_i32 s84, s30, 458752
  s_add_u32 s56, s30, -1
Lwi_12:
  s_lshl_b32 s55, s56, 13
  s_add_u32 s55, s55, 65536
  s_and_b32 s55, s55, 0x1ffff
  s_xor_b32 s54, s56, s85
  s_mul_i32 s54, s54, 57344
  s_add_u32 m0, s55, 0
  s_mov_b32 s57, s54
  buffer_load_dwordx4 v253, s[8:11], s57 offen offset:0 lds
  s_add_u32 s57, s57, 13312
  buffer_load_dwordx4 v253, s[8:11], s57 offen offset:1024 lds
  s_add_u32 s57, s57, 13312
  buffer_load_dwordx4 v253, s[8:11], s57 offen offset:2048 lds
  s_add_u32 s57, s57, 13312
  buffer_load_dwordx4 v253, s[8:11], s57 offen offset:3072 lds
  s_add_u32 m0, s55, 4096
  s_mov_b32 s57, s54
  buffer_load_dwordx4 v253, s[12:15], s57 offen offset:0 lds
  s_add_u32 s57, s57, 13312
  buffer_load_dwordx4 v253, s[12:15], s57 offen offset:1024 lds
  s_add_u32 s57, s57, 13312
  buffer_load_dwordx4 v253, s[12:15], s57 offen offset:2048 lds
  s_add_u32 s57, s57, 13312
  buffer_load_dwordx4 v253, s[12:15], s57 offen offset:3072 lds
  s_add_u32 s56, s56, 3
  s_cmp_lt_u32 s56, 12
  s_cbranch_scc1 Lwi_12
  s_sub_u32 s56, s30, 1
Lt1_13:
  s_mul_i32 s54, s56, 43
  s_lshr_b32 s54, s54, 8
  s_mul_i32 s54, s54, 409600
  s_lshl_b32 s55, s56, 13
  s_add_u32 s54, s54, s55
  s_lshl_b32 s55, s56, 10
  s_add_u32 m0, s55, 131072
  s_add_u32 s56, s56, 3
  s_cmp_lt_u32 s56, 24
  buffer_load_dwordx4 v254, s[16:19], s54 offen lds
  s_cbranch_scc1 Lt1_13
Lw_11:
Lc_10:
  s_cmp_ge_u32 s29, 14
  s_cbranch_scc0 Lc_14
  s_cmp_eq_u32 s30, 0
  s_cbranch_scc1 Lw_15
  s_lshr_b32 s54, s29, 3
  s_lshl_b32 s54, s54, 5
  s_add_u32 s51, s36, s54
  s_sub_u32 s53, s37, s54
  s_add_u32 s53, s53, 32
  s_cmp_ge_u32 s30, 2
  s_cselect_b32 s50, s53, s51
  s_and_b32 s52, s30, 1
  v_mov_b32 v4, 0
  v_mov_b32 v5, 0
  v_mov_b32 v6, 0
  v_mov_b32 v7, 0
  v_mov_b32 v8, 0
  v_mov_b32 v9, 0
  v_mov_b32 v10, 0
  v_mov_b32 v11, 0
  v_lshrrev_b32 v12, 3, v1
  v_bfe_u32 v13, v1, 4, 1
  v_lshlrev_b32 v13, 2, v13
  v_and_b32 v14, 7, v1
  v_xor_b32 v13, v13, v14
  v_lshlrev_b32 v12, 10, v12
  v_lshl_add_u32 v12, v13, 4, v12
  s_lshl_b32 s54, s49, 7
  v_add_u32 v254, s54, v12
  s_mul_i32 s81, s30, 8192
  s_mul_i32 s82, s30, 4096
  s_add_u32 s82, s82, 32768
  s_lshl_b32 s83, s30, 11
  s_add_u32 s83, s83, 155648
  s_mul_i32 s84, s30, 458752
  s_lshl_b32 s87, s30, 13
  s_add_u32 s87, s87, 65536
  s_mul_i32 s88, s30, 6144
  s_add_u32 s88, s88, 131072
  s_add_u32 m0, s87, 0
  s_add_u32 s54, s84, 0
  buffer_load_dwordx4 v254, s[16:19], s54 offen lds
  s_add_u32 m0, s87, 1024
  s_add_u32 s54, s84, 8192
  buffer_load_dwordx4 v254, s[16:19], s54 offen lds
  s_add_u32 m0, s87, 2048
  s_add_u32 s54, s84, 16384
  buffer_load_dwordx4 v254, s[16:19], s54 offen lds
  s_add_u32 m0, s87, 3072
  s_add_u32 s54, s84, 24576
  buffer_load_dwordx4 v254, s[16:19], s54 offen lds
  s_add_u32 m0, s87, 4096
  s_add_u32 s54, s84, 32768
  buffer_load_dwordx4 v254, s[16:19], s54 offen lds
  s_add_u32 m0, s87, 5120
  s_add_u32 s54, s84, 40960
  buffer_load_dwordx4 v254, s[16:19], s54 offen lds
  s_add_u32 m0, s87, 6144
  s_add_u32 s54, s84, 49152
  buffer_load_dwordx4 v254, s[16:19], s54 offen lds
  s_add_u32 m0, s87, 7168
  s_add_u32 s54, s84, 57344
  buffer_load_dwordx4 v254, s[16:19], s54 offen lds
  s_add_u32 m0, s87, 32768
  s_add_u32 s54, s84, 65536
  buffer_load_dwordx4 v254, s[16:19], s54 offen lds
  s_add_u32 m0, s87, 33792
  s_add_u32 s54, s84, 73728
  buffer_load_dwordx4 v254, s[16:19], s54 offen lds
  s_add_u32 m0, s87, 34816
  s_add_u32 s54, s84, 81920
  buffer_load_dwordx4 v254, s[16:19], s54 offen lds
  s_add_u32 m0, s87, 35840
  s_add_u32 s54, s84, 90112
  buffer_load_dwordx4 v254, s[16:19], s54 offen lds
  s_add_u32 m0, s87, 36864
  s_add_u32 s54, s84, 196608
  buffer_load_dwordx4 v254, s[16:19], s54 offen lds
  s_add_u32 m0, s87, 37888
  s_add_u32 s54, s84, 204800
  buffer_load_dwordx4 v254, s[16:19], s54 offen lds
  s_add_u32 m0, s87, 38912
  s_add_u32 s54, s84, 212992
  buffer_load_dwordx4 v254, s[16:19], s54 offen lds
  s_add_u32 m0, s87, 39936
  s_add_u32 s54, s84, 221184
  buffer_load_dwordx4 v254, s[16:19], s54 offen lds
  s_add_u32 m0, s88, 0
  s_add_u32 s54, s84, 229376
  buffer_load_dwordx4 v254, s[16:19], s54 offen lds
  s_add_u32 m0, s88, 1024
  s_add_u32 s54, s84, 237568
  buffer_load_dwordx4 v254, s[16:19], s54 offen lds
  s_add_u32 m0, s88, 2048
  s_add_u32 s54, s84, 245760
  buffer_load_dwordx4 v254, s[16:19], s54 offen lds
  s_add_u32 m0, s88, 3072
  s_add_u32 s54, s84, 253952
  buffer_load_dwordx4 v254, s[16:19], s54 offen lds
  s_add_u32 m0, s88, 4096
  s_add_u32 s54, s84, 262144
  buffer_load_dwordx4 v254, s[16:19], s54 offen lds
  s_add_u32 m0, s88, 5120
  s_add_u32 s54, s84, 270336
  buffer_load_dwordx4 v254, s[16:19], s54 offen lds
Lw_15:
Lc_14:
Lc_7:
  s_mov_b32 s77, 0
  s_cmp_eq_u32 s33, 0
  s_cbranch_scc0 Lc_16
  s_lshr_b32 s54, s29, 3
  s_lshl_b32 s54, s54, 5
  s_add_u32 s51, s36, s54
  s_sub_u32 s53, s37, s54
  s_add_u32 s53, s53, 32
  s_cmp_ge_u32 s30, 2
  s_cselect_b32 s50, s53, s51
  s_and_b32 s52, s30, 1
  v_mov_b32 v4, 0
  v_mov_b32 v5, 0
  v_mov_b32 v6, 0
  v_mov_b32 v7, 0
  v_mov_b32 v8, 0
  v_mov_b32 v9, 0
  v_mov_b32 v10, 0
  v_mov_b32 v11, 0
  s_cmp_lt_u32 s29, 14
  s_cselect_b32 s77, 1, 0
  s_lshl_b32 s76, s30, 13
  s_add_u32 s76, s76, 65536
  s_xor_b32 s75, s85, 0
  s_add_u32 s75, s75, s30
  s_mul_i32 s75, s75, 57344
  s_xor_b32 s101, s85, 8
  s_add_u32 s101, s101, s30
  s_mul_i32 s101, s101, 57344
  s_xor_b32 s69, s85, 16
  s_add_u32 s69, s69, s30
  s_mul_i32 s69, s69, 57344
  s_xor_b32 s100, s85, 24
  s_add_u32 s100, s100, s30
  s_mul_i32 s100, s100, 57344
  v_lshrrev_b32 v12, 5, v1
  v_bfe_u32 v13, v1, 2, 2
  v_lshl_add_u32 v12, v12, 3, v13
  v_lshlrev_b32 v12, 8, v12
  v_bfe_u32 v14, v1, 4, 1
  v_and_b32 v15, 1, v1
  v_lshl_add_u32 v14, v14, 1, v15
  s_lshl_b32 s54, s30, 2
  v_add_u32 v14, s54, v14
  v_lshlrev_b32 v13, 2, v13
  v_xor_b32 v14, v14, v13
  v_lshl_add_u32 v12, v14, 4, v12
  v_bfe_u32 v15, v1, 1, 1
  v_lshl_add_u32 v12, v15, 3, v12
  v_add_u32 v248, 65536, v12
  v_add_u32 v250, 114688, v12
  v_mov_b32 v252, v12
  v_lshrrev_b32 v12, 4, v1
  v_xor_b32 v12, v12, v1
  v_and_b32 v12, 1, v12
  v_cmp_eq_u32 vcc, 0, v12
  v_mov_b32 v13, 0x3f803f80
  s_nop 0
  v_cndmask_b32 v240, 0, v13, vcc
  v_mov_b32 v241, v240
  v_mov_b32 v242, v240
  v_mov_b32 v243, v240
  v_lshrrev_b32 v12, 3, v1
  v_bfe_u32 v13, v1, 4, 1
  v_lshlrev_b32 v13, 2, v13
  v_and_b32 v14, 7, v1
  v_xor_b32 v13, v13, v14
  v_lshlrev_b32 v12, 10, v12
  v_lshl_add_u32 v12, v13, 4, v12
  s_lshl_b32 s54, s49, 7
  v_add_u32 v254, s54, v12
  s_mul_i32 s81, s30, 8192
  s_mul_i32 s82, s30, 4096
  s_add_u32 s82, s82, 32768
  s_lshl_b32 s83, s30, 11
  s_add_u32 s83, s83, 155648
  s_mul_i32 s84, s30, 458752
  s_lshl_b32 s87, s30, 13
  s_add_u32 s87, s87, 65536
  s_mul_i32 s88, s30, 6144
  s_add_u32 s88, s88, 131072
  v_lshrrev_b32 v12, 5, v1
  v_bfe_u32 v13, v1, 2, 2
  v_lshl_add_u32 v12, v12, 3, v13
  v_lshlrev_b32 v12, 7, v12
  v_bfe_u32 v14, v1, 4, 1
  v_and_b32 v15, 1, v1
  v_lshl_add_u32 v14, v14, 1, v15
  v_bfe_u32 v13, v1, 3, 1
  v_xor_b32 v13, s52, v13
  v_lshl_add_u32 v14, v13, 2, v14
  v_lshl_add_u32 v12, v14, 4, v12
  v_bfe_u32 v15, v1, 1, 1
  v_lshl_add_u32 v12, v15, 3, v12
  v_xor_b32 v13, 64, v12
  v_add_u32 v249, s88, v12
  v_add_u32 v251, s88, v13
Lc_16:
  s_and_b32 s57, s42, 1
  s_mul_i32 s57, s57, 0x80008000
  v_xor_b32 v32, s57, v16
  v_xor_b32 v33, s57, v17
  v_xor_b32 v34, s57, v18
  v_xor_b32 v35, s57, v19
  v_xor_b32 v36, s57, v20
  v_xor_b32 v37, s57, v21
  v_xor_b32 v38, s57, v22
  v_xor_b32 v39, s57, v23
  v_xor_b32 v40, s57, v24
  v_xor_b32 v41, s57, v25
  v_xor_b32 v42, s57, v26
  v_xor_b32 v43, s57, v27
  v_xor_b32 v44, s57, v28
  v_xor_b32 v45, s57, v29
  v_xor_b32 v46, s57, v30
  v_xor_b32 v47, s57, v31
  v_lshlrev_b32 v96, 16, v200
  v_and_b32 v97, 0xffff0000, v200
  v_lshlrev_b32 v98, 16, v201
  v_and_b32 v99, 0xffff0000, v201
  v_lshlrev_b32 v100, 16, v202
  v_and_b32 v101, 0xffff0000, v202
  v_lshlrev_b32 v102, 16, v203
  v_and_b32 v103, 0xffff0000, v203
  v_lshlrev_b32 v104, 16, v204
  v_and_b32 v105, 0xffff0000, v204
  v_lshlrev_b32 v106, 16, v205
  v_and_b32 v107, 0xffff0000, v205
  v_lshlrev_b32 v108, 16, v206
  v_and_b32 v109, 0xffff0000, v206
  v_lshlrev_b32 v110, 16, v207
  v_and_b32 v111, 0xffff0000, v207
  v_mov_b32 v121, v96
  s_cmp_ge_u32 s30, 2
  s_cselect_b64 vcc, -1, 0
  v_and_b32 v12, 19, v1
  v_bfe_u32 v13, v1, 2, 1
  v_lshl_add_u32 v12, v13, 3, v12
  v_bfe_u32 v13, v1, 3, 1
  v_lshl_add_u32 v12, v13, 2, v12
  v_sub_u32 v13, 32, v12
  v_cndmask_b32 v12, v12, v13, vcc
  v_lshrrev_b32 v13, 5, v1
  v_lshlrev_b32 v13, 10, v13
  v_lshl_add_u32 v12, v12, 2, v13
  v_add_u32 v120, 45056, v12
  s_cmp_eq_u32 s41, 0
  s_cselect_b32 s64, -1, 0
  s_mov_b32 s65, 0
  s_cmp_eq_u32 s33, 0
  s_cbranch_scc0 Lc_17
  s_cmp_lg_u32 s30, 0
  s_cbranch_scc1 Lw_18
  s_mov_b32 s47, 40000
Lh_19:
  v_cmp_ne_u32 vcc, s31, v134
  s_cbranch_vccz Lhd_20
  v_and_b32 v234, 15, v1
  v_lshlrev_b32 v234, 7, v234
  s_lshl_b32 s95, s28, 11
  s_add_u32 s95, s95, 4096
  buffer_load_dwordx2 v[134:135], v234, s[20:23], s95 offen sc1
  s_waitcnt vmcnt(0)
  s_sub_u32 s47, s47, 1
  s_cbranch_scc0 Lh_19
Lhd_20:
  v_cmp_ne_u32 s[62:63], s48, v135
  s_nop 0
  s_or_b64 vcc, vcc, s[62:63]
  s_cmp_eq_u64 vcc, 0
  s_cselect_b32 s54, 1, 0
  v_mov_b32 v14, s54
  v_mov_b32 v15, 157184
  ds_write_b32 v15, v14
  s_waitcnt lgkmcnt(0)
  s_lshr_b32 s54, s39, 1
  s_add_u32 s55, s39, 1
  s_lshr_b32 s55, s55, 1
  s_and_b32 s55, s55, 3
  s_lshl_b32 s54, s54, 13
  s_lshl_b32 s55, s55, 13
  v_lshlrev_b32 v12, 7, v1
  v_add_u32 v13, s55, v12
  v_add_u32 v12, s54, v12
  s_mov_b32 s47, 40000
Lp_21:
  buffer_load_dword v130, v12, s[20:23], s46 offen sc1
  buffer_load_dword v131, v13, s[20:23], s46 offen sc1
  s_waitcnt vmcnt(0)
  v_subrev_u32 v14, s31, v130
  v_subrev_u32 v15, s31, v131
  v_max_u32 v14, v14, v15
  v_cmp_lt_u32 vcc, 1, v14
  s_cbranch_vccz Ld_22
  s_sub_u32 s47, s47, 1
  s_cbranch_scc0 Lp_21
Ld_22:
  v_and_b32 v12, 15, v1
  s_lshl_b32 s54, s39, 7
  v_lshl_add_u32 v12, v12, 4, s54
  v_and_b32 v12, 0x3ff, v12
  v_lshrrev_b32 v13, 4, v1
  v_lshl_add_u32 v12, v13, 10, v12
  s_lshl_b32 s54, s38, 16
  s_add_u32 s54, s54, s43
  s_mov_b32 m0, 45056
  s_nop 0
  buffer_load_dwordx4 v12, s[20:23], s54 offen offset:0 sc1 lds
  s_add_u32 s54, s54, 3072
  buffer_load_dwordx4 v12, s[20:23], s54 offen offset:1024 sc1 lds
  s_add_u32 s54, s54, 3072
  buffer_load_dwordx4 v12, s[20:23], s54 offen offset:2048 sc1 lds
  s_add_u32 s54, s54, 3072
  buffer_load_dwordx4 v12, s[20:23], s54 offen offset:3072 sc1 lds
  s_add_u32 s54, s54, 7168
  s_mov_b32 m0, 49152
  s_nop 0
  buffer_load_dwordx4 v12, s[20:23], s54 offen offset:0 sc1 lds
  s_add_u32 s54, s54, 3072
  buffer_load_dwordx4 v12, s[20:23], s54 offen offset:1024 sc1 lds
  s_add_u32 s54, s54, 3072
  buffer_load_dwordx4 v12, s[20:23], s54 offen offset:2048 sc1 lds
  s_add_u32 s54, s54, 3072
  buffer_load_dwordx4 v12, s[20:23], s54 offen offset:3072 sc1 lds
  s_add_u32 s54, s54, 7168
  s_mov_b32 m0, 53248
  s_nop 0
  buffer_load_dwordx4 v12, s[20:23], s54 offen offset:0 sc1 lds
  s_add_u32 s54, s54, 3072
  buffer_load_dwordx4 v12, s[20:23], s54 offen offset:1024 sc1 lds
  s_add_u32 s54, s54, 3072
  buffer_load_dwordx4 v12, s[20:23], s54 offen offset:2048 sc1 lds
  s_add_u32 s54, s54, 3072
  buffer_load_dwordx4 v12, s[20:23], s54 offen offset:3072 sc1 lds
  s_add_u32 s54, s54, 7168
  s_mov_b32 m0, 57344
  s_nop 0
  buffer_load_dwordx4 v12, s[20:23], s54 offen offset:0 sc1 lds
  s_add_u32 s54, s54, 3072
  buffer_load_dwordx4 v12, s[20:23], s54 offen offset:1024 sc1 lds
  s_add_u32 s54, s54, 3072
  buffer_load_dwordx4 v12, s[20:23], s54 offen offset:2048 sc1 lds
  s_add_u32 s54, s54, 3072
  buffer_load_dwordx4 v12, s[20:23], s54 offen offset:3072 sc1 lds
Lw_18:
  s_cmp_lt_u32 s29, 14
  s_cbranch_scc0 Lc_23
  s_cmp_eq_u32 s30, 0
  s_cbranch_scc1 Lw_24
  s_waitcnt vmcnt(0)
Lw_24:
  s_barrier
  ds_read_b64_tr_b16 a[0:1], v248 offset:0
  ds_read_b64_tr_b16 a[2:3], v248 offset:1024
  ds_read_b64_tr_b16 a[4:5], v248 offset:4096
  ds_read_b64_tr_b16 a[6:7], v248 offset:5120
  ds_read_b64_tr_b16 a[8:9], v248 offset:8192
  ds_read_b64_tr_b16 a[10:11], v248 offset:9216
  ds_read_b64_tr_b16 a[12:13], v248 offset:12288
  ds_read_b64_tr_b16 a[14:15], v248 offset:13312
  ds_read_b64_tr_b16 a[16:17], v248 offset:16384
  ds_read_b64_tr_b16 a[18:19], v248 offset:17408
  ds_read_b64_tr_b16 a[20:21], v248 offset:20480
  ds_read_b64_tr_b16 a[22:23], v248 offset:21504
  ds_read_b64_tr_b16 a[24:25], v248 offset:24576
  ds_read_b64_tr_b16 a[26:27], v248 offset:25600
  ds_read_b64_tr_b16 a[28:29], v248 offset:28672
  ds_read_b64_tr_b16 a[30:31], v248 offset:29696
  ds_read_b64_tr_b16 a[32:33], v248 offset:32768
  ds_read_b64_tr_b16 a[34:35], v248 offset:33792
  ds_read_b64_tr_b16 a[36:37], v248 offset:36864
  ds_read_b64_tr_b16 a[38:39], v248 offset:37888
  ds_read_b64_tr_b16 a[40:41], v248 offset:40960
  ds_read_b64_tr_b16 a[42:43], v248 offset:41984
  ds_read_b64_tr_b16 a[44:45], v248 offset:45056
  ds_read_b64_tr_b16 a[46:47], v248 offset:46080
  ds_read_b64_tr_b16 a[48:49], v250 offset:0
  ds_read_b64_tr_b16 a[50:51], v250 offset:1024
  ds_read_b64_tr_b16 a[52:53], v250 offset:4096
  ds_read_b64_tr_b16 a[54:55], v250 offset:5120
  ds_read_b64_tr_b16 a[56:57], v250 offset:8192
  ds_read_b64_tr_b16 a[58:59], v250 offset:9216
  ds_read_b64_tr_b16 a[60:61], v250 offset:12288
  ds_read_b64_tr_b16 a[62:63], v250 offset:13312
  ds_read_b64_tr_b16 a[64:65], v252 offset:0
  ds_read_b64_tr_b16 a[66:67], v252 offset:1024
  ds_read_b64_tr_b16 a[68:69], v252 offset:4096
  ds_read_b64_tr_b16 a[70:71], v252 offset:5120
  ds_read_b64_tr_b16 a[72:73], v252 offset:8192
  ds_read_b64_tr_b16 a[74:75], v252 offset:9216
  ds_read_b64_tr_b16 a[76:77], v252 offset:12288
  ds_read_b64_tr_b16 a[78:79], v252 offset:13312
  ds_read_b64_tr_b16 a[80:81], v252 offset:16384
  ds_read_b64_tr_b16 a[82:83], v252 offset:17408
  ds_read_b64_tr_b16 a[84:85], v252 offset:20480
  ds_read_b64_tr_b16 a[86:87], v252 offset:21504
  ds_read_b64_tr_b16 a[88:89], v252 offset:24576
  ds_read_b64_tr_b16 a[90:91], v252 offset:25600
  ds_read_b64_tr_b16 a[92:93], v252 offset:28672
  ds_read_b64_tr_b16 a[94:95], v252 offset:29696
  ds_read_b64_tr_b16 v[200:201], v249 offset:0
  ds_read_b64_tr_b16 v[202:203], v249 offset:512
  ds_read_b64_tr_b16 v[204:205], v251 offset:0
  ds_read_b64_tr_b16 v[206:207], v251 offset:512
  ds_read_b64_tr_b16 v[208:209], v249 offset:2048
  ds_read_b64_tr_b16 v[210:211], v249 offset:2560
  ds_read_b64_tr_b16 v[212:213], v251 offset:2048
  ds_read_b64_tr_b16 v[214:215], v251 offset:2560
  ds_read_b64_tr_b16 v[216:217], v249 offset:4096
  ds_read_b64_tr_b16 v[218:219], v249 offset:4608
  ds_read_b64_tr_b16 v[220:221], v251 offset:4096
  ds_read_b64_tr_b16 v[222:223], v251 offset:4608
Lc_23:
  s_cmp_lg_u32 s30, 0
  s_cbranch_scc1 Lw_25
  s_waitcnt vmcnt(0)
Lw_25:
Lc_17:
  s_cmp_lg_u32 s33, 0
  s_cbranch_scc0 Lc_26
  s_mov_b32 s47, 40000
  buffer_load_dwordx4 v[136:139], v228, s[20:23], s92 offen sc1
  buffer_load_dwordx4 v[140:143], v229, s[20:23], s92 offen sc1
  buffer_load_dwordx4 v[144:147], v230, s[20:23], s92 offen sc1
Lz_27:
  s_waitcnt vmcnt(0)
  v_max3_u32 v12, v136, v137, v138
  v_max3_u32 v12, v12, v139, v140
  v_max3_u32 v12, v12, v141, v142
  v_max3_u32 v12, v12, v143, v144
  v_max3_u32 v12, v12, v145, v146
  v_max_u32 v12, v12, v147
  v_cmp_eq_u32 vcc, -1, v12
  s_cbranch_vccz Lzd_28
  buffer_load_dwordx4 v[136:139], v228, s[20:23], s92 offen sc1
  buffer_load_dwordx4 v[140:143], v229, s[20:23], s92 offen sc1
  buffer_load_dwordx4 v[144:147], v230, s[20:23], s92 offen sc1
  s_sub_u32 s47, s47, 1
  s_cbranch_scc0 Lz_27
  s_waitcnt vmcnt(0)
Lzd_28:
  ds_write_b128 v231, v[136:139]
  ds_write_b128 v232, v[140:143]
  ds_write_b128 v233, v[144:147]
Lc_26:
  s_waitcnt lgkmcnt(0)
  s_barrier
  ds_read2st64_b32 v[48:49], v120 offset0:0 offset1:1
  ds_read2st64_b32 v[50:51], v120 offset0:2 offset1:3
  ds_read2st64_b32 v[52:53], v120 offset0:8 offset1:9
  ds_read2st64_b32 v[54:55], v120 offset0:10 offset1:11
  ds_read2st64_b32 v[56:57], v120 offset0:16 offset1:17
  ds_read2st64_b32 v[58:59], v120 offset0:18 offset1:19
  ds_read2st64_b32 v[60:61], v120 offset0:24 offset1:25
  ds_read2st64_b32 v[62:63], v120 offset0:26 offset1:27
  ds_read2st64_b32 v[64:65], v120 offset0:32 offset1:33
  ds_read2st64_b32 v[66:67], v120 offset0:34 offset1:35
  ds_read2st64_b32 v[68:69], v120 offset0:40 offset1:41
  ds_read2st64_b32 v[70:71], v120 offset0:42 offset1:43
  ds_read2st64_b32 v[72:73], v120 offset0:48 offset1:49
  ds_read2st64_b32 v[74:75], v120 offset0:50 offset1:51
  ds_read2st64_b32 v[76:77], v120 offset0:56 offset1:57
  ds_read2st64_b32 v[78:79], v120 offset0:58 offset1:59
  s_cmp_eq_u32 s77, 1
  s_cbranch_scc1 Lo_30
Lob_31:
  s_waitcnt lgkmcnt(14)
  v_mfma_f32_32x32x16_bf16 v[96:111], v[48:51], v[16:19], v[96:111]
  s_waitcnt lgkmcnt(12)
  v_mfma_f32_32x32x16_bf16 v[96:111], v[52:55], v[20:23], v[96:111]
  s_waitcnt lgkmcnt(10)
  v_mfma_f32_32x32x16_bf16 v[96:111], v[56:59], v[24:27], v[96:111]
  s_waitcnt lgkmcnt(8)
  v_mfma_f32_32x32x16_bf16 v[96:111], v[60:63], v[28:31], v[96:111]
  s_waitcnt lgkmcnt(6)
  v_mfma_f32_32x32x16_bf16 v[96:111], v[64:67], v[32:35], v[96:111]
  s_waitcnt lgkmcnt(4)
  v_mfma_f32_32x32x16_bf16 v[96:111], v[68:71], v[36:39], v[96:111]
  s_waitcnt lgkmcnt(2)
  v_mfma_f32_32x32x16_bf16 v[96:111], v[72:75], v[40:43], v[96:111]
  s_waitcnt lgkmcnt(0)
  v_mfma_f32_32x32x16_bf16 v[96:111], v[76:79], v[44:47], v[96:111]
Lm_29:
  s_cmp_eq_u32 s33, 0
  s_cbranch_scc0 Lc_32
  v_mov_b32 v12, 157184
  ds_read_b32 v13, v12
  s_waitcnt lgkmcnt(0)
  v_readfirstlane_b32 s32, v13
Lc_32:
  s_nop 0
  s_mov_b32 s89, s32
  s_lshl_b32 s56, s40, 4
  s_add_u32 s56, s56, s41
  s_lshl_b32 s55, s56, 11
  s_add_u32 s55, s55, s44
  s_lshl_b32 s56, s56, 8
  s_add_u32 s56, s56, s74
  s_nop 1
  v_cndmask_b32 v96, v96, v121, s[64:65]
  v_cvt_pk_bf16_f32 v48, v96, v97
  v_cvt_pk_bf16_f32 v49, v98, v99
  v_cvt_pk_bf16_f32 v50, v100, v101
  v_cvt_pk_bf16_f32 v51, v102, v103
  s_cmp_eq_u32 s89, 0
  s_cbranch_scc1 Ls_33
  buffer_store_dwordx4 v[48:51], v2, s[20:23], s55 offen nt
Lb_34:
  v_cvt_pk_bf16_f32 v52, v104, v105
  v_cvt_pk_bf16_f32 v53, v106, v107
  v_cvt_pk_bf16_f32 v54, v108, v109
  v_cvt_pk_bf16_f32 v55, v110, v111
  s_cmp_eq_u32 s89, 0
  s_cbranch_scc1 Ls_35
  buffer_store_dwordx4 v[52:55], v2, s[20:23], s55 offen offset:1024 nt
Lb_36:
  v_pk_add_f32 v[56:57], v[96:97], v[98:99]
  v_pk_mul_f32 v[58:59], v[96:97], v[96:97]
  v_pk_fma_f32 v[58:59], v[98:99], v[98:99], v[58:59]
  v_pk_add_f32 v[56:57], v[56:57], v[100:101]
  v_pk_fma_f32 v[58:59], v[100:101], v[100:101], v[58:59]
  v_pk_add_f32 v[56:57], v[56:57], v[102:103]
  v_pk_fma_f32 v[58:59], v[102:103], v[102:103], v[58:59]
  v_pk_add_f32 v[56:57], v[56:57], v[104:105]
  v_pk_fma_f32 v[58:59], v[104:105], v[104:105], v[58:59]
  v_pk_add_f32 v[56:57], v[56:57], v[106:107]
  v_pk_fma_f32 v[58:59], v[106:107], v[106:107], v[58:59]
  v_pk_add_f32 v[56:57], v[56:57], v[108:109]
  v_pk_fma_f32 v[58:59], v[108:109], v[108:109], v[58:59]
  v_pk_add_f32 v[56:57], v[56:57], v[110:111]
  v_pk_fma_f32 v[58:59], v[110:111], v[110:111], v[58:59]
  v_add_f32 v56, v56, v57
  v_add_f32 v58, v58, v59
  v_lshlrev_b32 v13, 2, v1
  s_nop 0
  v_permlane32_swap_b32 v56, v58
  v_add_f32 v56, v56, v58
  s_cmp_eq_u32 s89, 0
  s_cbranch_scc1 Ls_37
  buffer_store_dword v56, v13, s[20:23], s56 offen
Lb_38:
  s_lshl_b32 s54, s28, 4
  s_add_u32 s54, s54, s29
  s_lshl_b32 s54, s54, 5
  s_add_u32 s54, s54, s30
  s_lshl_b32 s54, s54, 2
  v_mov_b32 v14, s31
  v_mov_b32 v15, 98304
  s_waitcnt vmcnt(0)
  s_mov_b64 exec, 1
  s_cmp_eq_u32 s89, 0
  s_cbranch_scc1 Ls_39
  buffer_store_dword v14, v15, s[20:23], s54 offen
Lb_40:
  s_mov_b64 exec, -1
  v_lshrrev_b32 v12, 3, v1
  v_bfe_u32 v13, v1, 4, 1
  v_lshlrev_b32 v13, 2, v13
  v_and_b32 v14, 7, v1
  v_xor_b32 v13, v13, v14
  v_lshlrev_b32 v12, 10, v12
  v_lshl_add_u32 v12, v13, 4, v12
  s_lshl_b32 s54, s49, 7
  v_add_u32 v254, s54, v12
  s_mul_i32 s81, s30, 8192
  s_mul_i32 s82, s30, 4096
  s_add_u32 s82, s82, 32768
  s_lshl_b32 s83, s30, 11
  s_add_u32 s83, s83, 155648
  s_mul_i32 s84, s30, 458752
  s_lshl_b32 s87, s30, 13
  s_add_u32 s87, s87, 65536
  s_mul_i32 s88, s30, 6144
  s_add_u32 s88, s88, 131072
  s_cmp_ge_u32 s30, 2
  s_cselect_b32 s54, s37, s36
  s_and_b32 s55, s30, 1
  s_lshl_b32 s55, s55, 5
  s_add_u32 s54, s54, s55
  s_lshl_b32 s79, s54, 15
  s_add_u32 s79, s79, s44
  s_add_u32 s96, s79, 8192
  s_xor_b32 s79, s79, s86
  s_xor_b32 s96, s96, s86
  s_lshl_b32 s59, s54, 12
  s_add_u32 s59, s59, s74
  s_lshr_b32 s57, s30, 1
  s_lshl_b32 s57, s57, 20
  s_and_b32 s58, s30, 1
  s_lshl_b32 s58, s58, 13
  s_add_u32 s57, s57, s58
  s_add_u32 s57, s57, s44
  s_add_u32 s57, s57, 16384
  s_xor_b32 s57, s57, s86
  s_lshl_b32 s97, s36, 15
  s_add_u32 s97, s97, s57
  s_lshl_b32 s98, s37, 15
  s_add_u32 s98, s98, s57
  s_lshl_b32 s57, s29, 2
  s_add_u32 s57, s57, s30
  s_lshl_b32 s57, s57, 11
  s_add_u32 s57, s57, s45
  s_add_u32 s62, s36, 0
  s_mul_i32 s62, s62, 114688
  s_add_u32 s62, s62, s57
  s_add_u32 s63, s36, 32
  s_mul_i32 s63, s63, 114688
  s_add_u32 s63, s63, s57
  s_add_u32 s64, s37, 0
  s_mul_i32 s64, s64, 114688
  s_add_u32 s64, s64, s57
  s_add_u32 s65, s37, 32
  s_mul_i32 s65, s65, 114688
  s_add_u32 s65, s65, s57
  s_lshl_b32 s80, s28, 4
  s_add_u32 s80, s80, s29
  s_lshl_b32 s80, s80, 5
  s_add_u32 s80, s80, s30
  s_lshl_b32 s80, s80, 2
  s_add_u32 s80, s80, 131072
  s_lshl_b32 s99, s50, 15
  s_add_u32 s99, s99, s44
  s_lshl_b32 s55, s49, 1
  s_add_u32 s55, s55, s52
  s_lshl_b32 s55, s55, 11
  s_add_u32 s99, s99, s55
  s_cmp_eq_u32 s77, 1
  s_cbranch_scc1 Lo_41
Lob_42:
  v_lshrrev_b32 v12, 2, v1
  v_lshlrev_b32 v12, 7, v12
  v_and_b32 v15, 3, v1
  v_lshl_add_u32 v12, v15, 2, v12
  s_lshl_b32 s55, s28, 11
  s_add_u32 s55, s55, 98304
  s_mov_b32 s47, 40000
Lp_43:
  buffer_load_dword v130, v12, s[20:23], s55 offen sc1
  s_waitcnt vmcnt(0)
  v_subrev_u32 v14, s31, v130
  v_cmp_lt_u32 vcc, 1, v14
  s_cbranch_vccz Ld_44
  s_sub_u32 s47, s47, 1
  s_cbranch_scc0 Lp_43
Ld_44:
  s_cmp_lt_u32 s29, 14
  s_cbranch_scc0 Lc_45
  s_add_u32 m0, s81, 0
  s_add_u32 s58, s79, 0
  buffer_load_dwordx4 v2, s[20:23], s58 offen offset:0 sc1 lds
  buffer_load_dwordx4 v2, s[20:23], s58 offen offset:1024 sc1 lds
  buffer_load_dwordx4 v2, s[20:23], s58 offen offset:2048 sc1 lds
  buffer_load_dwordx4 v2, s[20:23], s58 offen offset:3072 sc1 lds
  s_add_u32 m0, s81, 4096
  s_add_u32 s58, s79, 4096
  buffer_load_dwordx4 v2, s[20:23], s58 offen offset:0 sc1 lds
  buffer_load_dwordx4 v2, s[20:23], s58 offen offset:1024 sc1 lds
  buffer_load_dwordx4 v2, s[20:23], s58 offen offset:2048 sc1 lds
  buffer_load_dwordx4 v2, s[20:23], s58 offen offset:3072 sc1 lds
Lc_45:
  s_cmp_eq_u32 s77, 1
  s_cbranch_scc1 Lo_46
Lob_47:
  s_waitcnt vmcnt(0)
  s_barrier
  s_cmp_lt_u32 s29, 14
  s_cbranch_scc0 Lc_48
  s_cmp_lg_u32 s33, 0
  s_cbranch_scc1 L_b1l1
  v_lshlrev_b32 v198, 2, v1
  v_add_u32 v198, 159744, v198
  s_lshl_b32 s54, s30, 10
  s_add_u32 s54, s54, 159744
  v_add_u32 v199, s54, v2
  ds_read_b128 v[144:147], v2 offset:0
  ds_read_b128 v[148:151], v2 offset:1024
  ds_read_b128 v[152:155], v2 offset:2048
  ds_read_b128 v[156:159], v2 offset:3072
  v_lshrrev_b32 v14, 4, v1
  v_lshlrev_b32 v14, 16, v14
  v_and_b32 v15, 15, v1
  v_lshl_add_u32 v14, v15, 4, v14
  s_lshl_b32 s55, s34, 10
  s_lshl_b32 s56, s35, 8
  s_add_u32 s55, s55, s56
  s_lshl_b32 s56, s30, 19
  s_add_u32 s55, s55, s56
  v_mov_b32 v252, v14
  s_add_u32 s90, s55, 3145728
  s_add_u32 s91, s55, 3407872
  v_mov_b32 v244, -1
  v_mov_b32 v245, -1
  v_mov_b32 v246, -1
  v_mov_b32 v247, -1
  s_waitcnt lgkmcnt(3)
  v_mfma_f32_32x32x16_bf16 v[16:31], a[0:3], v[144:147], 0
  ds_read_b128 v[160:163], v2 offset:4096
  v_mfma_f32_32x32x16_bf16 v[32:47], a[4:7], v[144:147], 0
  buffer_load_dwordx4 v[164:167], v2, s[20:23], s59 offen offset:0 sc1
  s_waitcnt lgkmcnt(3)
  v_mfma_f32_32x32x16_bf16 v[16:31], a[8:11], v[148:151], v[16:31]
  ds_read_b128 v[144:147], v2 offset:5120
  buffer_load_dwordx4 v[168:171], v2, s[20:23], s59 offen offset:1024 sc1
  v_mfma_f32_32x32x16_bf16 v[32:47], a[12:15], v[148:151], v[32:47]
  buffer_load_dwordx4 v[172:175], v2, s[20:23], s59 offen offset:2048 sc1
  s_waitcnt lgkmcnt(3)
  v_mfma_f32_32x32x16_bf16 v[16:31], a[16:19], v[152:155], v[16:31]
  ds_read_b128 v[148:151], v2 offset:6144
  buffer_load_dwordx4 v[176:179], v2, s[20:23], s59 offen offset:3072 sc1
  v_mfma_f32_32x32x16_bf16 v[32:47], a[20:23], v[152:155], v[32:47]
  s_add_u32 m0, s76, 0
  s_add_u32 s54, s69, 0
  buffer_load_dwordx4 v253, s[8:11], s54 offen lds
  s_waitcnt lgkmcnt(3)
  v_mfma_f32_32x32x16_bf16 v[16:31], a[24:27], v[156:159], v[16:31]
  ds_read_b128 v[152:155], v2 offset:7168
  s_add_u32 m0, s76, 1024
  s_add_u32 s54, s69, 14336
  buffer_load_dwordx4 v253, s[8:11], s54 offen lds
  v_mfma_f32_32x32x16_bf16 v[32:47], a[28:31], v[156:159], v[32:47]
  s_add_u32 m0, s76, 2048
  s_add_u32 s54, s69, 28672
  buffer_load_dwordx4 v253, s[8:11], s54 offen lds
  s_waitcnt lgkmcnt(3)
  v_mfma_f32_32x32x16_bf16 v[16:31], a[32:35], v[160:163], v[16:31]
  ds_read_b128 v[156:159], v2 offset:8192
  s_add_u32 m0, s76, 3072
  s_add_u32 s54, s69, 43008
  buffer_load_dwordx4 v253, s[8:11], s54 offen lds
  v_mfma_f32_32x32x16_bf16 v[32:47], a[36:39], v[160:163], v[32:47]
  s_add_u32 m0, s76, 4096
  s_add_u32 s54, s69, 0
  buffer_load_dwordx4 v253, s[12:15], s54 offen lds
  s_waitcnt lgkmcnt(3)
  v_mfma_f32_32x32x16_bf16 v[16:31], a[40:43], v[144:147], v[16:31]
  ds_read_b128 v[160:163], v2 offset:9216
  s_add_u32 m0, s76, 5120
  s_add_u32 s54, s69, 14336
  buffer_load_dwordx4 v253, s[12:15], s54 offen lds
  v_mfma_f32_32x32x16_bf16 v[32:47], a[44:47], v[144:147], v[32:47]
  s_waitcnt lgkmcnt(3)
  v_mfma_f32_32x32x16_bf16 v[16:31], a[48:51], v[148:151], v[16:31]
  ds_read_b128 v[144:147], v2 offset:10240
  s_add_u32 m0, s76, 6144
  s_add_u32 s54, s69, 28672
  buffer_load_dwordx4 v253, s[12:15], s54 offen lds
  v_mfma_f32_32x32x16_bf16 v[32:47], a[52:55], v[148:151], v[32:47]
  s_waitcnt lgkmcnt(3)
  v_mfma_f32_32x32x16_bf16 v[16:31], a[56:59], v[152:155], v[16:31]
  ds_read_b128 v[148:151], v2 offset:11264
  s_add_u32 m0, s76, 7168
  s_add_u32 s54, s69, 43008
  buffer_load_dwordx4 v253, s[12:15], s54 offen lds
  v_mfma_f32_32x32x16_bf16 v[32:47], a[60:63], v[152:155], v[32:47]
  s_waitcnt lgkmcnt(3)
  v_mfma_f32_32x32x16_bf16 v[48:63], a[0:3], v[156:159], 0
  ds_read_b128 v[152:155], v2 offset:12288
  s_add_u32 m0, s76, 32768
  s_add_u32 s54, s69, 229376
  buffer_load_dwordx4 v253, s[8:11], s54 offen lds
  v_mfma_f32_32x32x16_bf16 v[64:79], a[4:7], v[156:159], 0
  s_waitcnt lgkmcnt(3)
  v_mfma_f32_32x32x16_bf16 v[48:63], a[8:11], v[160:163], v[48:63]
  ds_read_b128 v[156:159], v2 offset:13312
  s_add_u32 m0, s76, 33792
  s_add_u32 s54, s69, 243712
  buffer_load_dwordx4 v253, s[8:11], s54 offen lds
  v_mfma_f32_32x32x16_bf16 v[64:79], a[12:15], v[160:163], v[64:79]
  s_waitcnt lgkmcnt(3)
  v_mfma_f32_32x32x16_bf16 v[48:63], a[16:19], v[144:147], v[48:63]
  ds_read_b128 v[160:163], v2 offset:14336
  s_add_u32 m0, s81, 32768
  s_add_u32 s58, s96, 0
  buffer_load_dwordx4 v2, s[20:23], s58 offen sc1 lds
  v_mfma_f32_32x32x16_bf16 v[64:79], a[20:23], v[144:147], v[64:79]
  s_waitcnt lgkmcnt(3)
  v_mfma_f32_32x32x16_bf16 v[48:63], a[24:27], v[148:151], v[48:63]
  ds_read_b128 v[144:147], v2 offset:15360
  s_add_u32 m0, s76, 34816
  s_add_u32 s54, s69, 258048
  buffer_load_dwordx4 v253, s[8:11], s54 offen lds
  v_mfma_f32_32x32x16_bf16 v[64:79], a[28:31], v[148:151], v[64:79]
  s_waitcnt lgkmcnt(3)
  v_mfma_f32_32x32x16_bf16 v[48:63], a[32:35], v[152:155], v[48:63]
  ds_read_b128 v[148:151], v2 offset:16384
  s_add_u32 m0, s81, 33792
  s_add_u32 s58, s96, 1024
  buffer_load_dwordx4 v2, s[20:23], s58 offen sc1 lds
  v_mfma_f32_32x32x16_bf16 v[64:79], a[36:39], v[152:155], v[64:79]
  s_waitcnt lgkmcnt(3)
  v_mfma_f32_32x32x16_bf16 v[48:63], a[40:43], v[156:159], v[48:63]
  ds_read_b128 v[152:155], v2 offset:17408
  s_add_u32 m0, s76, 35840
  s_add_u32 s54, s69, 272384
  buffer_load_dwordx4 v253, s[8:11], s54 offen lds
  v_mfma_f32_32x32x16_bf16 v[64:79], a[44:47], v[156:159], v[64:79]
  s_waitcnt lgkmcnt(3)
  v_mfma_f32_32x32x16_bf16 v[48:63], a[48:51], v[160:163], v[48:63]
  ds_read_b128 v[156:159], v2 offset:18432
  s_add_u32 m0, s81, 34816
  s_add_u32 s58, s96, 2048
  buffer_load_dwordx4 v2, s[20:23], s58 offen sc1 lds
  v_mfma_f32_32x32x16_bf16 v[64:79], a[52:55], v[160:163], v[64:79]
  s_waitcnt lgkmcnt(3)
  v_mfma_f32_32x32x16_bf16 v[48:63], a[56:59], v[144:147], v[48:63]
  ds_read_b128 v[160:163], v2 offset:19456
  s_add_u32 m0, s76, 36864
  s_add_u32 s54, s69, 229376
  buffer_load_dwordx4 v253, s[12:15], s54 offen lds
  v_mfma_f32_32x32x16_bf16 v[64:79], a[60:63], v[144:147], v[64:79]
  s_waitcnt lgkmcnt(3)
  v_mfma_f32_32x32x16_bf16 v[80:95], a[0:3], v[148:151], 0
  ds_read_b128 v[144:147], v2 offset:20480
  s_add_u32 m0, s81, 35840
  s_add_u32 s58, s96, 3072
  buffer_load_dwordx4 v2, s[20:23], s58 offen sc1 lds
  v_mfma_f32_32x32x16_bf16 v[96:111], a[4:7], v[148:151], 0
  s_waitcnt lgkmcnt(3)
  v_mfma_f32_32x32x16_bf16 v[80:95], a[8:11], v[152:155], v[80:95]
  ds_read_b128 v[148:151], v2 offset:21504
  s_add_u32 m0, s76, 37888
  s_add_u32 s54, s69, 243712
  buffer_load_dwordx4 v253, s[12:15], s54 offen lds
  s_waitcnt vmcnt(18)
  v_add_f32 v164, v164, v172
  v_mfma_f32_32x32x16_bf16 v[96:111], a[12:15], v[152:155], v[96:111]
  v_add_f32 v165, v165, v173
  v_add_f32 v166, v166, v174
  v_add_f32 v167, v167, v175
  s_waitcnt lgkmcnt(3)
  v_mfma_f32_32x32x16_bf16 v[80:95], a[16:19], v[156:159], v[80:95]
  ds_read_b128 v[152:155], v2 offset:22528
  s_add_u32 m0, s81, 36864
  s_add_u32 s58, s96, 4096
  buffer_load_dwordx4 v2, s[20:23], s58 offen sc1 lds
  v_add_f32 v168, v168, v176
  v_mfma_f32_32x32x16_bf16 v[96:111], a[20:23], v[156:159], v[96:111]
  s_waitcnt lgkmcnt(3)
  v_mfma_f32_32x32x16_bf16 v[80:95], a[24:27], v[160:163], v[80:95]
  ds_read_b128 v[156:159], v2 offset:23552
  s_add_u32 m0, s76, 38912
  s_add_u32 s54, s69, 258048
  buffer_load_dwordx4 v253, s[12:15], s54 offen lds
  v_add_f32 v169, v169, v177
  v_mfma_f32_32x32x16_bf16 v[96:111], a[28:31], v[160:163], v[96:111]
  v_add_f32 v170, v170, v178
  s_waitcnt lgkmcnt(3)
  v_mfma_f32_32x32x16_bf16 v[80:95], a[32:35], v[144:147], v[80:95]
  ds_read_b128 v[160:163], v2 offset:24576
  s_add_u32 m0, s81, 37888
  s_add_u32 s58, s96, 5120
  buffer_load_dwordx4 v2, s[20:23], s58 offen sc1 lds
  v_mfma_f32_32x32x16_bf16 v[96:111], a[36:39], v[144:147], v[96:111]
  v_add_f32 v171, v171, v179
  s_waitcnt lgkmcnt(3)
  v_mfma_f32_32x32x16_bf16 v[80:95], a[40:43], v[148:151], v[80:95]
  ds_read_b128 v[144:147], v2 offset:25600
  s_add_u32 m0, s76, 39936
  s_add_u32 s54, s69, 272384
  buffer_load_dwordx4 v253, s[12:15], s54 offen lds
  v_add_f32 v164, v164, v168
  v_mfma_f32_32x32x16_bf16 v[96:111], a[44:47], v[148:151], v[96:111]
  s_waitcnt vmcnt(14)
  s_barrier
  s_waitcnt lgkmcnt(3)
  v_mfma_f32_32x32x16_bf16 v[80:95], a[48:51], v[152:155], v[80:95]
  ds_read_b128 v[148:151], v2 offset:26624
  ds_read_b64_tr_b16 a[128:129], v248 offset:0
  ds_read_b64_tr_b16 a[130:131], v248 offset:1024
  s_add_u32 m0, s81, 38912
  s_add_u32 s58, s96, 6144
  buffer_load_dwordx4 v2, s[20:23], s58 offen sc1 lds
  v_mfma_f32_32x32x16_bf16 v[96:111], a[52:55], v[152:155], v[96:111]
  ds_read_b64_tr_b16 a[132:133], v248 offset:4096
  ds_read_b64_tr_b16 a[134:135], v248 offset:5120
  v_add_f32 v165, v165, v169
  v_add_f32 v166, v166, v170
  s_waitcnt lgkmcnt(7)
  v_mfma_f32_32x32x16_bf16 v[80:95], a[56:59], v[156:159], v[80:95]
  ds_read_b128 v[152:155], v2 offset:27648
  ds_read_b64_tr_b16 a[136:137], v248 offset:8192
  ds_read_b64_tr_b16 a[138:139], v248 offset:9216
  s_add_u32 m0, s81, 39936
  s_add_u32 s58, s96, 7168
  buffer_load_dwordx4 v2, s[20:23], s58 offen sc1 lds
  v_mfma_f32_32x32x16_bf16 v[96:111], a[60:63], v[156:159], v[96:111]
  ds_read_b64_tr_b16 a[140:141], v248 offset:12288
  ds_read_b64_tr_b16 a[142:143], v248 offset:13312
  v_add_f32 v167, v167, v171
  s_waitcnt lgkmcnt(11)
  v_mfma_f32_32x32x16_bf16 v[112:127], a[0:3], v[160:163], 0
  ds_read_b128 v[156:159], v2 offset:28672
  ds_read_b64_tr_b16 a[144:145], v248 offset:16384
  ds_read_b64_tr_b16 a[146:147], v248 offset:17408
  v_mfma_f32_32x32x16_bf16 v[128:143], a[4:7], v[160:163], 0
  ds_read_b64_tr_b16 a[148:149], v248 offset:20480
  ds_read_b64_tr_b16 a[150:151], v248 offset:21504
  s_waitcnt lgkmcnt(15)
  v_mfma_f32_32x32x16_bf16 v[112:127], a[8:11], v[144:147], v[112:127]
  ds_read_b128 v[160:163], v2 offset:29696
  ds_read_b64_tr_b16 a[152:153], v248 offset:24576
  ds_read_b64_tr_b16 a[154:155], v248 offset:25600
  s_add_u32 m0, s88, 0
  s_add_u32 s54, s84, 49152
  buffer_load_dwordx4 v254, s[16:19], s54 offen lds
  v_mfma_f32_32x32x16_bf16 v[128:143], a[12:15], v[144:147], v[128:143]
  ds_read_b64_tr_b16 a[156:157], v248 offset:28672
  ds_read_b64_tr_b16 a[158:159], v248 offset:29696
  s_add_u32 m0, s88, 1024
  s_add_u32 s54, s84, 57344
  buffer_load_dwordx4 v254, s[16:19], s54 offen lds
  s_waitcnt lgkmcnt(15)
  v_mfma_f32_32x32x16_bf16 v[112:127], a[16:19], v[148:151], v[112:127]
  ds_read_b128 v[144:147], v2 offset:30720
  s_add_u32 m0, s88, 2048
  s_add_u32 s54, s84, 65536
  buffer_load_dwordx4 v254, s[16:19], s54 offen lds
  v_mfma_f32_32x32x16_bf16 v[128:143], a[20:23], v[148:151], v[128:143]
  ds_write_b128 v199, v[164:167]
  s_waitcnt lgkmcnt(15)
  v_mfma_f32_32x32x16_bf16 v[112:127], a[24:27], v[152:155], v[112:127]
  ds_read_b128 v[148:151], v2 offset:31744
  s_add_u32 m0, s88, 3072
  s_add_u32 s54, s84, 73728
  buffer_load_dwordx4 v254, s[16:19], s54 offen lds
  v_mfma_f32_32x32x16_bf16 v[128:143], a[28:31], v[152:155], v[128:143]
  s_waitcnt lgkmcnt(12)
  v_mfma_f32_32x32x16_bf16 v[112:127], a[32:35], v[156:159], v[112:127]
  s_add_u32 m0, s88, 4096
  s_add_u32 s54, s84, 81920
  buffer_load_dwordx4 v254, s[16:19], s54 offen lds
  v_mfma_f32_32x32x16_bf16 v[128:143], a[36:39], v[156:159], v[128:143]
  s_waitcnt lgkmcnt(0)
  s_waitcnt vmcnt(5)
  s_barrier
  v_mfma_f32_32x32x16_bf16 v[112:127], a[40:43], v[160:163], v[112:127]
  ds_read_b128 v[152:155], v2 offset:32768
  s_add_u32 m0, s76, 0
  s_add_u32 s54, s100, 0
  buffer_load_dwordx4 v253, s[8:11], s54 offen lds
  v_mfma_f32_32x32x16_bf16 v[128:143], a[44:47], v[160:163], v[128:143]
  ds_read_b128 v[156:159], v2 offset:33792
  v_mfma_f32_32x32x16_bf16 v[112:127], a[48:51], v[144:147], v[112:127]
  ds_read_b128 v[160:163], v2 offset:34816
  v_mfma_f32_16x16x32_bf16 v[4:7], a[128:131], v[240:243], v[4:7]
  v_mfma_f32_16x16x32_bf16 v[8:11], a[132:135], v[240:243], v[8:11]
  s_add_u32 m0, s76, 1024
  s_add_u32 s54, s100, 14336
  buffer_load_dwordx4 v253, s[8:11], s54 offen lds
  v_mfma_f32_32x32x16_bf16 v[128:143], a[52:55], v[144:147], v[128:143]
  v_mfma_f32_32x32x16_bf16 v[112:127], a[56:59], v[148:151], v[112:127]
  ds_read_b128 v[144:147], v2 offset:35840
  v_mfma_f32_16x16x32_bf16 v[4:7], a[136:139], v[240:243], v[4:7]
  v_mfma_f32_16x16x32_bf16 v[8:11], a[140:143], v[240:243], v[8:11]
  s_add_u32 m0, s76, 2048
  s_add_u32 s54, s100, 28672
  buffer_load_dwordx4 v253, s[8:11], s54 offen lds
  v_mfma_f32_32x32x16_bf16 v[128:143], a[60:63], v[148:151], v[128:143]
  s_waitcnt lgkmcnt(3)
  v_mfma_f32_32x32x16_bf16 v[16:31], a[64:67], v[152:155], v[16:31]
  ds_read_b128 v[148:151], v2 offset:36864
  v_mfma_f32_16x16x32_bf16 v[4:7], a[144:147], v[240:243], v[4:7]
  v_mfma_f32_16x16x32_bf16 v[8:11], a[148:151], v[240:243], v[8:11]
  s_add_u32 m0, s76, 3072
  s_add_u32 s54, s100, 43008
  buffer_load_dwordx4 v253, s[8:11], s54 offen lds
  ds_read2st64_b32 v[164:165], v198 offset0:0 offset1:1
  ds_read2st64_b32 v[166:167], v198 offset0:2 offset1:3
  v_mfma_f32_32x32x16_bf16 v[32:47], a[68:71], v[152:155], v[32:47]
  ds_read2st64_b32 v[168:169], v198 offset0:4 offset1:5
  ds_read2st64_b32 v[170:171], v198 offset0:6 offset1:7
  ds_read2st64_b32 v[172:173], v198 offset0:8 offset1:9
  ds_read2st64_b32 v[174:175], v198 offset0:10 offset1:11
  ds_read2st64_b32 v[176:177], v198 offset0:12 offset1:13
  s_waitcnt lgkmcnt(10)
  v_mfma_f32_32x32x16_bf16 v[16:31], a[72:75], v[156:159], v[16:31]
  ds_read_b128 v[152:155], v2 offset:37888
  v_mfma_f32_16x16x32_bf16 v[4:7], a[152:155], v[240:243], v[4:7]
  v_mfma_f32_16x16x32_bf16 v[8:11], a[156:159], v[240:243], v[8:11]
  s_add_u32 m0, s76, 4096
  s_add_u32 s54, s100, 0
  buffer_load_dwordx4 v253, s[12:15], s54 offen lds
  ds_read2st64_b32 v[178:179], v198 offset0:14 offset1:15
  v_mfma_f32_32x32x16_bf16 v[32:47], a[76:79], v[156:159], v[32:47]
  s_waitcnt lgkmcnt(7)
  v_add_f32 v164, v164, v165
  v_mfma_f32_32x32x16_bf16 v[16:31], a[80:83], v[160:163], v[16:31]
  ds_read_b128 v[156:159], v2 offset:38912
  s_add_u32 m0, s76, 5120
  s_add_u32 s54, s100, 14336
  buffer_load_dwordx4 v253, s[12:15], s54 offen lds
  v_add_f32 v166, v166, v167
  v_mfma_f32_32x32x16_bf16 v[32:47], a[84:87], v[160:163], v[32:47]
  v_add_f32 v164, v164, v166
  v_mov_b32 v165, v164
  v_mfma_f32_32x32x16_bf16 v[16:31], a[88:91], v[144:147], v[16:31]
  ds_read_b128 v[160:163], v2 offset:39936
  s_add_u32 m0, s76, 6144
  s_add_u32 s54, s100, 28672
  buffer_load_dwordx4 v253, s[12:15], s54 offen lds
  s_nop 1
  v_permlane32_swap_b32 v164, v165
  v_mfma_f32_32x32x16_bf16 v[32:47], a[92:95], v[144:147], v[32:47]
  v_mul_f32 v166, 0xbb000000, v164
  v_mul_f32 v165, 0x3b000000, v165
  s_barrier
  v_mfma_f32_32x32x16_bf16 v[16:31], a[96:99], v[148:151], v[16:31]
  ds_read_b128 v[144:147], v2 offset:40960
  ds_read_b64_tr_b16 a[160:161], v248 offset:32768
  ds_read_b64_tr_b16 a[162:163], v248 offset:33792
  buffer_store_dwordx4 v[244:247], v252, s[20:23], s90 offen sc1
  v_mfma_f32_32x32x16_bf16 v[32:47], a[100:103], v[148:151], v[32:47]
  ds_read_b64_tr_b16 a[164:165], v248 offset:36864
  ds_read_b64_tr_b16 a[166:167], v248 offset:37888
  v_cvt_pk_bf16_f32 v167, v166, v166
  v_fma_f32 v165, -v166, v166, v165
  s_waitcnt lgkmcnt(8)
  v_mfma_f32_32x32x16_bf16 v[16:31], a[104:107], v[152:155], v[16:31]
  ds_read_b128 v[148:151], v2 offset:41984
  ds_read_b64_tr_b16 a[168:169], v248 offset:40960
  ds_read_b64_tr_b16 a[170:171], v248 offset:41984
  s_add_u32 m0, s76, 7168
  s_add_u32 s54, s100, 43008
  buffer_load_dwordx4 v253, s[12:15], s54 offen lds
  v_mfma_f32_32x32x16_bf16 v[32:47], a[108:111], v[152:155], v[32:47]
  ds_read_b64_tr_b16 a[172:173], v248 offset:45056
  ds_read_b64_tr_b16 a[174:175], v248 offset:46080
  v_and_b32 v167, 0xffff0000, v167
  v_max_f32 v165, 0, v165
  s_waitcnt lgkmcnt(11)
  v_mfma_f32_32x32x16_bf16 v[16:31], a[112:115], v[156:159], v[16:31]
  ds_read_b128 v[152:155], v2 offset:43008
  ds_read_b64_tr_b16 a[176:177], v250 offset:0
  ds_read_b64_tr_b16 a[178:179], v250 offset:1024
  buffer_store_dwordx4 v[244:247], v252, s[20:23], s91 offen sc1
  v_mfma_f32_32x32x16_bf16 v[32:47], a[116:119], v[156:159], v[32:47]
  ds_read_b64_tr_b16 a[180:181], v250 offset:4096
  ds_read_b64_tr_b16 a[182:183], v250 offset:5120
  v_sub_f32 v167, v166, v167
  v_add_f32 v165, 0x3727c5ac, v165
  s_waitcnt lgkmcnt(15)
  v_mfma_f32_32x32x16_bf16 v[16:31], a[120:123], v[160:163], v[16:31]
  ds_read_b128 v[156:159], v2 offset:44032
  ds_read_b64_tr_b16 a[184:185], v250 offset:8192
  ds_read_b64_tr_b16 a[186:187], v250 offset:9216
  s_add_u32 m0, s81, 0
  s_add_u32 s58, s97, 0
  buffer_load_dwordx4 v2, s[20:23], s58 offen sc1 lds
  v_mfma_f32_32x32x16_bf16 v[32:47], a[124:127], v[160:163], v[32:47]
  ds_read_b64_tr_b16 a[188:189], v250 offset:12288
  ds_read_b64_tr_b16 a[190:191], v250 offset:13312
  v_cvt_pk_bf16_f32 v180, v166, v167
  v_rsq_f32 v164, v165
  s_waitcnt lgkmcnt(15)
  v_mfma_f32_32x32x16_bf16 v[48:63], a[64:67], v[144:147], v[48:63]
  ds_read_b128 v[160:163], v2 offset:45056
  s_add_u32 m0, s81, 1024
  s_add_u32 s58, s97, 1024
  buffer_load_dwordx4 v2, s[20:23], s58 offen sc1 lds
  v_mov_b32 v181, v180
  v_sqrt_f32 v191, v165
  v_mfma_f32_32x32x16_bf16 v[64:79], a[68:71], v[144:147], v[64:79]
  v_mul_f32 v190, 0xbfb8aa3b, v164
  v_add_f32 v168, v168, v169
  v_add_f32 v170, v170, v171
  v_add_f32 v168, v168, v170
  s_waitcnt lgkmcnt(15)
  v_mfma_f32_32x32x16_bf16 v[48:63], a[72:75], v[148:151], v[48:63]
  ds_read_b128 v[144:147], v2 offset:46080
  s_add_u32 m0, s81, 2048
  s_add_u32 s58, s97, 2048
  buffer_load_dwordx4 v2, s[20:23], s58 offen sc1 lds
  v_mov_b32 v169, v168
  v_mfma_f32_32x32x16_bf16 v[64:79], a[76:79], v[148:151], v[64:79]
  s_nop 1
  v_permlane32_swap_b32 v168, v169
  v_mul_f32 v170, 0xbb000000, v168
  s_waitcnt lgkmcnt(2)
  s_barrier
  v_mfma_f32_32x32x16_bf16 v[48:63], a[80:83], v[152:155], v[48:63]
  ds_read_b128 v[148:151], v2 offset:47104
  s_add_u32 m0, s76, 32768
  s_add_u32 s54, s100, 229376
  buffer_load_dwordx4 v253, s[8:11], s54 offen lds
  v_mul_f32 v169, 0x3b000000, v169
  v_mfma_f32_32x32x16_bf16 v[64:79], a[84:87], v[152:155], v[64:79]
  v_cvt_pk_bf16_f32 v171, v170, v170
  v_fma_f32 v169, -v170, v170, v169
  v_mfma_f32_32x32x16_bf16 v[48:63], a[88:91], v[156:159], v[48:63]
  ds_read_b128 v[152:155], v2 offset:48128
  v_mfma_f32_16x16x32_bf16 v[4:7], a[160:163], v[240:243], v[4:7]
  v_mfma_f32_16x16x32_bf16 v[8:11], a[164:167], v[240:243], v[8:11]
  s_add_u32 m0, s76, 33792
  s_add_u32 s54, s100, 243712
  buffer_load_dwordx4 v253, s[8:11], s54 offen lds
  v_and_b32 v171, 0xffff0000, v171
  v_mfma_f32_32x32x16_bf16 v[64:79], a[92:95], v[156:159], v[64:79]
  v_max_f32 v169, 0, v169
  v_sub_f32 v171, v170, v171
  s_waitcnt lgkmcnt(3)
  v_mfma_f32_32x32x16_bf16 v[48:63], a[96:99], v[160:163], v[48:63]
  ds_read_b128 v[156:159], v2 offset:49152
  v_mfma_f32_16x16x32_bf16 v[4:7], a[168:171], v[240:243], v[4:7]
  v_mfma_f32_16x16x32_bf16 v[8:11], a[172:175], v[240:243], v[8:11]
  s_add_u32 m0, s76, 34816
  s_add_u32 s54, s100, 258048
  buffer_load_dwordx4 v253, s[8:11], s54 offen lds
  v_add_f32 v169, 0x3727c5ac, v169
  v_mfma_f32_32x32x16_bf16 v[64:79], a[100:103], v[160:163], v[64:79]
  v_cvt_pk_bf16_f32 v182, v170, v171
  v_rsq_f32 v168, v169
  s_waitcnt lgkmcnt(3)
  v_mfma_f32_32x32x16_bf16 v[48:63], a[104:107], v[144:147], v[48:63]
  ds_read_b128 v[160:163], v2 offset:50176
  v_mfma_f32_16x16x32_bf16 v[4:7], a[176:179], v[240:243], v[4:7]
  v_mfma_f32_16x16x32_bf16 v[8:11], a[180:183], v[240:243], v[8:11]
  s_add_u32 m0, s76, 35840
  s_add_u32 s54, s100, 272384
  buffer_load_dwordx4 v253, s[8:11], s54 offen lds
  v_mov_b32 v183, v182
  v_mfma_f32_32x32x16_bf16 v[64:79], a[108:111], v[144:147], v[64:79]
  v_sqrt_f32 v193, v169
  v_mul_f32 v192, 0xbfb8aa3b, v168
  s_waitcnt lgkmcnt(3)
  v_mfma_f32_32x32x16_bf16 v[48:63], a[112:115], v[148:151], v[48:63]
  ds_read_b128 v[144:147], v2 offset:51200
  v_mfma_f32_16x16x32_bf16 v[4:7], a[184:187], v[240:243], v[4:7]
  v_mfma_f32_16x16x32_bf16 v[8:11], a[188:191], v[240:243], v[8:11]
  s_add_u32 m0, s76, 36864
  s_add_u32 s54, s100, 229376
  buffer_load_dwordx4 v253, s[12:15], s54 offen lds
  v_mfma_f32_32x32x16_bf16 v[64:79], a[116:119], v[148:151], v[64:79]
  v_add_f32 v172, v172, v173
  v_add_f32 v174, v174, v175
  s_waitcnt lgkmcnt(3)
  v_mfma_f32_32x32x16_bf16 v[48:63], a[120:123], v[152:155], v[48:63]
  ds_read_b128 v[148:151], v2 offset:52224
  s_add_u32 m0, s76, 37888
  s_add_u32 s54, s100, 243712
  buffer_load_dwordx4 v253, s[12:15], s54 offen lds
  v_add_f32 v172, v172, v174
  v_mfma_f32_32x32x16_bf16 v[64:79], a[124:127], v[152:155], v[64:79]
  v_mov_b32 v173, v172
  s_nop 1
  v_permlane32_swap_b32 v172, v173
  s_waitcnt lgkmcnt(3)
  v_mfma_f32_32x32x16_bf16 v[80:95], a[64:67], v[156:159], v[80:95]
  ds_read_b128 v[152:155], v2 offset:53248
  s_add_u32 m0, s81, 3072
  s_add_u32 s58, s97, 3072
  buffer_load_dwordx4 v2, s[20:23], s58 offen sc1 lds
  v_mul_f32 v174, 0xbb000000, v172
  v_mfma_f32_32x32x16_bf16 v[96:111], a[68:71], v[156:159], v[96:111]
  v_mul_f32 v173, 0x3b000000, v173
  v_cvt_pk_bf16_f32 v175, v174, v174
  s_waitcnt lgkmcnt(3)
  v_mfma_f32_32x32x16_bf16 v[80:95], a[72:75], v[160:163], v[80:95]
  ds_read_b128 v[156:159], v2 offset:54272
  s_add_u32 m0, s76, 38912
  s_add_u32 s54, s100, 258048
  buffer_load_dwordx4 v253, s[12:15], s54 offen lds
  v_fma_f32 v173, -v174, v174, v173
  v_mfma_f32_32x32x16_bf16 v[96:111], a[76:79], v[160:163], v[96:111]
  v_and_b32 v175, 0xffff0000, v175
  v_max_f32 v173, 0, v173
  s_waitcnt lgkmcnt(3)
  v_mfma_f32_32x32x16_bf16 v[80:95], a[80:83], v[144:147], v[80:95]
  ds_read_b128 v[160:163], v2 offset:55296
  s_add_u32 m0, s81, 4096
  s_add_u32 s58, s97, 4096
  buffer_load_dwordx4 v2, s[20:23], s58 offen sc1 lds
  v_sub_f32 v175, v174, v175
  v_mfma_f32_32x32x16_bf16 v[96:111], a[84:87], v[144:147], v[96:111]
  v_add_f32 v173, 0x3727c5ac, v173
  v_cvt_pk_bf16_f32 v184, v174, v175
  s_waitcnt lgkmcnt(3)
  v_mfma_f32_32x32x16_bf16 v[80:95], a[88:91], v[148:151], v[80:95]
  ds_read_b128 v[144:147], v2 offset:56320
  s_add_u32 m0, s76, 39936
  s_add_u32 s54, s100, 272384
  buffer_load_dwordx4 v253, s[12:15], s54 offen lds
  v_rsq_f32 v172, v173
  v_mfma_f32_32x32x16_bf16 v[96:111], a[92:95], v[148:151], v[96:111]
  v_mov_b32 v185, v184
  v_sqrt_f32 v195, v173
  s_waitcnt vmcnt(14)
  s_barrier
  s_waitcnt lgkmcnt(3)
  v_mfma_f32_32x32x16_bf16 v[80:95], a[96:99], v[152:155], v[80:95]
  ds_read_b128 v[148:151], v2 offset:57344
  ds_read_b64_tr_b16 a[192:193], v248 offset:0
  s_add_u32 m0, s81, 5120
  s_add_u32 s58, s97, 5120
  buffer_load_dwordx4 v2, s[20:23], s58 offen sc1 lds
  v_mfma_f32_32x32x16_bf16 v[96:111], a[100:103], v[152:155], v[96:111]
  ds_read_b64_tr_b16 a[194:195], v248 offset:1024
  v_mul_f32 v194, 0xbfb8aa3b, v172
  v_add_f32 v176, v176, v177
  s_waitcnt lgkmcnt(5)
  v_mfma_f32_32x32x16_bf16 v[80:95], a[104:107], v[156:159], v[80:95]
  ds_read_b128 v[152:155], v2 offset:58368
  ds_read_b64_tr_b16 a[196:197], v248 offset:4096
  s_add_u32 m0, s81, 6144
  s_add_u32 s58, s97, 6144
  buffer_load_dwordx4 v2, s[20:23], s58 offen sc1 lds
  v_mfma_f32_32x32x16_bf16 v[96:111], a[108:111], v[156:159], v[96:111]
  ds_read_b64_tr_b16 a[198:199], v248 offset:5120
  v_add_f32 v178, v178, v179
  v_add_f32 v176, v176, v178
  v_mov_b32 v177, v176
  s_waitcnt lgkmcnt(7)
  v_mfma_f32_32x32x16_bf16 v[80:95], a[112:115], v[160:163], v[80:95]
  ds_read_b128 v[156:159], v2 offset:59392
  ds_read_b64_tr_b16 a[200:201], v248 offset:8192
  s_add_u32 m0, s81, 7168
  s_add_u32 s58, s97, 7168
  buffer_load_dwordx4 v2, s[20:23], s58 offen sc1 lds
  v_mfma_f32_32x32x16_bf16 v[96:111], a[116:119], v[160:163], v[96:111]
  ds_read_b64_tr_b16 a[202:203], v248 offset:9216
  s_nop 1
  v_permlane32_swap_b32 v176, v177
  v_mul_f32 v178, 0xbb000000, v176
  v_mul_f32 v177, 0x3b000000, v177
  s_waitcnt lgkmcnt(9)
  v_mfma_f32_32x32x16_bf16 v[80:95], a[120:123], v[144:147], v[80:95]
  ds_read_b128 v[160:163], v2 offset:60416
  ds_read_b64_tr_b16 a[204:205], v248 offset:12288
  s_add_u32 m0, s88, 5120
  s_add_u32 s54, s84, 90112
  buffer_load_dwordx4 v254, s[16:19], s54 offen lds
  v_mfma_f32_32x32x16_bf16 v[96:111], a[124:127], v[144:147], v[96:111]
  ds_read_b64_tr_b16 a[206:207], v248 offset:13312
  v_cvt_pk_bf16_f32 v179, v178, v178
  v_fma_f32 v177, -v178, v178, v177
  v_and_b32 v179, 0xffff0000, v179
  s_waitcnt lgkmcnt(11)
  v_mfma_f32_32x32x16_bf16 v[112:127], a[64:67], v[148:151], v[112:127]
  ds_read_b128 v[144:147], v2 offset:61440
  ds_read_b64_tr_b16 a[208:209], v248 offset:16384
  v_max_f32 v177, 0, v177
  v_mfma_f32_32x32x16_bf16 v[128:143], a[68:71], v[148:151], v[128:143]
  ds_read_b64_tr_b16 a[210:211], v248 offset:17408
  v_sub_f32 v179, v178, v179
  v_add_f32 v177, 0x3727c5ac, v177
  s_waitcnt lgkmcnt(11)
  v_mfma_f32_32x32x16_bf16 v[112:127], a[72:75], v[152:155], v[112:127]
  ds_read_b128 v[148:151], v2 offset:62464
  ds_read_b64_tr_b16 a[212:213], v248 offset:20480
  v_cvt_pk_bf16_f32 v186, v178, v179
  v_mfma_f32_32x32x16_bf16 v[128:143], a[76:79], v[152:155], v[128:143]
  ds_read_b64_tr_b16 a[214:215], v248 offset:21504
  v_rsq_f32 v176, v177
  v_mov_b32 v187, v186
  s_waitcnt lgkmcnt(11)
  v_mfma_f32_32x32x16_bf16 v[112:127], a[80:83], v[156:159], v[112:127]
  ds_read_b128 v[152:155], v2 offset:63488
  ds_read_b64_tr_b16 a[216:217], v248 offset:24576
  v_sqrt_f32 v197, v177
  v_mfma_f32_32x32x16_bf16 v[128:143], a[84:87], v[156:159], v[128:143]
  ds_read_b64_tr_b16 a[218:219], v248 offset:25600
  v_mul_f32 v196, 0xbfb8aa3b, v176
  v_mov_b32 v188, 0
  s_waitcnt lgkmcnt(11)
  v_mfma_f32_32x32x16_bf16 v[112:127], a[88:91], v[160:163], v[112:127]
  ds_read_b128 v[156:159], v2 offset:64512
  ds_read_b64_tr_b16 a[220:221], v248 offset:28672
  v_mov_b32 v189, 0
  v_mfma_f32_32x32x16_bf16 v[128:143], a[92:95], v[160:163], v[128:143]
  ds_read_b64_tr_b16 a[222:223], v248 offset:29696
  s_waitcnt lgkmcnt(11)
  v_mfma_f32_32x32x16_bf16 v[112:127], a[96:99], v[144:147], v[112:127]
  v_mfma_f32_32x32x16_bf16 v[128:143], a[100:103], v[144:147], v[128:143]
  s_waitcnt lgkmcnt(0)
  s_waitcnt vmcnt(4)
  s_waitcnt vmcnt(1)
  s_barrier
  v_mfma_f32_32x32x16_bf16 v[112:127], a[104:107], v[148:151], v[112:127]
  ds_read_b128 v[160:163], v2 offset:0
  ds_read_b64_tr_b16 a[224:225], v248 offset:32768
  s_add_u32 m0, s81, 32768
  s_add_u32 s58, s98, 0
  buffer_load_dwordx4 v2, s[20:23], s58 offen sc1 lds
  v_mfma_f32_32x32x16_bf16 v[128:143], a[108:111], v[148:151], v[128:143]
  ds_read_b128 v[144:147], v2 offset:1024
  s_lshl_b32 s55, s35, 6
  s_add_u32 s55, s55, s34
  s_lshl_b32 s54, s55, 7
  s_add_u32 s54, s54, s46
  s_add_u32 s54, s54, 163840
  v_mov_b32 v14, s31
  v_mov_b32 v15, 0
  s_mov_b64 exec, 1
  buffer_store_dword v14, v15, s[20:23], s54 offen sc1
  s_mov_b64 exec, -1
  ds_read_b64_tr_b16 a[226:227], v248 offset:33792
  v_mfma_f32_32x32x16_bf16 v[112:127], a[112:115], v[152:155], v[112:127]
  ds_read_b128 v[148:151], v2 offset:2048
  v_mfma_f32_16x16x32_bf16 v[4:7], a[192:195], v[240:243], v[4:7]
  v_mfma_f32_16x16x32_bf16 v[8:11], a[196:199], v[240:243], v[8:11]
  ds_read_b64_tr_b16 a[228:229], v248 offset:36864
  s_add_u32 m0, s81, 33792
  s_add_u32 s58, s98, 1024
  buffer_load_dwordx4 v2, s[20:23], s58 offen sc1 lds
  v_mfma_f32_32x32x16_bf16 v[128:143], a[116:119], v[152:155], v[128:143]
  ds_read_b64_tr_b16 a[230:231], v248 offset:37888
  v_mfma_f32_32x32x16_bf16 v[112:127], a[120:123], v[156:159], v[112:127]
  ds_read_b128 v[152:155], v2 offset:3072
  v_mfma_f32_16x16x32_bf16 v[4:7], a[200:203], v[240:243], v[4:7]
  v_mfma_f32_16x16x32_bf16 v[8:11], a[204:207], v[240:243], v[8:11]
  ds_read_b64_tr_b16 a[232:233], v248 offset:40960
  s_add_u32 m0, s81, 34816
  s_add_u32 s58, s98, 2048
  buffer_load_dwordx4 v2, s[20:23], s58 offen sc1 lds
  v_mfma_f32_32x32x16_bf16 v[128:143], a[124:127], v[156:159], v[128:143]
  ds_read_b64_tr_b16 a[234:235], v248 offset:41984
  s_waitcnt lgkmcnt(9)
  v_mfma_f32_32x32x16_bf16 v[16:31], a[128:131], v[160:163], v[16:31]
  ds_read_b128 v[156:159], v2 offset:4096
  v_mfma_f32_16x16x32_bf16 v[4:7], a[208:211], v[240:243], v[4:7]
  v_mfma_f32_16x16x32_bf16 v[8:11], a[212:215], v[240:243], v[8:11]
  ds_read_b64_tr_b16 a[236:237], v248 offset:45056
  s_add_u32 m0, s81, 35840
  s_add_u32 s58, s98, 3072
  buffer_load_dwordx4 v2, s[20:23], s58 offen sc1 lds
  v_mfma_f32_32x32x16_bf16 v[32:47], a[132:135], v[160:163], v[32:47]
  ds_read_b64_tr_b16 a[238:239], v248 offset:46080
  s_waitcnt lgkmcnt(10)
  v_mfma_f32_32x32x16_bf16 v[16:31], a[136:139], v[144:147], v[16:31]
  ds_read_b128 v[160:163], v2 offset:5120
  v_mfma_f32_16x16x32_bf16 v[4:7], a[216:219], v[240:243], v[4:7]
  v_mfma_f32_16x16x32_bf16 v[8:11], a[220:223], v[240:243], v[8:11]
  ds_read_b64_tr_b16 a[240:241], v250 offset:0
  s_add_u32 m0, s81, 36864
  s_add_u32 s58, s98, 4096
  buffer_load_dwordx4 v2, s[20:23], s58 offen sc1 lds
  v_mfma_f32_32x32x16_bf16 v[32:47], a[140:143], v[144:147], v[32:47]
  ds_read_b64_tr_b16 a[242:243], v250 offset:1024
  s_waitcnt lgkmcnt(11)
  v_mfma_f32_32x32x16_bf16 v[16:31], a[144:147], v[148:151], v[16:31]
  ds_read_b128 v[144:147], v2 offset:6144
  ds_read_b64_tr_b16 a[244:245], v250 offset:4096
  s_add_u32 m0, s81, 37888
  s_add_u32 s58, s98, 5120
  buffer_load_dwordx4 v2, s[20:23], s58 offen sc1 lds
  v_mfma_f32_32x32x16_bf16 v[32:47], a[148:151], v[148:151], v[32:47]
  ds_read_b64_tr_b16 a[246:247], v250 offset:5120
  s_waitcnt lgkmcnt(11)
  v_mfma_f32_32x32x16_bf16 v[16:31], a[152:155], v[152:155], v[16:31]
  ds_read_b128 v[148:151], v2 offset:7168
  ds_read_b64_tr_b16 a[248:249], v250 offset:8192
  s_add_u32 m0, s81, 38912
  s_add_u32 s58, s98, 6144
  buffer_load_dwordx4 v2, s[20:23], s58 offen sc1 lds
  v_mfma_f32_32x32x16_bf16 v[32:47], a[156:159], v[152:155], v[32:47]
  ds_read_b64_tr_b16 a[250:251], v250 offset:9216
  s_waitcnt lgkmcnt(11)
  v_mfma_f32_32x32x16_bf16 v[16:31], a[160:163], v[156:159], v[16:31]
  ds_read_b128 v[152:155], v2 offset:8192
  ds_read_b64_tr_b16 a[252:253], v250 offset:12288
  s_add_u32 m0, s81, 39936
  s_add_u32 s58, s98, 7168
  buffer_load_dwordx4 v2, s[20:23], s58 offen sc1 lds
  v_mfma_f32_32x32x16_bf16 v[32:47], a[164:167], v[156:159], v[32:47]
  ds_read_b64_tr_b16 a[254:255], v250 offset:13312
  s_waitcnt lgkmcnt(11)
  v_mfma_f32_32x32x16_bf16 v[16:31], a[168:171], v[160:163], v[16:31]
  ds_read_b128 v[156:159], v2 offset:9216
  s_add_u32 m0, s87, 0
  s_add_u32 s54, s84, 98304
  buffer_load_dwordx4 v254, s[16:19], s54 offen lds
  v_mfma_f32_32x32x16_bf16 v[32:47], a[172:175], v[160:163], v[32:47]
  s_waitcnt lgkmcnt(9)
  v_mfma_f32_32x32x16_bf16 v[16:31], a[176:179], v[144:147], v[16:31]
  ds_read_b128 v[160:163], v2 offset:10240
  s_waitcnt lgkmcnt(2)
  v_mfma_f32_16x16x32_bf16 v[4:7], a[224:227], v[240:243], v[4:7]
  v_mfma_f32_16x16x32_bf16 v[8:11], a[228:231], v[240:243], v[8:11]
  s_add_u32 m0, s87, 1024
  s_add_u32 s54, s84, 106496
  buffer_load_dwordx4 v254, s[16:19], s54 offen lds
  v_mfma_f32_32x32x16_bf16 v[32:47], a[180:183], v[144:147], v[32:47]
  v_mfma_f32_32x32x16_bf16 v[16:31], a[184:187], v[148:151], v[16:31]
  ds_read_b128 v[144:147], v2 offset:11264
  v_mfma_f32_16x16x32_bf16 v[4:7], a[232:235], v[240:243], v[4:7]
  v_mfma_f32_16x16x32_bf16 v[8:11], a[236:239], v[240:243], v[8:11]
  s_add_u32 m0, s87, 2048
  s_add_u32 s54, s84, 114688
  buffer_load_dwordx4 v254, s[16:19], s54 offen lds
  v_mfma_f32_32x32x16_bf16 v[32:47], a[188:191], v[148:151], v[32:47]
  v_mfma_f32_32x32x16_bf16 v[16:31], a[192:195], v[152:155], v[16:31]
  ds_read_b128 v[148:151], v2 offset:12288
  v_mfma_f32_16x16x32_bf16 v[4:7], a[240:243], v[240:243], v[4:7]
  v_mfma_f32_16x16x32_bf16 v[8:11], a[244:247], v[240:243], v[8:11]
  s_add_u32 m0, s87, 3072
  s_add_u32 s54, s84, 122880
  buffer_load_dwordx4 v254, s[16:19], s54 offen lds
  v_mfma_f32_32x32x16_bf16 v[32:47], a[196:199], v[152:155], v[32:47]
  s_waitcnt lgkmcnt(3)
  v_mfma_f32_32x32x16_bf16 v[16:31], a[200:203], v[156:159], v[16:31]
  ds_read_b128 v[152:155], v2 offset:13312
  v_mfma_f32_16x16x32_bf16 v[4:7], a[248:251], v[240:243], v[4:7]
  v_mfma_f32_16x16x32_bf16 v[8:11], a[252:255], v[240:243], v[8:11]
  s_add_u32 m0, s87, 4096
  s_add_u32 s54, s84, 131072
  buffer_load_dwordx4 v254, s[16:19], s54 offen lds
  v_mfma_f32_32x32x16_bf16 v[32:47], a[204:207], v[156:159], v[32:47]
  s_waitcnt lgkmcnt(3)
  v_mfma_f32_32x32x16_bf16 v[16:31], a[208:211], v[160:163], v[16:31]
  ds_read_b128 v[156:159], v2 offset:14336
  ds_read_b64_tr_b16 v[224:225], v249 offset:0
  s_add_u32 m0, s87, 5120
  s_add_u32 s54, s84, 139264
  buffer_load_dwordx4 v254, s[16:19], s54 offen lds
  v_mfma_f32_32x32x16_bf16 v[32:47], a[212:215], v[160:163], v[32:47]
  ds_read_b64_tr_b16 v[226:227], v249 offset:512
  v_and_b32 v12, 1, v1
  v_lshlrev_b32 v12, 6, v12
  v_lshrrev_b32 v13, 4, v1
  v_lshl_add_u32 v12, v13, 4, v12
  s_waitcnt lgkmcnt(5)
  v_mfma_f32_32x32x16_bf16 v[16:31], a[216:219], v[144:147], v[16:31]
  ds_read_b128 v[160:163], v2 offset:15360
  ds_read_b64_tr_b16 v[228:229], v251 offset:0
  s_add_u32 m0, s87, 6144
  s_add_u32 s54, s84, 147456
  buffer_load_dwordx4 v254, s[16:19], s54 offen lds
  v_mfma_f32_32x32x16_bf16 v[32:47], a[220:223], v[144:147], v[32:47]
  ds_read_b64_tr_b16 v[230:231], v251 offset:512
  s_lshl_b32 s55, s30, 8
  s_add_u32 s55, s55, 157696
  v_add_u32 v12, s55, v12
  ds_write_b128 v12, v[4:7]
  s_waitcnt lgkmcnt(8)
  v_mfma_f32_32x32x16_bf16 v[16:31], a[224:227], v[148:151], v[16:31]
  ds_read_b128 v[144:147], v2 offset:16384
  ds_read_b64_tr_b16 v[232:233], v249 offset:2048
  s_add_u32 m0, s87, 7168
  s_add_u32 s54, s84, 155648
  buffer_load_dwordx4 v254, s[16:19], s54 offen lds
  v_mfma_f32_32x32x16_bf16 v[32:47], a[228:231], v[148:151], v[32:47]
  ds_read_b64_tr_b16 v[234:235], v249 offset:2560
  ds_write_b128 v12, v[8:11] offset:128
  v_and_b32 v13, 31, v1
  s_waitcnt lgkmcnt(11)
  v_mfma_f32_32x32x16_bf16 v[16:31], a[232:235], v[152:155], v[16:31]
  ds_read_b128 v[148:151], v2 offset:17408
  ds_read_b64_tr_b16 v[236:237], v251 offset:2048
  v_lshlrev_b32 v13, 2, v13
  v_add_u32 v13, s55, v13
  v_mfma_f32_32x32x16_bf16 v[32:47], a[236:239], v[152:155], v[32:47]
  ds_read_b64_tr_b16 v[238:239], v251 offset:2560
  s_waitcnt lgkmcnt(3)
  ds_read2_b32 v[14:15], v13 offset0:0 offset1:32
  v_cmp_gt_u32 vcc, 32, v1
  v_mfma_f32_32x32x16_bf16 v[16:31], a[240:243], v[156:159], v[16:31]
  ds_read_b128 v[152:155], v2 offset:18432
  s_waitcnt vmcnt(17)
  ds_read_b64_tr_b16 v[240:241], v249 offset:4096
  v_mfma_f32_32x32x16_bf16 v[32:47], a[244:247], v[156:159], v[32:47]
  ds_read_b64_tr_b16 v[242:243], v249 offset:4608
  v_mfma_f32_32x32x16_bf16 v[16:31], a[248:251], v[160:163], v[16:31]
  ds_read_b128 v[156:159], v2 offset:19456
  ds_read_b64_tr_b16 v[244:245], v251 offset:4096
  v_mfma_f32_32x32x16_bf16 v[32:47], a[252:255], v[160:163], v[32:47]
  ds_read_b64_tr_b16 v[246:247], v251 offset:4608
  s_waitcnt lgkmcnt(6)
  v_cndmask_b32 v14, 0, v14, vcc
  v_cvt_pk_bf16_f32 v4, v14, v14
  v_and_b32 v5, 0xffff0000, v4
  v_sub_f32 v14, v14, v5
  v_cvt_pk_bf16_f32 v5, v14, v14
  v_mov_b32 v6, 0
  v_mov_b32 v7, 0
  v_cndmask_b32 v15, 0, v15, vcc
  v_cvt_pk_bf16_f32 v8, v15, v15
  v_and_b32 v9, 0xffff0000, v8
  v_sub_f32 v15, v15, v9
  v_cvt_pk_bf16_f32 v9, v15, v15
  v_mov_b32 v10, 0
  v_mov_b32 v11, 0
  v_mfma_f32_32x32x16_bf16 v[16:31], v[4:7], v[180:183], v[16:31]
  s_nop 0
  v_mfma_f32_32x32x16_bf16 v[32:47], v[8:11], v[180:183], v[32:47]
  v_mfma_f32_32x32x16_bf16 v[48:63], a[128:131], v[144:147], v[48:63]
  ds_read_b128 v[160:163], v2 offset:20480
  v_mfma_f32_32x32x16_bf16 v[64:79], a[132:135], v[144:147], v[64:79]
  v_mfma_f32_32x32x16_bf16 v[48:63], a[136:139], v[148:151], v[48:63]
  ds_read_b128 v[144:147], v2 offset:21504
  s_waitcnt lgkmcnt(2)
  s_nop 3
  v_mul_f32 v16, v190, v16
  v_mul_f32 v17, v190, v17
  v_mul_f32 v18, v190, v18
  v_mul_f32 v19, v190, v19
  v_mfma_f32_32x32x16_bf16 v[64:79], a[140:143], v[148:151], v[64:79]
  s_add_u32 m0, s88, 0
  s_add_u32 s54, s84, 229376
  buffer_load_dwordx4 v254, s[16:19], s54 offen lds
  v_exp_f32 v16, v16
  v_exp_f32 v17, v17
  v_mfma_f32_32x32x16_bf16 v[48:63], a[144:147], v[152:155], v[48:63]
  ds_read_b128 v[148:151], v2 offset:22528
  v_exp_f32 v18, v18
  v_exp_f32 v19, v19
  v_mfma_f32_32x32x16_bf16 v[64:79], a[148:151], v[152:155], v[64:79]
  s_add_u32 m0, s88, 1024
  s_add_u32 s54, s84, 237568
  buffer_load_dwordx4 v254, s[16:19], s54 offen lds
  v_fma_f32 v16, v16, v191, v191
  v_fma_f32 v17, v17, v191, v191
  v_fma_f32 v18, v18, v191, v191
  v_fma_f32 v19, v19, v191, v191
  v_mfma_f32_32x32x16_bf16 v[48:63], a[152:155], v[156:159], v[48:63]
  ds_read_b128 v[152:155], v2 offset:23552
  v_rcp_f32 v16, v16
  v_rcp_f32 v17, v17
  v_mfma_f32_32x32x16_bf16 v[64:79], a[156:159], v[156:159], v[64:79]
  s_add_u32 m0, s88, 2048
  s_add_u32 s54, s84, 245760
  buffer_load_dwordx4 v254, s[16:19], s54 offen lds
  v_rcp_f32 v18, v18
  v_rcp_f32 v19, v19
  s_waitcnt lgkmcnt(3)
  v_mfma_f32_32x32x16_bf16 v[48:63], a[160:163], v[160:163], v[48:63]
  ds_read_b128 v[156:159], v2 offset:24576
  v_mul_f32 v32, v32, v16
  v_mul_f32 v33, v33, v17
  v_mul_f32 v34, v34, v18
  v_mul_f32 v35, v35, v19
  v_mfma_f32_32x32x16_bf16 v[64:79], a[164:167], v[160:163], v[64:79]
  s_add_u32 m0, s88, 3072
  s_add_u32 s54, s84, 253952
  buffer_load_dwordx4 v254, s[16:19], s54 offen lds
  v_mul_f32 v20, v190, v20
  v_mul_f32 v21, v190, v21
  v_mul_f32 v22, v190, v22
  v_mul_f32 v23, v190, v23
  s_waitcnt lgkmcnt(3)
  v_mfma_f32_32x32x16_bf16 v[48:63], a[168:171], v[144:147], v[48:63]
  ds_read_b128 v[160:163], v2 offset:25600
  v_cvt_pk_bf16_f32 v164, v32, v33
  v_cvt_pk_bf16_f32 v165, v34, v35
  v_exp_f32 v20, v20
  v_mfma_f32_32x32x16_bf16 v[64:79], a[172:175], v[144:147], v[64:79]
  s_add_u32 m0, s88, 4096
  s_add_u32 s54, s84, 262144
  buffer_load_dwordx4 v254, s[16:19], s54 offen lds
  v_exp_f32 v21, v21
  v_exp_f32 v22, v22
  s_waitcnt lgkmcnt(3)
  v_mfma_f32_32x32x16_bf16 v[48:63], a[176:179], v[148:151], v[48:63]
  ds_read_b128 v[144:147], v2 offset:26624
  v_exp_f32 v23, v23
  v_fma_f32 v20, v20, v191, v191
  v_fma_f32 v21, v21, v191, v191
  v_mfma_f32_32x32x16_bf16 v[64:79], a[180:183], v[148:151], v[64:79]
  s_add_u32 m0, s88, 5120
  s_add_u32 s54, s84, 270336
  buffer_load_dwordx4 v254, s[16:19], s54 offen lds
  v_fma_f32 v22, v22, v191, v191
  v_fma_f32 v23, v23, v191, v191
  v_rcp_f32 v20, v20
  s_waitcnt lgkmcnt(3)
  v_mfma_f32_32x32x16_bf16 v[48:63], a[184:187], v[152:155], v[48:63]
  ds_read_b128 v[148:151], v2 offset:27648
  v_rcp_f32 v21, v21
  v_rcp_f32 v22, v22
  v_mfma_f32_32x32x16_bf16 v[64:79], a[188:191], v[152:155], v[64:79]
  v_rcp_f32 v23, v23
  v_mul_f32 v36, v36, v20
  v_mul_f32 v37, v37, v21
  v_mul_f32 v38, v38, v22
  v_mul_f32 v39, v39, v23
  s_waitcnt lgkmcnt(3)
  v_mfma_f32_32x32x16_bf16 v[48:63], a[192:195], v[156:159], v[48:63]
  ds_read_b128 v[152:155], v2 offset:28672
  v_mul_f32 v24, v190, v24
  v_mul_f32 v25, v190, v25
  v_mul_f32 v26, v190, v26
  v_mul_f32 v27, v190, v27
  v_mfma_f32_32x32x16_bf16 v[64:79], a[196:199], v[156:159], v[64:79]
  v_cvt_pk_bf16_f32 v166, v36, v37
  v_cvt_pk_bf16_f32 v167, v38, v39
  v_exp_f32 v24, v24
  v_exp_f32 v25, v25
  s_waitcnt lgkmcnt(3)
  v_mfma_f32_32x32x16_bf16 v[48:63], a[200:203], v[160:163], v[48:63]
  ds_read_b128 v[156:159], v2 offset:29696
  v_exp_f32 v26, v26
  v_exp_f32 v27, v27
  v_mfma_f32_32x32x16_bf16 v[64:79], a[204:207], v[160:163], v[64:79]
  s_cmp_eq_u32 s32, 0
  s_cbranch_scc1 Ls_49
  buffer_store_dwordx4 v[164:167], v2, s[20:23], s62 offen nt
Lb_50:
  v_fma_f32 v24, v24, v191, v191
  v_fma_f32 v25, v25, v191, v191
  v_fma_f32 v26, v26, v191, v191
  v_fma_f32 v27, v27, v191, v191
  s_waitcnt lgkmcnt(3)
  v_mfma_f32_32x32x16_bf16 v[48:63], a[208:211], v[144:147], v[48:63]
  ds_read_b128 v[160:163], v2 offset:30720
  v_rcp_f32 v24, v24
  v_rcp_f32 v25, v25
  v_mfma_f32_32x32x16_bf16 v[64:79], a[212:215], v[144:147], v[64:79]
  v_rcp_f32 v26, v26
  v_rcp_f32 v27, v27
  v_mul_f32 v40, v40, v24
  v_mul_f32 v41, v41, v25
  s_waitcnt lgkmcnt(3)
  v_mfma_f32_32x32x16_bf16 v[48:63], a[216:219], v[148:151], v[48:63]
  ds_read_b128 v[144:147], v2 offset:31744
  v_mul_f32 v42, v42, v26
  v_mul_f32 v43, v43, v27
  v_mul_f32 v28, v190, v28
  v_mul_f32 v29, v190, v29
  v_mfma_f32_32x32x16_bf16 v[64:79], a[220:223], v[148:151], v[64:79]
  v_mul_f32 v30, v190, v30
  v_mul_f32 v31, v190, v31
  v_cvt_pk_bf16_f32 v168, v40, v41
  v_cvt_pk_bf16_f32 v169, v42, v43
  v_exp_f32 v28, v28
  s_waitcnt lgkmcnt(3)
  v_mfma_f32_32x32x16_bf16 v[48:63], a[224:227], v[152:155], v[48:63]
  v_exp_f32 v29, v29
  v_exp_f32 v30, v30
  v_exp_f32 v31, v31
  v_mfma_f32_32x32x16_bf16 v[64:79], a[228:231], v[152:155], v[64:79]
  v_fma_f32 v28, v28, v191, v191
  v_fma_f32 v29, v29, v191, v191
  v_fma_f32 v30, v30, v191, v191
  v_fma_f32 v31, v31, v191, v191
  v_rcp_f32 v28, v28
  s_waitcnt lgkmcnt(0)
  s_waitcnt vmcnt(15)
  s_barrier
  v_mfma_f32_32x32x16_bf16 v[48:63], a[232:235], v[156:159], v[48:63]
  ds_read_b128 v[148:151], v2 offset:32768
  v_rcp_f32 v29, v29
  v_rcp_f32 v30, v30
  v_mfma_f32_32x32x16_bf16 v[64:79], a[236:239], v[156:159], v[64:79]
  ds_read_b128 v[152:155], v2 offset:33792
  s_add_u32 m0, s81, 0
  s_add_u32 s54, s84, 278528
  buffer_load_dwordx4 v254, s[16:19], s54 offen lds
  v_rcp_f32 v31, v31
  v_mfma_f32_32x32x16_bf16 v[48:63], a[240:243], v[160:163], v[48:63]
  ds_read_b128 v[156:159], v2 offset:34816
  v_mul_f32 v44, v44, v28
  v_mul_f32 v45, v45, v29
  v_mul_f32 v46, v46, v30
  v_mul_f32 v47, v47, v31
  v_mfma_f32_32x32x16_bf16 v[64:79], a[244:247], v[160:163], v[64:79]
  s_add_u32 m0, s81, 1024
  s_add_u32 s54, s84, 286720
  buffer_load_dwordx4 v254, s[16:19], s54 offen lds
  v_cvt_pk_bf16_f32 v170, v44, v45
  v_cvt_pk_bf16_f32 v171, v46, v47
  v_mfma_f32_32x32x16_bf16 v[48:63], a[248:251], v[144:147], v[48:63]
  ds_read_b128 v[160:163], v2 offset:35840
  v_lshrrev_b32 v12, 2, v1
  v_min_u32 v12, 13, v12
  v_lshlrev_b32 v12, 7, v12
  v_and_b32 v15, 3, v1
  v_lshl_add_u32 v12, v15, 2, v12
  s_lshl_b32 s90, s28, 11
  s_add_u32 s90, s90, 196608
  v_mfma_f32_32x32x16_bf16 v[64:79], a[252:255], v[144:147], v[64:79]
  s_add_u32 m0, s81, 2048
  s_add_u32 s54, s84, 294912
  buffer_load_dwordx4 v254, s[16:19], s54 offen lds
  s_cmp_eq_u32 s32, 0
  s_cbranch_scc1 Ls_51
  buffer_store_dwordx4 v[168:171], v2, s[20:23], s62 offen offset:1024 nt
Lb_52:
  v_mfma_f32_32x32x16_bf16 v[48:63], v[4:7], v[182:185], v[48:63]
  v_mfma_f32_32x32x16_bf16 v[64:79], v[8:11], v[182:185], v[64:79]
  s_waitcnt lgkmcnt(3)
  v_mfma_f32_32x32x16_bf16 v[80:95], a[128:131], v[148:151], v[80:95]
  ds_read_b128 v[144:147], v2 offset:36864
  v_mfma_f32_32x32x16_bf16 v[96:111], a[132:135], v[148:151], v[96:111]
  s_add_u32 m0, s81, 3072
  s_add_u32 s54, s84, 303104
  buffer_load_dwordx4 v254, s[16:19], s54 offen lds
  s_waitcnt lgkmcnt(3)
  v_mfma_f32_32x32x16_bf16 v[80:95], a[136:139], v[152:155], v[80:95]
  ds_read_b128 v[148:151], v2 offset:37888
  s_nop 0
  v_mul_f32 v48, v192, v48
  v_mul_f32 v49, v192, v49
  v_mul_f32 v50, v192, v50
  v_mul_f32 v51, v192, v51
  v_mfma_f32_32x32x16_bf16 v[96:111], a[140:143], v[152:155], v[96:111]
  s_add_u32 m0, s81, 4096
  s_add_u32 s54, s84, 311296
  buffer_load_dwordx4 v254, s[16:19], s54 offen lds
  v_exp_f32 v48, v48
  v_exp_f32 v49, v49
  s_waitcnt lgkmcnt(3)
  v_mfma_f32_32x32x16_bf16 v[80:95], a[144:147], v[156:159], v[80:95]
  ds_read_b128 v[152:155], v2 offset:38912
  v_exp_f32 v50, v50
  v_exp_f32 v51, v51
  v_mfma_f32_32x32x16_bf16 v[96:111], a[148:151], v[156:159], v[96:111]
  s_add_u32 m0, s87, 32768
  s_add_u32 s54, s84, 163840
  buffer_load_dwordx4 v254, s[16:19], s54 offen lds
  v_fma_f32 v48, v48, v193, v193
  v_fma_f32 v49, v49, v193, v193
  v_fma_f32 v50, v50, v193, v193
  v_fma_f32 v51, v51, v193, v193
  s_waitcnt lgkmcnt(3)
  v_mfma_f32_32x32x16_bf16 v[80:95], a[152:155], v[160:163], v[80:95]
  ds_read_b128 v[156:159], v2 offset:39936
  v_rcp_f32 v48, v48
  v_rcp_f32 v49, v49
  v_mfma_f32_32x32x16_bf16 v[96:111], a[156:159], v[160:163], v[96:111]
  s_add_u32 m0, s81, 5120
  s_add_u32 s54, s84, 319488
  buffer_load_dwordx4 v254, s[16:19], s54 offen lds
  v_rcp_f32 v50, v50
  v_rcp_f32 v51, v51
  s_waitcnt lgkmcnt(3)
  v_mfma_f32_32x32x16_bf16 v[80:95], a[160:163], v[144:147], v[80:95]
  ds_read_b128 v[160:163], v2 offset:40960
  v_mul_f32 v64, v64, v48
  v_mul_f32 v65, v65, v49
  v_mul_f32 v66, v66, v50
  v_mul_f32 v67, v67, v51
  v_mfma_f32_32x32x16_bf16 v[96:111], a[164:167], v[144:147], v[96:111]
  s_add_u32 m0, s87, 33792
  s_add_u32 s54, s84, 172032
  buffer_load_dwordx4 v254, s[16:19], s54 offen lds
  v_mul_f32 v52, v192, v52
  v_mul_f32 v53, v192, v53
  v_mul_f32 v54, v192, v54
  v_mul_f32 v55, v192, v55
  s_waitcnt lgkmcnt(3)
  v_mfma_f32_32x32x16_bf16 v[80:95], a[168:171], v[148:151], v[80:95]
  ds_read_b128 v[144:147], v2 offset:41984
  v_cvt_pk_bf16_f32 v164, v64, v65
  v_cvt_pk_bf16_f32 v165, v66, v67
  v_exp_f32 v52, v52
  v_mfma_f32_32x32x16_bf16 v[96:111], a[172:175], v[148:151], v[96:111]
  s_add_u32 m0, s81, 6144
  s_add_u32 s54, s84, 327680
  buffer_load_dwordx4 v254, s[16:19], s54 offen lds
  v_exp_f32 v53, v53
  v_exp_f32 v54, v54
  s_waitcnt lgkmcnt(3)
  v_mfma_f32_32x32x16_bf16 v[80:95], a[176:179], v[152:155], v[80:95]
  ds_read_b128 v[148:151], v2 offset:43008
  v_exp_f32 v55, v55
  v_fma_f32 v52, v52, v193, v193
  v_fma_f32 v53, v53, v193, v193
  v_mfma_f32_32x32x16_bf16 v[96:111], a[180:183], v[152:155], v[96:111]
  s_add_u32 m0, s87, 34816
  s_add_u32 s54, s84, 180224
  buffer_load_dwordx4 v254, s[16:19], s54 offen lds
  v_fma_f32 v54, v54, v193, v193
  v_fma_f32 v55, v55, v193, v193
  v_rcp_f32 v52, v52
  s_waitcnt lgkmcnt(3)
  v_mfma_f32_32x32x16_bf16 v[80:95], a[184:187], v[156:159], v[80:95]
  ds_read_b128 v[152:155], v2 offset:44032
  v_rcp_f32 v53, v53
  v_rcp_f32 v54, v54
  v_mfma_f32_32x32x16_bf16 v[96:111], a[188:191], v[156:159], v[96:111]
  s_add_u32 m0, s81, 7168
  s_add_u32 s54, s84, 335872
  buffer_load_dwordx4 v254, s[16:19], s54 offen lds
  v_rcp_f32 v55, v55
  v_mul_f32 v68, v68, v52
  v_mul_f32 v69, v69, v53
  s_waitcnt lgkmcnt(3)
  v_mfma_f32_32x32x16_bf16 v[80:95], a[192:195], v[160:163], v[80:95]
  ds_read_b128 v[156:159], v2 offset:45056
  v_mul_f32 v70, v70, v54
  v_mul_f32 v71, v71, v55
  v_mul_f32 v56, v192, v56
  v_mul_f32 v57, v192, v57
  v_mfma_f32_32x32x16_bf16 v[96:111], a[196:199], v[160:163], v[96:111]
  s_add_u32 m0, s87, 35840
  s_add_u32 s54, s84, 188416
  buffer_load_dwordx4 v254, s[16:19], s54 offen lds
  v_mul_f32 v58, v192, v58
  v_mul_f32 v59, v192, v59
  v_cvt_pk_bf16_f32 v166, v68, v69
  v_cvt_pk_bf16_f32 v167, v70, v71
  s_waitcnt lgkmcnt(3)
  v_mfma_f32_32x32x16_bf16 v[80:95], a[200:203], v[144:147], v[80:95]
  ds_read_b128 v[160:163], v2 offset:46080
  v_exp_f32 v56, v56
  v_exp_f32 v57, v57
  v_mfma_f32_32x32x16_bf16 v[96:111], a[204:207], v[144:147], v[96:111]
  s_add_u32 m0, s83, 0
  s_add_u32 s54, s84, 409600
  buffer_load_dwordx4 v254, s[16:19], s54 offen lds
  v_exp_f32 v58, v58
  v_exp_f32 v59, v59
  s_waitcnt lgkmcnt(3)
  v_mfma_f32_32x32x16_bf16 v[80:95], a[208:211], v[148:151], v[80:95]
  ds_read_b128 v[144:147], v2 offset:47104
  s_cmp_eq_u32 s32, 0
  s_cbranch_scc1 Ls_53
  buffer_store_dwordx4 v[164:167], v2, s[20:23], s63 offen nt
Lb_54:
  v_fma_f32 v56, v56, v193, v193
  v_fma_f32 v57, v57, v193, v193
  v_mfma_f32_32x32x16_bf16 v[96:111], a[212:215], v[148:151], v[96:111]
  s_add_u32 m0, s87, 36864
  s_add_u32 s54, s84, 196608
  buffer_load_dwordx4 v254, s[16:19], s54 offen lds
  v_fma_f32 v58, v58, v193, v193
  v_fma_f32 v59, v59, v193, v193
  v_rcp_f32 v56, v56
  s_waitcnt lgkmcnt(3)
  v_mfma_f32_32x32x16_bf16 v[80:95], a[216:219], v[152:155], v[80:95]
  ds_read_b128 v[148:151], v2 offset:48128
  v_rcp_f32 v57, v57
  v_rcp_f32 v58, v58
  v_mfma_f32_32x32x16_bf16 v[96:111], a[220:223], v[152:155], v[96:111]
  s_add_u32 m0, s83, 1024
  s_add_u32 s54, s84, 417792
  buffer_load_dwordx4 v254, s[16:19], s54 offen lds
  v_rcp_f32 v59, v59
  v_mul_f32 v72, v72, v56
  v_mul_f32 v73, v73, v57
  s_waitcnt lgkmcnt(3)
  v_mfma_f32_32x32x16_bf16 v[80:95], a[224:227], v[156:159], v[80:95]
  ds_read_b128 v[152:155], v2 offset:49152
  v_mul_f32 v74, v74, v58
  v_mul_f32 v75, v75, v59
  v_mul_f32 v60, v192, v60
  v_mul_f32 v61, v192, v61
  v_mfma_f32_32x32x16_bf16 v[96:111], a[228:231], v[156:159], v[96:111]
  s_add_u32 m0, s87, 37888
  s_add_u32 s54, s84, 204800
  buffer_load_dwordx4 v254, s[16:19], s54 offen lds
  v_mul_f32 v62, v192, v62
  v_mul_f32 v63, v192, v63
  v_cvt_pk_bf16_f32 v168, v72, v73
  v_cvt_pk_bf16_f32 v169, v74, v75
  s_waitcnt lgkmcnt(3)
  v_mfma_f32_32x32x16_bf16 v[80:95], a[232:235], v[160:163], v[80:95]
  ds_read_b128 v[156:159], v2 offset:50176
  v_exp_f32 v60, v60
  v_exp_f32 v61, v61
  v_mfma_f32_32x32x16_bf16 v[96:111], a[236:239], v[160:163], v[96:111]
  buffer_load_dwordx4 v[172:175], v2, s[20:23], s99 offen offset:0 sc1
  v_exp_f32 v62, v62
  v_exp_f32 v63, v63
  s_waitcnt lgkmcnt(3)
  v_mfma_f32_32x32x16_bf16 v[80:95], a[240:243], v[144:147], v[80:95]
  ds_read_b128 v[160:163], v2 offset:51200
  v_fma_f32 v60, v60, v193, v193
  v_fma_f32 v61, v61, v193, v193
  v_fma_f32 v62, v62, v193, v193
  v_fma_f32 v63, v63, v193, v193
  v_mfma_f32_32x32x16_bf16 v[96:111], a[244:247], v[144:147], v[96:111]
  s_add_u32 m0, s87, 38912
  s_add_u32 s54, s84, 212992
  buffer_load_dwordx4 v254, s[16:19], s54 offen lds
  v_rcp_f32 v60, v60
  v_rcp_f32 v61, v61
  s_waitcnt lgkmcnt(3)
  v_mfma_f32_32x32x16_bf16 v[80:95], a[248:251], v[148:151], v[80:95]
  ds_read_b128 v[144:147], v2 offset:52224
  v_rcp_f32 v62, v62
  v_rcp_f32 v63, v63
  v_mfma_f32_32x32x16_bf16 v[96:111], a[252:255], v[148:151], v[96:111]
  buffer_load_dwordx4 v[176:179], v2, s[20:23], s99 offen offset:1024 sc1
  v_mul_f32 v76, v76, v60
  v_mul_f32 v77, v77, v61
  v_mul_f32 v78, v78, v62
  v_mul_f32 v79, v79, v63
  v_mfma_f32_32x32x16_bf16 v[80:95], v[4:7], v[184:187], v[80:95]
  v_mfma_f32_32x32x16_bf16 v[96:111], v[8:11], v[184:187], v[96:111]
  s_waitcnt lgkmcnt(3)
  v_mfma_f32_32x32x16_bf16 v[112:127], a[128:131], v[152:155], v[112:127]
  ds_read_b128 v[148:151], v2 offset:53248
  v_cvt_pk_bf16_f32 v170, v76, v77
  v_cvt_pk_bf16_f32 v171, v78, v79
  v_mfma_f32_32x32x16_bf16 v[128:143], a[132:135], v[152:155], v[128:143]
  s_add_u32 m0, s87, 39936
  s_add_u32 s54, s84, 221184
  buffer_load_dwordx4 v254, s[16:19], s54 offen lds
  s_cmp_eq_u32 s32, 0
  s_cbranch_scc1 Ls_55
  buffer_store_dwordx4 v[168:171], v2, s[20:23], s63 offen offset:1024 nt
Lb_56:
  s_waitcnt lgkmcnt(3)
  v_mfma_f32_32x32x16_bf16 v[112:127], a[136:139], v[156:159], v[112:127]
  ds_read_b128 v[152:155], v2 offset:54272
  v_mul_f32 v80, v194, v80
  v_mul_f32 v81, v194, v81
  v_mul_f32 v82, v194, v82
  v_mul_f32 v83, v194, v83
  v_mfma_f32_32x32x16_bf16 v[128:143], a[140:143], v[156:159], v[128:143]
  v_exp_f32 v80, v80
  v_exp_f32 v81, v81
  v_exp_f32 v82, v82
  s_waitcnt lgkmcnt(3)
  v_mfma_f32_32x32x16_bf16 v[112:127], a[144:147], v[160:163], v[112:127]
  ds_read_b128 v[156:159], v2 offset:55296
  v_exp_f32 v83, v83
  v_fma_f32 v80, v80, v195, v195
  v_fma_f32 v81, v81, v195, v195
  v_mfma_f32_32x32x16_bf16 v[128:143], a[148:151], v[160:163], v[128:143]
  v_fma_f32 v82, v82, v195, v195
  v_fma_f32 v83, v83, v195, v195
  v_rcp_f32 v80, v80
  v_rcp_f32 v81, v81
  s_waitcnt lgkmcnt(3)
  v_mfma_f32_32x32x16_bf16 v[112:127], a[152:155], v[144:147], v[112:127]
  ds_read_b128 v[160:163], v2 offset:56320
  v_rcp_f32 v82, v82
  v_rcp_f32 v83, v83
  v_mfma_f32_32x32x16_bf16 v[128:143], a[156:159], v[144:147], v[128:143]
  v_mul_f32 v96, v96, v80
  v_mul_f32 v97, v97, v81
  v_mul_f32 v98, v98, v82
  v_mul_f32 v99, v99, v83
  v_mul_f32 v84, v194, v84
  v_mul_f32 v85, v194, v85
  s_waitcnt lgkmcnt(3)
  v_mfma_f32_32x32x16_bf16 v[112:127], a[160:163], v[148:151], v[112:127]
  ds_read_b128 v[144:147], v2 offset:57344
  v_mul_f32 v86, v194, v86
  v_mul_f32 v87, v194, v87
  v_cvt_pk_bf16_f32 v164, v96, v97
  v_cvt_pk_bf16_f32 v165, v98, v99
  v_mfma_f32_32x32x16_bf16 v[128:143], a[164:167], v[148:151], v[128:143]
  v_exp_f32 v84, v84
  v_exp_f32 v85, v85
  v_exp_f32 v86, v86
  s_waitcnt lgkmcnt(3)
  v_mfma_f32_32x32x16_bf16 v[112:127], a[168:171], v[152:155], v[112:127]
  ds_read_b128 v[148:151], v2 offset:58368
  v_exp_f32 v87, v87
  v_fma_f32 v84, v84, v195, v195
  v_fma_f32 v85, v85, v195, v195
  v_mfma_f32_32x32x16_bf16 v[128:143], a[172:175], v[152:155], v[128:143]
  v_fma_f32 v86, v86, v195, v195
  v_fma_f32 v87, v87, v195, v195
  v_rcp_f32 v84, v84
  v_rcp_f32 v85, v85
  s_waitcnt lgkmcnt(3)
  v_mfma_f32_32x32x16_bf16 v[112:127], a[176:179], v[156:159], v[112:127]
  ds_read_b128 v[152:155], v2 offset:59392
  v_rcp_f32 v86, v86
  v_rcp_f32 v87, v87
  v_mfma_f32_32x32x16_bf16 v[128:143], a[180:183], v[156:159], v[128:143]
  v_mul_f32 v100, v100, v84
  v_mul_f32 v101, v101, v85
  v_mul_f32 v102, v102, v86
  v_mul_f32 v103, v103, v87
  v_mul_f32 v88, v194, v88
  s_waitcnt lgkmcnt(3)
  v_mfma_f32_32x32x16_bf16 v[112:127], a[184:187], v[160:163], v[112:127]
  ds_read_b128 v[156:159], v2 offset:60416
  v_mul_f32 v89, v194, v89
  v_mul_f32 v90, v194, v90
  v_mul_f32 v91, v194, v91
  v_cvt_pk_bf16_f32 v166, v100, v101
  v_mfma_f32_32x32x16_bf16 v[128:143], a[188:191], v[160:163], v[128:143]
  v_cvt_pk_bf16_f32 v167, v102, v103
  v_exp_f32 v88, v88
  v_exp_f32 v89, v89
  s_waitcnt lgkmcnt(3)
  v_mfma_f32_32x32x16_bf16 v[112:127], a[192:195], v[144:147], v[112:127]
  ds_read_b128 v[160:163], v2 offset:61440
  v_exp_f32 v90, v90
  v_exp_f32 v91, v91
  v_mfma_f32_32x32x16_bf16 v[128:143], a[196:199], v[144:147], v[128:143]
  s_cmp_eq_u32 s32, 0
  s_cbranch_scc1 Ls_57
  buffer_store_dwordx4 v[164:167], v2, s[20:23], s64 offen nt
Lb_58:
  v_fma_f32 v88, v88, v195, v195
  v_fma_f32 v89, v89, v195, v195
  v_fma_f32 v90, v90, v195, v195
  v_fma_f32 v91, v91, v195, v195
  s_waitcnt vmcnt(1)
  v_mov_b32 v14, s31
  v_mov_b32 v15, 65536
  s_mov_b64 exec, 1
  s_cmp_eq_u32 s32, 0
  s_cbranch_scc1 Ls_59
  buffer_store_dword v14, v15, s[20:23], s80 offen
Lb_60:
  s_mov_b64 exec, -1
  s_barrier
  s_waitcnt lgkmcnt(3)
  v_mfma_f32_32x32x16_bf16 v[112:127], a[200:203], v[148:151], v[112:127]
  ds_read_b128 v[144:147], v2 offset:62464
  v_rcp_f32 v88, v88
  v_rcp_f32 v89, v89
  v_mfma_f32_32x32x16_bf16 v[128:143], a[204:207], v[148:151], v[128:143]
  s_add_u32 m0, s82, 0
  s_add_u32 s54, s84, 344064
  buffer_load_dwordx4 v254, s[16:19], s54 offen lds
  v_rcp_f32 v90, v90
  v_rcp_f32 v91, v91
  s_waitcnt lgkmcnt(3)
  v_mfma_f32_32x32x16_bf16 v[112:127], a[208:211], v[152:155], v[112:127]
  ds_read_b128 v[148:151], v2 offset:63488
  v_mul_f32 v104, v104, v88
  v_mul_f32 v105, v105, v89
  v_mul_f32 v106, v106, v90
  v_mul_f32 v107, v107, v91
  v_mfma_f32_32x32x16_bf16 v[128:143], a[212:215], v[152:155], v[128:143]
  s_add_u32 m0, s82, 1024
  s_add_u32 s54, s84, 352256
  buffer_load_dwordx4 v254, s[16:19], s54 offen lds
  v_mul_f32 v92, v194, v92
  v_mul_f32 v93, v194, v93
  v_mul_f32 v94, v194, v94
  v_mul_f32 v95, v194, v95
  s_waitcnt lgkmcnt(3)
  v_mfma_f32_32x32x16_bf16 v[112:127], a[216:219], v[156:159], v[112:127]
  ds_read_b128 v[152:155], v2 offset:64512
  v_cvt_pk_bf16_f32 v168, v104, v105
  v_cvt_pk_bf16_f32 v169, v106, v107
  v_exp_f32 v92, v92
  v_mfma_f32_32x32x16_bf16 v[128:143], a[220:223], v[156:159], v[128:143]
  s_add_u32 m0, s82, 2048
  s_add_u32 s54, s84, 360448
  buffer_load_dwordx4 v254, s[16:19], s54 offen lds
  v_exp_f32 v93, v93
  v_exp_f32 v94, v94
  s_waitcnt lgkmcnt(3)
  v_mfma_f32_32x32x16_bf16 v[112:127], a[224:227], v[160:163], v[112:127]
  v_exp_f32 v95, v95
  v_fma_f32 v92, v92, v195, v195
  v_fma_f32 v93, v93, v195, v195
  v_fma_f32 v94, v94, v195, v195
  v_fma_f32 v95, v95, v195, v195
  v_mfma_f32_32x32x16_bf16 v[128:143], a[228:231], v[160:163], v[128:143]
  s_add_u32 m0, s82, 3072
  s_add_u32 s54, s84, 368640
  buffer_load_dwordx4 v254, s[16:19], s54 offen lds
  v_rcp_f32 v92, v92
  v_rcp_f32 v93, v93
  s_waitcnt lgkmcnt(2)
  v_mfma_f32_32x32x16_bf16 v[112:127], a[232:235], v[144:147], v[112:127]
  v_rcp_f32 v94, v94
  v_rcp_f32 v95, v95
  v_mul_f32 v108, v108, v92
  v_mul_f32 v109, v109, v93
  v_mfma_f32_32x32x16_bf16 v[128:143], a[236:239], v[144:147], v[128:143]
  v_mul_f32 v110, v110, v94
  v_mul_f32 v111, v111, v95
  v_cvt_pk_bf16_f32 v170, v108, v109
  v_cvt_pk_bf16_f32 v171, v110, v111
  s_waitcnt lgkmcnt(1)
  v_mfma_f32_32x32x16_bf16 v[112:127], a[240:243], v[148:151], v[112:127]
  s_cmp_eq_u32 s32, 0
  s_cbranch_scc1 Ls_61
  buffer_store_dwordx4 v[168:171], v2, s[20:23], s64 offen offset:1024 nt
Lb_62:
  v_mfma_f32_32x32x16_bf16 v[128:143], a[244:247], v[148:151], v[128:143]
  s_waitcnt lgkmcnt(0)
  v_mfma_f32_32x32x16_bf16 v[112:127], a[248:251], v[152:155], v[112:127]
  v_mfma_f32_32x32x16_bf16 v[128:143], a[252:255], v[152:155], v[128:143]
  buffer_load_dword v13, v12, s[20:23], s90 offen sc1
  v_mfma_f32_32x32x16_bf16 v[112:127], v[4:7], v[186:189], v[112:127]
  v_mfma_f32_32x32x16_bf16 v[128:143], v[8:11], v[186:189], v[128:143]
  v_lshrrev_b32 v14, 5, v1
  v_bfe_u32 v15, v1, 2, 2
  v_lshl_add_u32 v14, v14, 3, v15
  v_lshlrev_b32 v14, 7, v14
  v_bfe_u32 v16, v1, 4, 1
  v_and_b32 v17, 1, v1
  v_lshl_add_u32 v16, v16, 1, v17
  v_bfe_u32 v15, v1, 3, 1
  v_xor_b32 v15, s52, v15
  v_lshl_add_u32 v16, v15, 2, v16
  v_lshl_add_u32 v14, v16, 4, v14
  v_bfe_u32 v17, v1, 1, 1
  v_lshl_add_u32 v14, v17, 3, v14
  v_xor_b32 v15, 64, v14
  v_add_u32 v180, s87, v14
  v_add_u32 v181, s81, v14
  v_add_u32 v182, s82, v14
  v_add_u32 v183, s83, v14
  v_add_u32 v184, s88, v14
  v_add_u32 v185, s87, v15
  v_add_u32 v186, s81, v15
  v_add_u32 v187, s82, v15
  v_add_u32 v188, s83, v15
  v_add_u32 v189, s88, v15
  s_mul_i32 s55, s30, 28672
  s_add_u32 s55, s55, s45
  s_mul_i32 s57, s33, 6144
  s_sub_u32 s58, 6144, s57
  s_mul_i32 s91, s51, 114688
  s_add_u32 s91, s91, s55
  s_add_u32 s92, s91, s57
  s_add_u32 s93, s91, s58
  s_mul_i32 s94, s53, 114688
  s_add_u32 s94, s94, s55
  s_add_u32 s95, s94, s57
  s_add_u32 s77, s94, s58
  v_mul_f32 v112, v196, v112
  s_waitcnt vmcnt(0)
  v_subrev_u32 v14, s31, v13
  v_cmp_lt_u32 vcc, 1, v14
  s_cbranch_vccnz Lpf_63
Lpb_64:
  buffer_load_dwordx4 v[144:147], v2, s[20:23], s92 offen offset:0 sc1
  v_mul_f32 v113, v196, v113
  v_mul_f32 v114, v196, v114
  v_mul_f32 v115, v196, v115
  v_exp_f32 v112, v112
  v_exp_f32 v113, v113
  v_exp_f32 v114, v114
  v_exp_f32 v115, v115
  v_fma_f32 v112, v112, v197, v197
  v_fma_f32 v113, v113, v197, v197
  buffer_load_dwordx4 v[148:151], v2, s[20:23], s92 offen offset:1024 sc1
  v_fma_f32 v114, v114, v197, v197
  v_fma_f32 v115, v115, v197, v197
  v_rcp_f32 v112, v112
  v_rcp_f32 v113, v113
  v_rcp_f32 v114, v114
  v_rcp_f32 v115, v115
  v_mul_f32 v128, v128, v112
  v_mul_f32 v129, v129, v113
  v_mul_f32 v130, v130, v114
  buffer_load_dwordx4 v[152:155], v2, s[20:23], s92 offen offset:2048 sc1
  v_mul_f32 v131, v131, v115
  v_mul_f32 v116, v196, v116
  v_mul_f32 v117, v196, v117
  v_mul_f32 v118, v196, v118
  v_mul_f32 v119, v196, v119
  v_cvt_pk_bf16_f32 v164, v128, v129
  v_cvt_pk_bf16_f32 v165, v130, v131
  v_exp_f32 v116, v116
  v_exp_f32 v117, v117
  buffer_load_dwordx4 v[156:159], v2, s[20:23], s92 offen offset:3072 sc1
  v_exp_f32 v118, v118
  v_exp_f32 v119, v119
  v_fma_f32 v116, v116, v197, v197
  v_fma_f32 v117, v117, v197, v197
  v_fma_f32 v118, v118, v197, v197
  v_fma_f32 v119, v119, v197, v197
  v_rcp_f32 v116, v116
  v_rcp_f32 v117, v117
  v_rcp_f32 v118, v118
  s_add_u32 s57, s92, 4096
  buffer_load_dwordx4 v[160:163], v2, s[20:23], s57 offen offset:0 sc1
  v_rcp_f32 v119, v119
  v_mul_f32 v132, v132, v116
  v_mul_f32 v133, v133, v117
  v_mul_f32 v134, v134, v118
  v_mul_f32 v135, v135, v119
  v_mul_f32 v120, v196, v120
  v_mul_f32 v121, v196, v121
  v_mul_f32 v122, v196, v122
  v_mul_f32 v123, v196, v123
  s_add_u32 s57, s92, 4096
  buffer_load_dwordx4 v[248:251], v2, s[20:23], s57 offen offset:1024 sc1
  v_cvt_pk_bf16_f32 v166, v132, v133
  v_cvt_pk_bf16_f32 v167, v134, v135
  v_exp_f32 v120, v120
  v_exp_f32 v121, v121
  v_exp_f32 v122, v122
  v_exp_f32 v123, v123
  s_cmp_eq_u32 s32, 0
  s_cbranch_scc1 Ls_67
  buffer_store_dwordx4 v[164:167], v2, s[20:23], s65 offen nt
Lb_68:
  v_fma_f32 v120, v120, v197, v197
  v_fma_f32 v121, v121, v197, v197
  s_add_u32 s57, s91, 16384
  buffer_load_dwordx4 v[80:83], v2, s[20:23], s57 offen offset:1024 sc1
  v_fma_f32 v122, v122, v197, v197
  v_fma_f32 v123, v123, v197, v197
  v_rcp_f32 v120, v120
  v_rcp_f32 v121, v121
  v_rcp_f32 v122, v122
  v_rcp_f32 v123, v123
  v_mul_f32 v136, v136, v120
  v_mul_f32 v137, v137, v121
  v_mul_f32 v138, v138, v122
  s_add_u32 s57, s91, 16384
  buffer_load_dwordx4 v[84:87], v2, s[20:23], s57 offen offset:2048 sc1
  v_mul_f32 v139, v139, v123
  v_mul_f32 v124, v196, v124
  v_mul_f32 v125, v196, v125
  v_mul_f32 v126, v196, v126
  v_mul_f32 v127, v196, v127
  v_cvt_pk_bf16_f32 v168, v136, v137
  v_cvt_pk_bf16_f32 v169, v138, v139
  v_exp_f32 v124, v124
  v_exp_f32 v125, v125
  buffer_load_dwordx4 v[88:91], v2, s[20:23], s93 offen offset:0 sc1
  v_exp_f32 v126, v126
  v_exp_f32 v127, v127
  v_fma_f32 v124, v124, v197, v197
  v_fma_f32 v125, v125, v197, v197
  v_fma_f32 v126, v126, v197, v197
  v_fma_f32 v127, v127, v197, v197
  v_rcp_f32 v124, v124
  v_rcp_f32 v125, v125
  v_rcp_f32 v126, v126
  buffer_load_dwordx4 v[92:95], v2, s[20:23], s93 offen offset:1024 sc1
  v_rcp_f32 v127, v127
  v_mul_f32 v140, v140, v124
  v_mul_f32 v141, v141, v125
  v_mul_f32 v142, v142, v126
  v_mul_f32 v143, v143, v127
  v_cvt_pk_bf16_f32 v170, v140, v141
  v_cvt_pk_bf16_f32 v171, v142, v143
  s_cmp_eq_u32 s32, 0
  s_cbranch_scc1 Ls_69
  buffer_store_dwordx4 v[168:171], v2, s[20:23], s65 offen offset:1024 nt
Lb_70:
  s_mov_b32 s89, s32
  s_branch L_b1done
L_b1l1:
  v_lshlrev_b32 v198, 2, v1
  v_add_u32 v198, 159744, v198
  s_lshl_b32 s54, s30, 10
  s_add_u32 s54, s54, 159744
  v_add_u32 v199, s54, v2
  v_lshrrev_b32 v12, 5, v1
  v_bfe_u32 v13, v1, 2, 2
  v_lshl_add_u32 v12, v12, 3, v13
  v_lshlrev_b32 v12, 7, v12
  v_bfe_u32 v14, v1, 4, 1
  v_and_b32 v15, 1, v1
  v_lshl_add_u32 v14, v14, 1, v15
  v_bfe_u32 v13, v1, 3, 1
  v_xor_b32 v13, s52, v13
  v_lshl_add_u32 v14, v13, 2, v14
  v_lshl_add_u32 v12, v14, 4, v12
  v_bfe_u32 v15, v1, 1, 1
  v_lshl_add_u32 v12, v15, 3, v12
  v_xor_b32 v13, 64, v12
  v_add_u32 v249, s88, v12
  v_add_u32 v251, s88, v13
  v_add_u32 v248, s87, v12
  v_add_u32 v250, s87, v13
  ds_read_b128 v[144:147], v2 offset:0
  ds_read_b128 v[148:151], v2 offset:1024
  ds_read_b128 v[152:155], v2 offset:2048
  ds_read_b128 v[156:159], v2 offset:3072
  s_waitcnt lgkmcnt(3)
  v_mfma_f32_32x32x16_bf16 v[16:31], a[0:3], v[144:147], 0
  ds_read_b128 v[160:163], v2 offset:4096
  v_mfma_f32_32x32x16_bf16 v[32:47], a[4:7], v[144:147], 0
  buffer_load_dwordx4 v[164:167], v2, s[20:23], s59 offen offset:0 sc1
  s_waitcnt lgkmcnt(3)
  v_mfma_f32_32x32x16_bf16 v[16:31], a[8:11], v[148:151], v[16:31]
  ds_read_b128 v[144:147], v2 offset:5120
  v_mfma_f32_32x32x16_bf16 v[32:47], a[12:15], v[148:151], v[32:47]
  s_waitcnt lgkmcnt(3)
  v_mfma_f32_32x32x16_bf16 v[16:31], a[16:19], v[152:155], v[16:31]
  ds_read_b128 v[148:151], v2 offset:6144
  buffer_load_dwordx4 v[168:171], v2, s[20:23], s59 offen offset:1024 sc1
  v_mfma_f32_32x32x16_bf16 v[32:47], a[20:23], v[152:155], v[32:47]
  s_waitcnt lgkmcnt(3)
  v_mfma_f32_32x32x16_bf16 v[16:31], a[24:27], v[156:159], v[16:31]
  ds_read_b128 v[152:155], v2 offset:7168
  v_mfma_f32_32x32x16_bf16 v[32:47], a[28:31], v[156:159], v[32:47]
  buffer_load_dwordx4 v[172:175], v2, s[20:23], s59 offen offset:2048 sc1
  s_waitcnt lgkmcnt(3)
  v_mfma_f32_32x32x16_bf16 v[16:31], a[32:35], v[160:163], v[16:31]
  ds_read_b128 v[156:159], v2 offset:8192
  v_mfma_f32_32x32x16_bf16 v[32:47], a[36:39], v[160:163], v[32:47]
  s_waitcnt lgkmcnt(3)
  v_mfma_f32_32x32x16_bf16 v[16:31], a[40:43], v[144:147], v[16:31]
  ds_read_b128 v[160:163], v2 offset:9216
  buffer_load_dwordx4 v[176:179], v2, s[20:23], s59 offen offset:3072 sc1
  v_mfma_f32_32x32x16_bf16 v[32:47], a[44:47], v[144:147], v[32:47]
  s_waitcnt lgkmcnt(3)
  v_mfma_f32_32x32x16_bf16 v[16:31], a[48:51], v[148:151], v[16:31]
  ds_read_b128 v[144:147], v2 offset:10240
  v_mfma_f32_32x32x16_bf16 v[32:47], a[52:55], v[148:151], v[32:47]
  s_waitcnt lgkmcnt(3)
  v_mfma_f32_32x32x16_bf16 v[16:31], a[56:59], v[152:155], v[16:31]
  ds_read_b128 v[148:151], v2 offset:11264
  s_add_u32 m0, s81, 32768
  s_add_u32 s58, s96, 0
  buffer_load_dwordx4 v2, s[20:23], s58 offen sc1 lds
  v_mfma_f32_32x32x16_bf16 v[32:47], a[60:63], v[152:155], v[32:47]
  s_waitcnt lgkmcnt(3)
  v_mfma_f32_32x32x16_bf16 v[48:63], a[0:3], v[156:159], 0
  ds_read_b128 v[152:155], v2 offset:12288
  v_mfma_f32_32x32x16_bf16 v[64:79], a[4:7], v[156:159], 0
  s_waitcnt lgkmcnt(3)
  v_mfma_f32_32x32x16_bf16 v[48:63], a[8:11], v[160:163], v[48:63]
  ds_read_b128 v[156:159], v2 offset:13312
  s_add_u32 m0, s81, 33792
  s_add_u32 s58, s96, 1024
  buffer_load_dwordx4 v2, s[20:23], s58 offen sc1 lds
  v_mfma_f32_32x32x16_bf16 v[64:79], a[12:15], v[160:163], v[64:79]
  s_waitcnt lgkmcnt(3)
  v_mfma_f32_32x32x16_bf16 v[48:63], a[16:19], v[144:147], v[48:63]
  ds_read_b128 v[160:163], v2 offset:14336
  v_mfma_f32_32x32x16_bf16 v[64:79], a[20:23], v[144:147], v[64:79]
  s_waitcnt lgkmcnt(3)
  v_mfma_f32_32x32x16_bf16 v[48:63], a[24:27], v[148:151], v[48:63]
  ds_read_b128 v[144:147], v2 offset:15360
  s_add_u32 m0, s81, 34816
  s_add_u32 s58, s96, 2048
  buffer_load_dwordx4 v2, s[20:23], s58 offen sc1 lds
  v_mfma_f32_32x32x16_bf16 v[64:79], a[28:31], v[148:151], v[64:79]
  s_waitcnt lgkmcnt(3)
  v_mfma_f32_32x32x16_bf16 v[48:63], a[32:35], v[152:155], v[48:63]
  ds_read_b128 v[148:151], v2 offset:16384
  v_mfma_f32_32x32x16_bf16 v[64:79], a[36:39], v[152:155], v[64:79]
  s_waitcnt lgkmcnt(3)
  v_mfma_f32_32x32x16_bf16 v[48:63], a[40:43], v[156:159], v[48:63]
  ds_read_b128 v[152:155], v2 offset:17408
  s_add_u32 m0, s81, 35840
  s_add_u32 s58, s96, 3072
  buffer_load_dwordx4 v2, s[20:23], s58 offen sc1 lds
  v_mfma_f32_32x32x16_bf16 v[64:79], a[44:47], v[156:159], v[64:79]
  s_waitcnt lgkmcnt(3)
  v_mfma_f32_32x32x16_bf16 v[48:63], a[48:51], v[160:163], v[48:63]
  ds_read_b128 v[156:159], v2 offset:18432
  v_mfma_f32_32x32x16_bf16 v[64:79], a[52:55], v[160:163], v[64:79]
  s_waitcnt lgkmcnt(3)
  v_mfma_f32_32x32x16_bf16 v[48:63], a[56:59], v[144:147], v[48:63]
  ds_read_b128 v[160:163], v2 offset:19456
  s_add_u32 m0, s81, 36864
  s_add_u32 s58, s96, 4096
  buffer_load_dwordx4 v2, s[20:23], s58 offen sc1 lds
  v_mfma_f32_32x32x16_bf16 v[64:79], a[60:63], v[144:147], v[64:79]
  s_waitcnt lgkmcnt(3)
  v_mfma_f32_32x32x16_bf16 v[80:95], a[0:3], v[148:151], 0
  ds_read_b128 v[144:147], v2 offset:20480
  v_mfma_f32_32x32x16_bf16 v[96:111], a[4:7], v[148:151], 0
  s_waitcnt lgkmcnt(3)
  v_mfma_f32_32x32x16_bf16 v[80:95], a[8:11], v[152:155], v[80:95]
  ds_read_b128 v[148:151], v2 offset:21504
  s_add_u32 m0, s81, 37888
  s_add_u32 s58, s96, 5120
  buffer_load_dwordx4 v2, s[20:23], s58 offen sc1 lds
  s_waitcnt vmcnt(6)
  v_add_f32 v164, v164, v172
  v_mfma_f32_32x32x16_bf16 v[96:111], a[12:15], v[152:155], v[96:111]
  v_add_f32 v165, v165, v173
  v_add_f32 v166, v166, v174
  v_add_f32 v167, v167, v175
  s_waitcnt lgkmcnt(3)
  v_mfma_f32_32x32x16_bf16 v[80:95], a[16:19], v[156:159], v[80:95]
  ds_read_b128 v[152:155], v2 offset:22528
  ds_read_b64_tr_b16 v[200:201], v248 offset:0
  v_add_f32 v168, v168, v176
  v_mfma_f32_32x32x16_bf16 v[96:111], a[20:23], v[156:159], v[96:111]
  ds_read_b64_tr_b16 v[202:203], v248 offset:512
  s_waitcnt lgkmcnt(5)
  v_mfma_f32_32x32x16_bf16 v[80:95], a[24:27], v[160:163], v[80:95]
  ds_read_b128 v[156:159], v2 offset:23552
  ds_read_b64_tr_b16 v[204:205], v250 offset:0
  s_add_u32 m0, s81, 38912
  s_add_u32 s58, s96, 6144
  buffer_load_dwordx4 v2, s[20:23], s58 offen sc1 lds
  v_mfma_f32_32x32x16_bf16 v[96:111], a[28:31], v[160:163], v[96:111]
  ds_read_b64_tr_b16 v[206:207], v250 offset:512
  v_add_f32 v169, v169, v177
  v_add_f32 v170, v170, v178
  s_waitcnt lgkmcnt(7)
  v_mfma_f32_32x32x16_bf16 v[80:95], a[32:35], v[144:147], v[80:95]
  ds_read_b128 v[160:163], v2 offset:24576
  ds_read_b64_tr_b16 v[208:209], v248 offset:2048
  v_mfma_f32_32x32x16_bf16 v[96:111], a[36:39], v[144:147], v[96:111]
  ds_read_b64_tr_b16 v[210:211], v248 offset:2560
  v_add_f32 v171, v171, v179
  s_waitcnt lgkmcnt(9)
  v_mfma_f32_32x32x16_bf16 v[80:95], a[40:43], v[148:151], v[80:95]
  ds_read_b128 v[144:147], v2 offset:25600
  ds_read_b64_tr_b16 v[212:213], v250 offset:2048
  s_add_u32 m0, s81, 39936
  s_add_u32 s58, s96, 7168
  buffer_load_dwordx4 v2, s[20:23], s58 offen sc1 lds
  v_mfma_f32_32x32x16_bf16 v[96:111], a[44:47], v[148:151], v[96:111]
  ds_read_b64_tr_b16 v[214:215], v250 offset:2560
  v_add_f32 v164, v164, v168
  s_waitcnt lgkmcnt(11)
  v_mfma_f32_32x32x16_bf16 v[80:95], a[48:51], v[152:155], v[80:95]
  ds_read_b128 v[148:151], v2 offset:26624
  ds_read_b64_tr_b16 v[216:217], v248 offset:4096
  v_add_f32 v165, v165, v169
  v_mfma_f32_32x32x16_bf16 v[96:111], a[52:55], v[152:155], v[96:111]
  ds_read_b64_tr_b16 v[218:219], v248 offset:4608
  v_add_f32 v166, v166, v170
  s_waitcnt lgkmcnt(11)
  v_mfma_f32_32x32x16_bf16 v[80:95], a[56:59], v[156:159], v[80:95]
  ds_read_b128 v[152:155], v2 offset:27648
  ds_read_b64_tr_b16 v[220:221], v250 offset:4096
  v_add_f32 v167, v167, v171
  v_mfma_f32_32x32x16_bf16 v[96:111], a[60:63], v[156:159], v[96:111]
  ds_read_b64_tr_b16 v[222:223], v250 offset:4608
  s_waitcnt lgkmcnt(11)
  v_mfma_f32_32x32x16_bf16 v[112:127], a[0:3], v[160:163], 0
  ds_read_b128 v[156:159], v2 offset:28672
  ds_read_b64_tr_b16 v[224:225], v248 offset:6144
  v_mfma_f32_32x32x16_bf16 v[128:143], a[4:7], v[160:163], 0
  ds_read_b64_tr_b16 v[226:227], v248 offset:6656
  ds_write_b128 v199, v[164:167]
  s_waitcnt lgkmcnt(12)
  v_mfma_f32_32x32x16_bf16 v[112:127], a[8:11], v[144:147], v[112:127]
  ds_read_b128 v[160:163], v2 offset:29696
  ds_read_b64_tr_b16 v[228:229], v250 offset:6144
  v_mfma_f32_32x32x16_bf16 v[128:143], a[12:15], v[144:147], v[128:143]
  ds_read_b64_tr_b16 v[230:231], v250 offset:6656
  s_waitcnt lgkmcnt(12)
  v_mfma_f32_32x32x16_bf16 v[112:127], a[16:19], v[148:151], v[112:127]
  ds_read_b128 v[144:147], v2 offset:30720
  ds_read_b64_tr_b16 v[232:233], v248 offset:32768
  v_mfma_f32_32x32x16_bf16 v[128:143], a[20:23], v[148:151], v[128:143]
  ds_read_b64_tr_b16 v[234:235], v248 offset:33280
  s_waitcnt lgkmcnt(12)
  v_mfma_f32_32x32x16_bf16 v[112:127], a[24:27], v[152:155], v[112:127]
  ds_read_b128 v[148:151], v2 offset:31744
  ds_read_b64_tr_b16 v[236:237], v250 offset:32768
  v_mfma_f32_32x32x16_bf16 v[128:143], a[28:31], v[152:155], v[128:143]
  ds_read_b64_tr_b16 v[238:239], v250 offset:33280
  s_waitcnt lgkmcnt(12)
  v_mfma_f32_32x32x16_bf16 v[112:127], a[32:35], v[156:159], v[112:127]
  ds_read_b64_tr_b16 v[240:241], v248 offset:34816
  v_mfma_f32_32x32x16_bf16 v[128:143], a[36:39], v[156:159], v[128:143]
  ds_read_b64_tr_b16 v[242:243], v248 offset:35328
  s_waitcnt lgkmcnt(0)
  s_waitcnt vmcnt(0)
  s_barrier
  v_mfma_f32_32x32x16_bf16 v[112:127], a[40:43], v[160:163], v[112:127]
  ds_read_b128 v[152:155], v2 offset:32768
  ds_read_b64_tr_b16 v[244:245], v250 offset:34816
  s_add_u32 m0, s81, 0
  s_add_u32 s58, s97, 0
  buffer_load_dwordx4 v2, s[20:23], s58 offen sc1 lds
  v_mfma_f32_32x32x16_bf16 v[128:143], a[44:47], v[160:163], v[128:143]
  ds_read_b128 v[156:159], v2 offset:33792
  ds_read_b64_tr_b16 v[246:247], v250 offset:35328
  v_mfma_f32_32x32x16_bf16 v[112:127], a[48:51], v[144:147], v[112:127]
  ds_read_b128 v[160:163], v2 offset:34816
  v_mfma_f32_32x32x16_bf16 v[128:143], a[52:55], v[144:147], v[128:143]
  s_add_u32 m0, s81, 1024
  s_add_u32 s58, s97, 1024
  buffer_load_dwordx4 v2, s[20:23], s58 offen sc1 lds
  v_mfma_f32_32x32x16_bf16 v[112:127], a[56:59], v[148:151], v[112:127]
  ds_read_b128 v[144:147], v2 offset:35840
  s_waitcnt lgkmcnt(2)
  v_mfma_f32_32x32x16_bf16 v[128:143], a[60:63], v[148:151], v[128:143]
  v_mfma_f32_32x32x16_bf16 v[16:31], a[64:67], v[152:155], v[16:31]
  ds_read_b128 v[148:151], v2 offset:36864
  s_add_u32 m0, s81, 2048
  s_add_u32 s58, s97, 2048
  buffer_load_dwordx4 v2, s[20:23], s58 offen sc1 lds
  ds_read2st64_b32 v[164:165], v198 offset0:0 offset1:1
  ds_read2st64_b32 v[166:167], v198 offset0:2 offset1:3
  v_mfma_f32_32x32x16_bf16 v[32:47], a[68:71], v[152:155], v[32:47]
  ds_read2st64_b32 v[168:169], v198 offset0:4 offset1:5
  ds_read2st64_b32 v[170:171], v198 offset0:6 offset1:7
  ds_read2st64_b32 v[172:173], v198 offset0:8 offset1:9
  ds_read2st64_b32 v[174:175], v198 offset0:10 offset1:11
  ds_read2st64_b32 v[176:177], v198 offset0:12 offset1:13
  v_mfma_f32_32x32x16_bf16 v[16:31], a[72:75], v[156:159], v[16:31]
  ds_read_b128 v[152:155], v2 offset:37888
  ds_read2st64_b32 v[178:179], v198 offset0:14 offset1:15
  v_mfma_f32_32x32x16_bf16 v[32:47], a[76:79], v[156:159], v[32:47]
  s_add_u32 m0, s81, 3072
  s_add_u32 s58, s97, 3072
  buffer_load_dwordx4 v2, s[20:23], s58 offen sc1 lds
  s_waitcnt lgkmcnt(7)
  v_add_f32 v164, v164, v165
  v_mfma_f32_32x32x16_bf16 v[16:31], a[80:83], v[160:163], v[16:31]
  ds_read_b128 v[156:159], v2 offset:38912
  v_add_f32 v166, v166, v167
  v_mfma_f32_32x32x16_bf16 v[32:47], a[84:87], v[160:163], v[32:47]
  v_add_f32 v164, v164, v166
  v_mov_b32 v165, v164
  v_mfma_f32_32x32x16_bf16 v[16:31], a[88:91], v[144:147], v[16:31]
  ds_read_b128 v[160:163], v2 offset:39936
  s_add_u32 m0, s81, 4096
  s_add_u32 s58, s97, 4096
  buffer_load_dwordx4 v2, s[20:23], s58 offen sc1 lds
  s_nop 1
  v_permlane32_swap_b32 v164, v165
  v_mfma_f32_32x32x16_bf16 v[32:47], a[92:95], v[144:147], v[32:47]
  v_mul_f32 v166, 0xbb000000, v164
  v_mul_f32 v165, 0x3b000000, v165
  v_mfma_f32_32x32x16_bf16 v[16:31], a[96:99], v[148:151], v[16:31]
  ds_read_b128 v[144:147], v2 offset:40960
  v_cvt_pk_bf16_f32 v167, v166, v166
  v_mfma_f32_32x32x16_bf16 v[32:47], a[100:103], v[148:151], v[32:47]
  s_add_u32 m0, s81, 5120
  s_add_u32 s58, s97, 5120
  buffer_load_dwordx4 v2, s[20:23], s58 offen sc1 lds
  v_fma_f32 v165, -v166, v166, v165
  v_and_b32 v167, 0xffff0000, v167
  s_waitcnt lgkmcnt(4)
  v_mfma_f32_32x32x16_bf16 v[16:31], a[104:107], v[152:155], v[16:31]
  ds_read_b128 v[148:151], v2 offset:41984
  v_max_f32 v165, 0, v165
  v_mfma_f32_32x32x16_bf16 v[32:47], a[108:111], v[152:155], v[32:47]
  v_sub_f32 v167, v166, v167
  v_add_f32 v165, 0x3727c5ac, v165
  s_waitcnt lgkmcnt(3)
  v_mfma_f32_32x32x16_bf16 v[16:31], a[112:115], v[156:159], v[16:31]
  ds_read_b128 v[152:155], v2 offset:43008
  s_add_u32 m0, s81, 6144
  s_add_u32 s58, s97, 6144
  buffer_load_dwordx4 v2, s[20:23], s58 offen sc1 lds
  v_cvt_pk_bf16_f32 v180, v166, v167
  v_mfma_f32_32x32x16_bf16 v[32:47], a[116:119], v[156:159], v[32:47]
  v_rsq_f32 v164, v165
  v_mov_b32 v181, v180
  s_waitcnt lgkmcnt(3)
  v_mfma_f32_32x32x16_bf16 v[16:31], a[120:123], v[160:163], v[16:31]
  ds_read_b128 v[156:159], v2 offset:44032
  v_sqrt_f32 v191, v165
  v_mfma_f32_32x32x16_bf16 v[32:47], a[124:127], v[160:163], v[32:47]
  s_add_u32 m0, s81, 7168
  s_add_u32 s58, s97, 7168
  buffer_load_dwordx4 v2, s[20:23], s58 offen sc1 lds
  v_mul_f32 v190, 0xbfb8aa3b, v164
  s_waitcnt lgkmcnt(3)
  v_mfma_f32_32x32x16_bf16 v[48:63], a[64:67], v[144:147], v[48:63]
  ds_read_b128 v[160:163], v2 offset:45056
  v_add_f32 v168, v168, v169
  v_mfma_f32_32x32x16_bf16 v[64:79], a[68:71], v[144:147], v[64:79]
  v_add_f32 v170, v170, v171
  v_add_f32 v168, v168, v170
  s_waitcnt lgkmcnt(3)
  v_mfma_f32_32x32x16_bf16 v[48:63], a[72:75], v[148:151], v[48:63]
  ds_read_b128 v[144:147], v2 offset:46080
  s_add_u32 m0, s87, 0
  s_add_u32 s54, s84, 0
  buffer_load_dwordx4 v254, s[16:19], s54 offen lds
  v_mov_b32 v169, v168
  v_mfma_f32_32x32x16_bf16 v[64:79], a[76:79], v[148:151], v[64:79]
  s_nop 1
  v_permlane32_swap_b32 v168, v169
  v_mul_f32 v170, 0xbb000000, v168
  s_waitcnt lgkmcnt(3)
  v_mfma_f32_32x32x16_bf16 v[48:63], a[80:83], v[152:155], v[48:63]
  ds_read_b128 v[148:151], v2 offset:47104
  v_mul_f32 v169, 0x3b000000, v169
  v_mfma_f32_32x32x16_bf16 v[64:79], a[84:87], v[152:155], v[64:79]
  s_add_u32 m0, s87, 1024
  s_add_u32 s54, s84, 8192
  buffer_load_dwordx4 v254, s[16:19], s54 offen lds
  v_cvt_pk_bf16_f32 v171, v170, v170
  v_fma_f32 v169, -v170, v170, v169
  s_waitcnt lgkmcnt(3)
  v_mfma_f32_32x32x16_bf16 v[48:63], a[88:91], v[156:159], v[48:63]
  ds_read_b128 v[152:155], v2 offset:48128
  v_and_b32 v171, 0xffff0000, v171
  v_mfma_f32_32x32x16_bf16 v[64:79], a[92:95], v[156:159], v[64:79]
  v_max_f32 v169, 0, v169
  v_sub_f32 v171, v170, v171
  s_waitcnt lgkmcnt(3)
  v_mfma_f32_32x32x16_bf16 v[48:63], a[96:99], v[160:163], v[48:63]
  ds_read_b128 v[156:159], v2 offset:49152
  s_add_u32 m0, s87, 2048
  s_add_u32 s54, s84, 16384
  buffer_load_dwordx4 v254, s[16:19], s54 offen lds
  v_add_f32 v169, 0x3727c5ac, v169
  v_mfma_f32_32x32x16_bf16 v[64:79], a[100:103], v[160:163], v[64:79]
  v_cvt_pk_bf16_f32 v182, v170, v171
  v_rsq_f32 v168, v169
  s_waitcnt lgkmcnt(3)
  v_mfma_f32_32x32x16_bf16 v[48:63], a[104:107], v[144:147], v[48:63]
  ds_read_b128 v[160:163], v2 offset:50176
  v_mov_b32 v183, v182
  v_mfma_f32_32x32x16_bf16 v[64:79], a[108:111], v[144:147], v[64:79]
  s_add_u32 m0, s87, 3072
  s_add_u32 s54, s84, 24576
  buffer_load_dwordx4 v254, s[16:19], s54 offen lds
  v_sqrt_f32 v193, v169
  v_mul_f32 v192, 0xbfb8aa3b, v168
  s_waitcnt lgkmcnt(3)
  v_mfma_f32_32x32x16_bf16 v[48:63], a[112:115], v[148:151], v[48:63]
  ds_read_b128 v[144:147], v2 offset:51200
  v_mfma_f32_32x32x16_bf16 v[64:79], a[116:119], v[148:151], v[64:79]
  v_add_f32 v172, v172, v173
  v_add_f32 v174, v174, v175
  s_waitcnt lgkmcnt(3)
  v_mfma_f32_32x32x16_bf16 v[48:63], a[120:123], v[152:155], v[48:63]
  ds_read_b128 v[148:151], v2 offset:52224
  s_add_u32 m0, s87, 4096
  s_add_u32 s54, s84, 32768
  buffer_load_dwordx4 v254, s[16:19], s54 offen lds
  v_add_f32 v172, v172, v174
  v_mfma_f32_32x32x16_bf16 v[64:79], a[124:127], v[152:155], v[64:79]
  v_mov_b32 v173, v172
  s_nop 1
  v_permlane32_swap_b32 v172, v173
  s_waitcnt lgkmcnt(3)
  v_mfma_f32_32x32x16_bf16 v[80:95], a[64:67], v[156:159], v[80:95]
  ds_read_b128 v[152:155], v2 offset:53248
  v_mul_f32 v174, 0xbb000000, v172
  v_mfma_f32_32x32x16_bf16 v[96:111], a[68:71], v[156:159], v[96:111]
  v_mul_f32 v173, 0x3b000000, v173
  v_cvt_pk_bf16_f32 v175, v174, v174
  s_waitcnt lgkmcnt(3)
  v_mfma_f32_32x32x16_bf16 v[80:95], a[72:75], v[160:163], v[80:95]
  ds_read_b128 v[156:159], v2 offset:54272
  s_add_u32 m0, s87, 5120
  s_add_u32 s54, s84, 40960
  buffer_load_dwordx4 v254, s[16:19], s54 offen lds
  v_fma_f32 v173, -v174, v174, v173
  v_mfma_f32_32x32x16_bf16 v[96:111], a[76:79], v[160:163], v[96:111]
  v_and_b32 v175, 0xffff0000, v175
  v_max_f32 v173, 0, v173
  s_waitcnt lgkmcnt(3)
  v_mfma_f32_32x32x16_bf16 v[80:95], a[80:83], v[144:147], v[80:95]
  ds_read_b128 v[160:163], v2 offset:55296
  v_sub_f32 v175, v174, v175
  v_mfma_f32_32x32x16_bf16 v[96:111], a[84:87], v[144:147], v[96:111]
  v_add_f32 v173, 0x3727c5ac, v173
  v_cvt_pk_bf16_f32 v184, v174, v175
  s_waitcnt lgkmcnt(3)
  v_mfma_f32_32x32x16_bf16 v[80:95], a[88:91], v[148:151], v[80:95]
  ds_read_b128 v[144:147], v2 offset:56320
  s_add_u32 m0, s87, 6144
  s_add_u32 s54, s84, 49152
  buffer_load_dwordx4 v254, s[16:19], s54 offen lds
  v_rsq_f32 v172, v173
  v_mfma_f32_32x32x16_bf16 v[96:111], a[92:95], v[148:151], v[96:111]
  v_mov_b32 v185, v184
  v_sqrt_f32 v195, v173
  s_waitcnt lgkmcnt(3)
  v_mfma_f32_32x32x16_bf16 v[80:95], a[96:99], v[152:155], v[80:95]
  ds_read_b128 v[148:151], v2 offset:57344
  v_mul_f32 v194, 0xbfb8aa3b, v172
  v_mfma_f32_32x32x16_bf16 v[96:111], a[100:103], v[152:155], v[96:111]
  v_add_f32 v176, v176, v177
  s_waitcnt lgkmcnt(3)
  v_mfma_f32_32x32x16_bf16 v[80:95], a[104:107], v[156:159], v[80:95]
  ds_read_b128 v[152:155], v2 offset:58368
  s_add_u32 m0, s87, 7168
  s_add_u32 s54, s84, 57344
  buffer_load_dwordx4 v254, s[16:19], s54 offen lds
  v_add_f32 v178, v178, v179
  v_mfma_f32_32x32x16_bf16 v[96:111], a[108:111], v[156:159], v[96:111]
  v_add_f32 v176, v176, v178
  v_mov_b32 v177, v176
  s_waitcnt lgkmcnt(3)
  v_mfma_f32_32x32x16_bf16 v[80:95], a[112:115], v[160:163], v[80:95]
  ds_read_b128 v[156:159], v2 offset:59392
  s_nop 1
  v_permlane32_swap_b32 v176, v177
  v_mfma_f32_32x32x16_bf16 v[96:111], a[116:119], v[160:163], v[96:111]
  v_mul_f32 v178, 0xbb000000, v176
  v_mul_f32 v177, 0x3b000000, v177
  s_waitcnt lgkmcnt(3)
  v_mfma_f32_32x32x16_bf16 v[80:95], a[120:123], v[144:147], v[80:95]
  ds_read_b128 v[160:163], v2 offset:60416
  s_add_u32 m0, s87, 32768
  s_add_u32 s54, s84, 65536
  buffer_load_dwordx4 v254, s[16:19], s54 offen lds
  v_cvt_pk_bf16_f32 v179, v178, v178
  v_mfma_f32_32x32x16_bf16 v[96:111], a[124:127], v[144:147], v[96:111]
  v_fma_f32 v177, -v178, v178, v177
  v_and_b32 v179, 0xffff0000, v179
  s_waitcnt lgkmcnt(3)
  v_mfma_f32_32x32x16_bf16 v[112:127], a[64:67], v[148:151], v[112:127]
  ds_read_b128 v[144:147], v2 offset:61440
  v_max_f32 v177, 0, v177
  v_mfma_f32_32x32x16_bf16 v[128:143], a[68:71], v[148:151], v[128:143]
  v_sub_f32 v179, v178, v179
  v_add_f32 v177, 0x3727c5ac, v177
  s_waitcnt lgkmcnt(3)
  v_mfma_f32_32x32x16_bf16 v[112:127], a[72:75], v[152:155], v[112:127]
  ds_read_b128 v[148:151], v2 offset:62464
  s_add_u32 m0, s87, 33792
  s_add_u32 s54, s84, 73728
  buffer_load_dwordx4 v254, s[16:19], s54 offen lds
  v_cvt_pk_bf16_f32 v186, v178, v179
  v_mfma_f32_32x32x16_bf16 v[128:143], a[76:79], v[152:155], v[128:143]
  v_rsq_f32 v176, v177
  v_mov_b32 v187, v186
  s_waitcnt lgkmcnt(3)
  v_mfma_f32_32x32x16_bf16 v[112:127], a[80:83], v[156:159], v[112:127]
  ds_read_b128 v[152:155], v2 offset:63488
  v_sqrt_f32 v197, v177
  v_mfma_f32_32x32x16_bf16 v[128:143], a[84:87], v[156:159], v[128:143]
  v_mul_f32 v196, 0xbfb8aa3b, v176
  v_mov_b32 v188, 0
  s_waitcnt lgkmcnt(3)
  v_mfma_f32_32x32x16_bf16 v[112:127], a[88:91], v[160:163], v[112:127]
  ds_read_b128 v[156:159], v2 offset:64512
  s_add_u32 m0, s87, 34816
  s_add_u32 s54, s84, 81920
  buffer_load_dwordx4 v254, s[16:19], s54 offen lds
  v_mov_b32 v189, 0
  v_mfma_f32_32x32x16_bf16 v[128:143], a[92:95], v[160:163], v[128:143]
  s_waitcnt lgkmcnt(3)
  v_mfma_f32_32x32x16_bf16 v[112:127], a[96:99], v[144:147], v[112:127]
  v_mfma_f32_32x32x16_bf16 v[128:143], a[100:103], v[144:147], v[128:143]
  s_waitcnt lgkmcnt(0)
  s_waitcnt vmcnt(11)
  s_barrier
  v_mfma_f32_32x32x16_bf16 v[112:127], a[104:107], v[148:151], v[112:127]
  ds_read_b128 v[160:163], v2 offset:0
  s_add_u32 m0, s87, 35840
  s_add_u32 s54, s84, 90112
  buffer_load_dwordx4 v254, s[16:19], s54 offen lds
  v_mfma_f32_32x32x16_bf16 v[128:143], a[108:111], v[148:151], v[128:143]
  ds_read_b128 v[144:147], v2 offset:1024
  v_mfma_f32_32x32x16_bf16 v[112:127], a[112:115], v[152:155], v[112:127]
  ds_read_b128 v[148:151], v2 offset:2048
  v_mfma_f32_32x32x16_bf16 v[128:143], a[116:119], v[152:155], v[128:143]
  v_mfma_f32_32x32x16_bf16 v[112:127], a[120:123], v[156:159], v[112:127]
  ds_read_b128 v[152:155], v2 offset:3072
  s_add_u32 m0, s81, 32768
  s_add_u32 s58, s98, 0
  buffer_load_dwordx4 v2, s[20:23], s58 offen sc1 lds
  v_mfma_f32_32x32x16_bf16 v[128:143], a[124:127], v[156:159], v[128:143]
  s_waitcnt lgkmcnt(3)
  v_mfma_f32_32x32x16_bf16 v[16:31], a[128:131], v[160:163], v[16:31]
  ds_read_b128 v[156:159], v2 offset:4096
  v_mfma_f32_32x32x16_bf16 v[32:47], a[132:135], v[160:163], v[32:47]
  ds_read_b64_tr_b16 a[0:1], v248 offset:36864
  s_waitcnt lgkmcnt(4)
  v_mfma_f32_32x32x16_bf16 v[16:31], a[136:139], v[144:147], v[16:31]
  ds_read_b128 v[160:163], v2 offset:5120
  ds_read_b64_tr_b16 a[2:3], v248 offset:37376
  s_add_u32 m0, s81, 33792
  s_add_u32 s58, s98, 1024
  buffer_load_dwordx4 v2, s[20:23], s58 offen sc1 lds
  v_mfma_f32_32x32x16_bf16 v[32:47], a[140:143], v[144:147], v[32:47]
  ds_read_b64_tr_b16 a[4:5], v250 offset:36864
  s_waitcnt lgkmcnt(6)
  v_mfma_f32_32x32x16_bf16 v[16:31], a[144:147], v[148:151], v[16:31]
  ds_read_b128 v[144:147], v2 offset:6144
  ds_read_b64_tr_b16 a[6:7], v250 offset:37376
  v_mfma_f32_32x32x16_bf16 v[32:47], a[148:151], v[148:151], v[32:47]
  ds_read_b64_tr_b16 a[8:9], v248 offset:38912
  s_waitcnt lgkmcnt(8)
  v_mfma_f32_32x32x16_bf16 v[16:31], a[152:155], v[152:155], v[16:31]
  ds_read_b128 v[148:151], v2 offset:7168
  ds_read_b64_tr_b16 a[10:11], v248 offset:39424
  s_add_u32 m0, s81, 34816
  s_add_u32 s58, s98, 2048
  buffer_load_dwordx4 v2, s[20:23], s58 offen sc1 lds
  v_mfma_f32_32x32x16_bf16 v[32:47], a[156:159], v[152:155], v[32:47]
  ds_read_b64_tr_b16 a[12:13], v250 offset:38912
  s_waitcnt lgkmcnt(10)
  v_mfma_f32_32x32x16_bf16 v[16:31], a[160:163], v[156:159], v[16:31]
  ds_read_b128 v[152:155], v2 offset:8192
  ds_read_b64_tr_b16 a[14:15], v250 offset:39424
  v_mfma_f32_32x32x16_bf16 v[32:47], a[164:167], v[156:159], v[32:47]
  ds_read_b64_tr_b16 a[16:17], v249 offset:0
  s_waitcnt lgkmcnt(11)
  v_mfma_f32_32x32x16_bf16 v[16:31], a[168:171], v[160:163], v[16:31]
  ds_read_b128 v[156:159], v2 offset:9216
  ds_read_b64_tr_b16 a[18:19], v249 offset:512
  s_add_u32 m0, s81, 35840
  s_add_u32 s58, s98, 3072
  buffer_load_dwordx4 v2, s[20:23], s58 offen sc1 lds
  v_mfma_f32_32x32x16_bf16 v[32:47], a[172:175], v[160:163], v[32:47]
  ds_read_b64_tr_b16 a[20:21], v251 offset:0
  s_waitcnt lgkmcnt(11)
  v_mfma_f32_32x32x16_bf16 v[16:31], a[176:179], v[144:147], v[16:31]
  ds_read_b128 v[160:163], v2 offset:10240
  ds_read_b64_tr_b16 a[22:23], v251 offset:512
  v_mfma_f32_32x32x16_bf16 v[32:47], a[180:183], v[144:147], v[32:47]
  ds_read_b64_tr_b16 a[24:25], v249 offset:2048
  s_waitcnt lgkmcnt(11)
  v_mfma_f32_32x32x16_bf16 v[16:31], a[184:187], v[148:151], v[16:31]
  ds_read_b128 v[144:147], v2 offset:11264
  ds_read_b64_tr_b16 a[26:27], v249 offset:2560
  s_add_u32 m0, s81, 36864
  s_add_u32 s58, s98, 4096
  buffer_load_dwordx4 v2, s[20:23], s58 offen sc1 lds
  v_mfma_f32_32x32x16_bf16 v[32:47], a[188:191], v[148:151], v[32:47]
  ds_read_b64_tr_b16 a[28:29], v251 offset:2048
  s_waitcnt lgkmcnt(11)
  v_mfma_f32_32x32x16_bf16 v[16:31], a[192:195], v[152:155], v[16:31]
  ds_read_b128 v[148:151], v2 offset:12288
  ds_read_b64_tr_b16 a[30:31], v251 offset:2560
  v_mfma_f32_32x32x16_bf16 v[32:47], a[196:199], v[152:155], v[32:47]
  s_waitcnt lgkmcnt(10)
  v_mfma_f32_32x32x16_bf16 v[16:31], a[200:203], v[156:159], v[16:31]
  ds_read_b128 v[152:155], v2 offset:13312
  s_add_u32 m0, s81, 37888
  s_add_u32 s58, s98, 5120
  buffer_load_dwordx4 v2, s[20:23], s58 offen sc1 lds
  v_mfma_f32_32x32x16_bf16 v[32:47], a[204:207], v[156:159], v[32:47]
  s_waitcnt lgkmcnt(1)
  v_mfma_f32_32x32x16_bf16 v[16:31], a[208:211], v[160:163], v[16:31]
  ds_read_b128 v[156:159], v2 offset:14336
  v_mfma_f32_32x32x16_bf16 v[32:47], a[212:215], v[160:163], v[32:47]
  v_mfma_f32_32x32x16_bf16 v[16:31], a[216:219], v[144:147], v[16:31]
  ds_read_b128 v[160:163], v2 offset:15360
  s_add_u32 m0, s81, 38912
  s_add_u32 s58, s98, 6144
  buffer_load_dwordx4 v2, s[20:23], s58 offen sc1 lds
  v_mfma_f32_32x32x16_bf16 v[32:47], a[220:223], v[144:147], v[32:47]
  v_mfma_f32_32x32x16_bf16 v[16:31], a[224:227], v[148:151], v[16:31]
  ds_read_b128 v[144:147], v2 offset:16384
  v_mfma_f32_32x32x16_bf16 v[32:47], a[228:231], v[148:151], v[32:47]
  s_waitcnt lgkmcnt(3)
  v_mfma_f32_32x32x16_bf16 v[16:31], a[232:235], v[152:155], v[16:31]
  ds_read_b128 v[148:151], v2 offset:17408
  s_add_u32 m0, s81, 39936
  s_add_u32 s58, s98, 7168
  buffer_load_dwordx4 v2, s[20:23], s58 offen sc1 lds
  v_mfma_f32_32x32x16_bf16 v[32:47], a[236:239], v[152:155], v[32:47]
  s_waitcnt lgkmcnt(3)
  v_mfma_f32_32x32x16_bf16 v[16:31], a[240:243], v[156:159], v[16:31]
  ds_read_b128 v[152:155], v2 offset:18432
  v_mfma_f32_32x32x16_bf16 v[32:47], a[244:247], v[156:159], v[32:47]
  s_waitcnt lgkmcnt(3)
  v_mfma_f32_32x32x16_bf16 v[16:31], a[248:251], v[160:163], v[16:31]
  ds_read_b128 v[156:159], v2 offset:19456
  s_add_u32 m0, s87, 36864
  s_add_u32 s54, s84, 376832
  buffer_load_dwordx4 v254, s[16:19], s54 offen lds
  v_mfma_f32_32x32x16_bf16 v[32:47], a[252:255], v[160:163], v[32:47]
  v_mfma_f32_32x32x16_bf16 v[16:31], v[4:7], v[180:183], v[16:31]
  v_mfma_f32_32x32x16_bf16 v[32:47], v[8:11], v[180:183], v[32:47]
  s_waitcnt lgkmcnt(3)
  v_mfma_f32_32x32x16_bf16 v[48:63], a[128:131], v[144:147], v[48:63]
  ds_read_b128 v[160:163], v2 offset:20480
  v_mfma_f32_32x32x16_bf16 v[64:79], a[132:135], v[144:147], v[64:79]
  s_waitcnt lgkmcnt(3)
  v_mfma_f32_32x32x16_bf16 v[48:63], a[136:139], v[148:151], v[48:63]
  ds_read_b128 v[144:147], v2 offset:21504
  s_add_u32 m0, s87, 37888
  s_add_u32 s54, s84, 385024
  buffer_load_dwordx4 v254, s[16:19], s54 offen lds
  s_nop 0
  v_mul_f32 v16, v190, v16
  v_mul_f32 v17, v190, v17
  v_mfma_f32_32x32x16_bf16 v[64:79], a[140:143], v[148:151], v[64:79]
  v_mul_f32 v18, v190, v18
  v_mul_f32 v19, v190, v19
  v_exp_f32 v16, v16
  v_exp_f32 v17, v17
  s_waitcnt lgkmcnt(3)
  v_mfma_f32_32x32x16_bf16 v[48:63], a[144:147], v[152:155], v[48:63]
  ds_read_b128 v[148:151], v2 offset:22528
  v_exp_f32 v18, v18
  v_exp_f32 v19, v19
  v_mfma_f32_32x32x16_bf16 v[64:79], a[148:151], v[152:155], v[64:79]
  v_fma_f32 v16, v16, v191, v191
  v_fma_f32 v17, v17, v191, v191
  v_fma_f32 v18, v18, v191, v191
  v_fma_f32 v19, v19, v191, v191
  v_rcp_f32 v16, v16
  s_waitcnt lgkmcnt(3)
  v_mfma_f32_32x32x16_bf16 v[48:63], a[152:155], v[156:159], v[48:63]
  ds_read_b128 v[152:155], v2 offset:23552
  s_add_u32 m0, s87, 38912
  s_add_u32 s54, s84, 393216
  buffer_load_dwordx4 v254, s[16:19], s54 offen lds
  v_rcp_f32 v17, v17
  v_mfma_f32_32x32x16_bf16 v[64:79], a[156:159], v[156:159], v[64:79]
  v_rcp_f32 v18, v18
  v_rcp_f32 v19, v19
  v_mul_f32 v32, v32, v16
  v_mul_f32 v33, v33, v17
  s_waitcnt lgkmcnt(3)
  v_mfma_f32_32x32x16_bf16 v[48:63], a[160:163], v[160:163], v[48:63]
  ds_read_b128 v[156:159], v2 offset:24576
  v_mul_f32 v34, v34, v18
  v_mul_f32 v35, v35, v19
  v_mul_f32 v20, v190, v20
  v_mul_f32 v21, v190, v21
  v_mfma_f32_32x32x16_bf16 v[64:79], a[164:167], v[160:163], v[64:79]
  v_mul_f32 v22, v190, v22
  v_mul_f32 v23, v190, v23
  v_cvt_pk_bf16_f32 v164, v32, v33
  v_cvt_pk_bf16_f32 v165, v34, v35
  v_exp_f32 v20, v20
  s_waitcnt lgkmcnt(3)
  v_mfma_f32_32x32x16_bf16 v[48:63], a[168:171], v[144:147], v[48:63]
  ds_read_b128 v[160:163], v2 offset:25600
  s_add_u32 m0, s87, 39936
  s_add_u32 s54, s84, 401408
  buffer_load_dwordx4 v254, s[16:19], s54 offen lds
  v_exp_f32 v21, v21
  v_mfma_f32_32x32x16_bf16 v[64:79], a[172:175], v[144:147], v[64:79]
  v_exp_f32 v22, v22
  v_exp_f32 v23, v23
  v_fma_f32 v20, v20, v191, v191
  v_fma_f32 v21, v21, v191, v191
  s_waitcnt lgkmcnt(3)
  v_mfma_f32_32x32x16_bf16 v[48:63], a[176:179], v[148:151], v[48:63]
  ds_read_b128 v[144:147], v2 offset:26624
  v_fma_f32 v22, v22, v191, v191
  v_fma_f32 v23, v23, v191, v191
  v_rcp_f32 v20, v20
  v_mfma_f32_32x32x16_bf16 v[64:79], a[180:183], v[148:151], v[64:79]
  v_rcp_f32 v21, v21
  v_rcp_f32 v22, v22
  v_rcp_f32 v23, v23
  s_waitcnt lgkmcnt(3)
  v_mfma_f32_32x32x16_bf16 v[48:63], a[184:187], v[152:155], v[48:63]
  ds_read_b128 v[148:151], v2 offset:27648
  s_add_u32 m0, s88, 0
  s_add_u32 s54, s84, 425984
  buffer_load_dwordx4 v254, s[16:19], s54 offen lds
  v_mul_f32 v36, v36, v20
  v_mul_f32 v37, v37, v21
  v_mfma_f32_32x32x16_bf16 v[64:79], a[188:191], v[152:155], v[64:79]
  v_mul_f32 v38, v38, v22
  v_mul_f32 v39, v39, v23
  v_mul_f32 v24, v190, v24
  v_mul_f32 v25, v190, v25
  v_mul_f32 v26, v190, v26
  v_mul_f32 v27, v190, v27
  s_waitcnt lgkmcnt(3)
  v_mfma_f32_32x32x16_bf16 v[48:63], a[192:195], v[156:159], v[48:63]
  ds_read_b128 v[152:155], v2 offset:28672
  v_cvt_pk_bf16_f32 v166, v36, v37
  v_cvt_pk_bf16_f32 v167, v38, v39
  v_exp_f32 v24, v24
  v_mfma_f32_32x32x16_bf16 v[64:79], a[196:199], v[156:159], v[64:79]
  v_exp_f32 v25, v25
  v_exp_f32 v26, v26
  v_exp_f32 v27, v27
  s_waitcnt lgkmcnt(3)
  v_mfma_f32_32x32x16_bf16 v[48:63], a[200:203], v[160:163], v[48:63]
  ds_read_b128 v[156:159], v2 offset:29696
  s_add_u32 m0, s88, 1024
  s_add_u32 s54, s84, 434176
  buffer_load_dwordx4 v254, s[16:19], s54 offen lds
  s_cmp_eq_u32 s32, 0
  s_cbranch_scc1 Ls_71
  buffer_store_dwordx4 v[164:167], v2, s[20:23], s62 offen nt
Lb_72:
  v_mfma_f32_32x32x16_bf16 v[64:79], a[204:207], v[160:163], v[64:79]
  v_fma_f32 v24, v24, v191, v191
  v_fma_f32 v25, v25, v191, v191
  v_fma_f32 v26, v26, v191, v191
  v_fma_f32 v27, v27, v191, v191
  v_rcp_f32 v24, v24
  s_waitcnt lgkmcnt(3)
  v_mfma_f32_32x32x16_bf16 v[48:63], a[208:211], v[144:147], v[48:63]
  ds_read_b128 v[160:163], v2 offset:30720
  v_rcp_f32 v25, v25
  v_rcp_f32 v26, v26
  v_mfma_f32_32x32x16_bf16 v[64:79], a[212:215], v[144:147], v[64:79]
  v_rcp_f32 v27, v27
  v_mul_f32 v40, v40, v24
  v_mul_f32 v41, v41, v25
  v_mul_f32 v42, v42, v26
  v_mul_f32 v43, v43, v27
  s_waitcnt lgkmcnt(3)
  v_mfma_f32_32x32x16_bf16 v[48:63], a[216:219], v[148:151], v[48:63]
  ds_read_b128 v[144:147], v2 offset:31744
  s_add_u32 m0, s88, 2048
  s_add_u32 s54, s84, 442368
  buffer_load_dwordx4 v254, s[16:19], s54 offen lds
  v_mul_f32 v28, v190, v28
  v_mul_f32 v29, v190, v29
  v_mfma_f32_32x32x16_bf16 v[64:79], a[220:223], v[148:151], v[64:79]
  v_mul_f32 v30, v190, v30
  v_mul_f32 v31, v190, v31
  v_cvt_pk_bf16_f32 v168, v40, v41
  v_cvt_pk_bf16_f32 v169, v42, v43
  v_exp_f32 v28, v28
  s_waitcnt lgkmcnt(3)
  v_mfma_f32_32x32x16_bf16 v[48:63], a[224:227], v[152:155], v[48:63]
  v_exp_f32 v29, v29
  v_exp_f32 v30, v30
  v_exp_f32 v31, v31
  v_mfma_f32_32x32x16_bf16 v[64:79], a[228:231], v[152:155], v[64:79]
  v_fma_f32 v28, v28, v191, v191
  v_fma_f32 v29, v29, v191, v191
  v_fma_f32 v30, v30, v191, v191
  v_fma_f32 v31, v31, v191, v191
  v_rcp_f32 v28, v28
  s_waitcnt lgkmcnt(0)
  s_waitcnt vmcnt(8)
  s_barrier
  v_mfma_f32_32x32x16_bf16 v[48:63], a[232:235], v[156:159], v[48:63]
  ds_read_b128 v[148:151], v2 offset:32768
  s_add_u32 m0, s88, 3072
  s_add_u32 s54, s84, 450560
  buffer_load_dwordx4 v254, s[16:19], s54 offen lds
  v_rcp_f32 v29, v29
  v_mfma_f32_32x32x16_bf16 v[64:79], a[236:239], v[156:159], v[64:79]
  ds_read_b128 v[152:155], v2 offset:33792
  v_rcp_f32 v30, v30
  v_rcp_f32 v31, v31
  v_mfma_f32_32x32x16_bf16 v[48:63], a[240:243], v[160:163], v[48:63]
  ds_read_b128 v[156:159], v2 offset:34816
  v_mul_f32 v44, v44, v28
  v_mul_f32 v45, v45, v29
  v_mul_f32 v46, v46, v30
  v_mul_f32 v47, v47, v31
  v_mfma_f32_32x32x16_bf16 v[64:79], a[244:247], v[160:163], v[64:79]
  v_cvt_pk_bf16_f32 v170, v44, v45
  v_cvt_pk_bf16_f32 v171, v46, v47
  s_cmp_eq_u32 s32, 0
  s_cbranch_scc1 Ls_73
  buffer_store_dwordx4 v[168:171], v2, s[20:23], s62 offen offset:1024 nt
Lb_74:
  v_mfma_f32_32x32x16_bf16 v[48:63], a[248:251], v[144:147], v[48:63]
  ds_read_b128 v[160:163], v2 offset:35840
  v_lshrrev_b32 v12, 2, v1
  v_min_u32 v12, 13, v12
  v_lshlrev_b32 v12, 7, v12
  v_and_b32 v15, 3, v1
  v_lshl_add_u32 v12, v15, 2, v12
  s_lshl_b32 s90, s28, 11
  s_add_u32 s90, s90, 196608
  s_add_u32 m0, s81, 0
  s_add_u32 s54, s84, 278528
  buffer_load_dwordx4 v254, s[16:19], s54 offen lds
  v_mfma_f32_32x32x16_bf16 v[64:79], a[252:255], v[144:147], v[64:79]
  v_mfma_f32_32x32x16_bf16 v[48:63], v[4:7], v[182:185], v[48:63]
  v_mfma_f32_32x32x16_bf16 v[64:79], v[8:11], v[182:185], v[64:79]
  s_waitcnt lgkmcnt(3)
  v_mfma_f32_32x32x16_bf16 v[80:95], a[128:131], v[148:151], v[80:95]
  ds_read_b128 v[144:147], v2 offset:36864
  v_mfma_f32_32x32x16_bf16 v[96:111], a[132:135], v[148:151], v[96:111]
  s_waitcnt lgkmcnt(3)
  v_mfma_f32_32x32x16_bf16 v[80:95], a[136:139], v[152:155], v[80:95]
  ds_read_b128 v[148:151], v2 offset:37888
  s_nop 3
  v_mul_f32 v48, v192, v48
  v_mul_f32 v49, v192, v49
  v_mul_f32 v50, v192, v50
  v_mul_f32 v51, v192, v51
  v_mfma_f32_32x32x16_bf16 v[96:111], a[140:143], v[152:155], v[96:111]
  v_exp_f32 v48, v48
  v_exp_f32 v49, v49
  v_exp_f32 v50, v50
  s_waitcnt lgkmcnt(3)
  v_mfma_f32_32x32x16_bf16 v[80:95], a[144:147], v[156:159], v[80:95]
  ds_read_b128 v[152:155], v2 offset:38912
  v_exp_f32 v51, v51
  v_fma_f32 v48, v48, v193, v193
  v_fma_f32 v49, v49, v193, v193
  v_mfma_f32_32x32x16_bf16 v[96:111], a[148:151], v[156:159], v[96:111]
  v_fma_f32 v50, v50, v193, v193
  v_fma_f32 v51, v51, v193, v193
  v_rcp_f32 v48, v48
  v_rcp_f32 v49, v49
  s_waitcnt lgkmcnt(3)
  v_mfma_f32_32x32x16_bf16 v[80:95], a[152:155], v[160:163], v[80:95]
  ds_read_b128 v[156:159], v2 offset:39936
  v_rcp_f32 v50, v50
  v_rcp_f32 v51, v51
  v_mfma_f32_32x32x16_bf16 v[96:111], a[156:159], v[160:163], v[96:111]
  v_mul_f32 v64, v64, v48
  v_mul_f32 v65, v65, v49
  v_mul_f32 v66, v66, v50
  v_mul_f32 v67, v67, v51
  v_mul_f32 v52, v192, v52
  v_mul_f32 v53, v192, v53
  s_waitcnt lgkmcnt(3)
  v_mfma_f32_32x32x16_bf16 v[80:95], a[160:163], v[144:147], v[80:95]
  ds_read_b128 v[160:163], v2 offset:40960
  v_mul_f32 v54, v192, v54
  v_mul_f32 v55, v192, v55
  v_cvt_pk_bf16_f32 v164, v64, v65
  v_cvt_pk_bf16_f32 v165, v66, v67
  v_mfma_f32_32x32x16_bf16 v[96:111], a[164:167], v[144:147], v[96:111]
  v_exp_f32 v52, v52
  v_exp_f32 v53, v53
  v_exp_f32 v54, v54
  s_waitcnt lgkmcnt(3)
  v_mfma_f32_32x32x16_bf16 v[80:95], a[168:171], v[148:151], v[80:95]
  ds_read_b128 v[144:147], v2 offset:41984
  v_exp_f32 v55, v55
  v_fma_f32 v52, v52, v193, v193
  v_fma_f32 v53, v53, v193, v193
  v_mfma_f32_32x32x16_bf16 v[96:111], a[172:175], v[148:151], v[96:111]
  v_fma_f32 v54, v54, v193, v193
  v_fma_f32 v55, v55, v193, v193
  v_rcp_f32 v52, v52
  v_rcp_f32 v53, v53
  s_waitcnt lgkmcnt(3)
  v_mfma_f32_32x32x16_bf16 v[80:95], a[176:179], v[152:155], v[80:95]
  ds_read_b128 v[148:151], v2 offset:43008
  v_rcp_f32 v54, v54
  v_rcp_f32 v55, v55
  v_mfma_f32_32x32x16_bf16 v[96:111], a[180:183], v[152:155], v[96:111]
  v_mul_f32 v68, v68, v52
  v_mul_f32 v69, v69, v53
  v_mul_f32 v70, v70, v54
  v_mul_f32 v71, v71, v55
  v_mul_f32 v56, v192, v56
  v_mul_f32 v57, v192, v57
  s_waitcnt lgkmcnt(3)
  v_mfma_f32_32x32x16_bf16 v[80:95], a[184:187], v[156:159], v[80:95]
  ds_read_b128 v[152:155], v2 offset:44032
  v_mul_f32 v58, v192, v58
  v_mul_f32 v59, v192, v59
  v_cvt_pk_bf16_f32 v166, v68, v69
  v_cvt_pk_bf16_f32 v167, v70, v71
  v_mfma_f32_32x32x16_bf16 v[96:111], a[188:191], v[156:159], v[96:111]
  v_exp_f32 v56, v56
  v_exp_f32 v57, v57
  v_exp_f32 v58, v58
  s_waitcnt lgkmcnt(3)
  v_mfma_f32_32x32x16_bf16 v[80:95], a[192:195], v[160:163], v[80:95]
  ds_read_b128 v[156:159], v2 offset:45056
  v_exp_f32 v59, v59
  s_cmp_eq_u32 s32, 0
  s_cbranch_scc1 Ls_75
  buffer_store_dwordx4 v[164:167], v2, s[20:23], s63 offen nt
Lb_76:
  v_mfma_f32_32x32x16_bf16 v[96:111], a[196:199], v[160:163], v[96:111]
  v_fma_f32 v56, v56, v193, v193
  v_fma_f32 v57, v57, v193, v193
  v_fma_f32 v58, v58, v193, v193
  v_fma_f32 v59, v59, v193, v193
  v_rcp_f32 v56, v56
  s_waitcnt lgkmcnt(3)
  v_mfma_f32_32x32x16_bf16 v[80:95], a[200:203], v[144:147], v[80:95]
  ds_read_b128 v[160:163], v2 offset:46080
  v_rcp_f32 v57, v57
  v_rcp_f32 v58, v58
  v_mfma_f32_32x32x16_bf16 v[96:111], a[204:207], v[144:147], v[96:111]
  v_rcp_f32 v59, v59
  v_mul_f32 v72, v72, v56
  v_mul_f32 v73, v73, v57
  v_mul_f32 v74, v74, v58
  v_mul_f32 v75, v75, v59
  s_waitcnt lgkmcnt(3)
  v_mfma_f32_32x32x16_bf16 v[80:95], a[208:211], v[148:151], v[80:95]
  ds_read_b128 v[144:147], v2 offset:47104
  s_add_u32 m0, s81, 1024
  s_add_u32 s54, s84, 286720
  buffer_load_dwordx4 v254, s[16:19], s54 offen lds
  v_mul_f32 v60, v192, v60
  v_mul_f32 v61, v192, v61
  v_mfma_f32_32x32x16_bf16 v[96:111], a[212:215], v[148:151], v[96:111]
  v_mul_f32 v62, v192, v62
  v_mul_f32 v63, v192, v63
  v_cvt_pk_bf16_f32 v168, v72, v73
  v_cvt_pk_bf16_f32 v169, v74, v75
  v_exp_f32 v60, v60
  s_waitcnt lgkmcnt(3)
  v_mfma_f32_32x32x16_bf16 v[80:95], a[216:219], v[152:155], v[80:95]
  ds_read_b128 v[148:151], v2 offset:48128
  v_exp_f32 v61, v61
  v_exp_f32 v62, v62
  v_mfma_f32_32x32x16_bf16 v[96:111], a[220:223], v[152:155], v[96:111]
  s_add_u32 m0, s81, 2048
  s_add_u32 s54, s84, 294912
  buffer_load_dwordx4 v254, s[16:19], s54 offen lds
  v_exp_f32 v63, v63
  v_fma_f32 v60, v60, v193, v193
  v_fma_f32 v61, v61, v193, v193
  s_waitcnt lgkmcnt(3)
  v_mfma_f32_32x32x16_bf16 v[80:95], a[224:227], v[156:159], v[80:95]
  ds_read_b128 v[152:155], v2 offset:49152
  v_fma_f32 v62, v62, v193, v193
  v_fma_f32 v63, v63, v193, v193
  v_rcp_f32 v60, v60
  v_mfma_f32_32x32x16_bf16 v[96:111], a[228:231], v[156:159], v[96:111]
  v_rcp_f32 v61, v61
  v_rcp_f32 v62, v62
  v_rcp_f32 v63, v63
  s_waitcnt lgkmcnt(3)
  v_mfma_f32_32x32x16_bf16 v[80:95], a[232:235], v[160:163], v[80:95]
  ds_read_b128 v[156:159], v2 offset:50176
  s_add_u32 m0, s81, 3072
  s_add_u32 s54, s84, 303104
  buffer_load_dwordx4 v254, s[16:19], s54 offen lds
  v_mul_f32 v76, v76, v60
  v_mul_f32 v77, v77, v61
  v_mfma_f32_32x32x16_bf16 v[96:111], a[236:239], v[160:163], v[96:111]
  v_mul_f32 v78, v78, v62
  v_mul_f32 v79, v79, v63
  v_cvt_pk_bf16_f32 v170, v76, v77
  v_cvt_pk_bf16_f32 v171, v78, v79
  s_waitcnt lgkmcnt(3)
  v_mfma_f32_32x32x16_bf16 v[80:95], a[240:243], v[144:147], v[80:95]
  ds_read_b128 v[160:163], v2 offset:51200
  s_cmp_eq_u32 s32, 0
  s_cbranch_scc1 Ls_77
  buffer_store_dwordx4 v[168:171], v2, s[20:23], s63 offen offset:1024 nt
Lb_78:
  v_mfma_f32_32x32x16_bf16 v[96:111], a[244:247], v[144:147], v[96:111]
  s_add_u32 m0, s81, 4096
  s_add_u32 s54, s84, 311296
  buffer_load_dwordx4 v254, s[16:19], s54 offen lds
  s_waitcnt lgkmcnt(3)
  v_mfma_f32_32x32x16_bf16 v[80:95], a[248:251], v[148:151], v[80:95]
  ds_read_b128 v[144:147], v2 offset:52224
  v_mfma_f32_32x32x16_bf16 v[96:111], a[252:255], v[148:151], v[96:111]
  v_mfma_f32_32x32x16_bf16 v[80:95], v[4:7], v[184:187], v[80:95]
  v_mfma_f32_32x32x16_bf16 v[96:111], v[8:11], v[184:187], v[96:111]
  s_waitcnt lgkmcnt(3)
  v_mfma_f32_32x32x16_bf16 v[112:127], a[128:131], v[152:155], v[112:127]
  ds_read_b128 v[148:151], v2 offset:53248
  s_add_u32 m0, s81, 5120
  s_add_u32 s54, s84, 319488
  buffer_load_dwordx4 v254, s[16:19], s54 offen lds
  v_mfma_f32_32x32x16_bf16 v[128:143], a[132:135], v[152:155], v[128:143]
  s_waitcnt lgkmcnt(3)
  v_mfma_f32_32x32x16_bf16 v[112:127], a[136:139], v[156:159], v[112:127]
  ds_read_b128 v[152:155], v2 offset:54272
  s_nop 0
  v_mul_f32 v80, v194, v80
  v_mul_f32 v81, v194, v81
  v_mul_f32 v82, v194, v82
  v_mul_f32 v83, v194, v83
  v_mfma_f32_32x32x16_bf16 v[128:143], a[140:143], v[156:159], v[128:143]
  s_add_u32 m0, s81, 6144
  s_add_u32 s54, s84, 327680
  buffer_load_dwordx4 v254, s[16:19], s54 offen lds
  v_exp_f32 v80, v80
  v_exp_f32 v81, v81
  s_waitcnt lgkmcnt(3)
  v_mfma_f32_32x32x16_bf16 v[112:127], a[144:147], v[160:163], v[112:127]
  ds_read_b128 v[156:159], v2 offset:55296
  v_exp_f32 v82, v82
  v_exp_f32 v83, v83
  v_mfma_f32_32x32x16_bf16 v[128:143], a[148:151], v[160:163], v[128:143]
  v_fma_f32 v80, v80, v195, v195
  v_fma_f32 v81, v81, v195, v195
  v_fma_f32 v82, v82, v195, v195
  v_fma_f32 v83, v83, v195, v195
  v_rcp_f32 v80, v80
  s_waitcnt vmcnt(3)
  v_mov_b32 v14, s31
  v_mov_b32 v15, 65536
  s_mov_b64 exec, 1
  s_cmp_eq_u32 s32, 0
  s_cbranch_scc1 Ls_79
  buffer_store_dword v14, v15, s[20:23], s80 offen
Lb_80:
  s_mov_b64 exec, -1
  s_barrier
  s_waitcnt lgkmcnt(3)
  v_mfma_f32_32x32x16_bf16 v[112:127], a[152:155], v[144:147], v[112:127]
  ds_read_b128 v[160:163], v2 offset:56320
  s_add_u32 m0, s81, 7168
  s_add_u32 s54, s84, 335872
  buffer_load_dwordx4 v254, s[16:19], s54 offen lds
  v_rcp_f32 v81, v81
  v_mfma_f32_32x32x16_bf16 v[128:143], a[156:159], v[144:147], v[128:143]
  v_rcp_f32 v82, v82
  v_rcp_f32 v83, v83
  v_mul_f32 v96, v96, v80
  v_mul_f32 v97, v97, v81
  s_waitcnt lgkmcnt(3)
  v_mfma_f32_32x32x16_bf16 v[112:127], a[160:163], v[148:151], v[112:127]
  ds_read_b128 v[144:147], v2 offset:57344
  v_mul_f32 v98, v98, v82
  v_mul_f32 v99, v99, v83
  v_mul_f32 v84, v194, v84
  v_mul_f32 v85, v194, v85
  v_mfma_f32_32x32x16_bf16 v[128:143], a[164:167], v[148:151], v[128:143]
  s_add_u32 m0, s83, 0
  s_add_u32 s54, s84, 409600
  buffer_load_dwordx4 v254, s[16:19], s54 offen lds
  v_mul_f32 v86, v194, v86
  v_mul_f32 v87, v194, v87
  v_cvt_pk_bf16_f32 v164, v96, v97
  v_cvt_pk_bf16_f32 v165, v98, v99
  s_waitcnt lgkmcnt(3)
  v_mfma_f32_32x32x16_bf16 v[112:127], a[168:171], v[152:155], v[112:127]
  ds_read_b128 v[148:151], v2 offset:58368
  v_exp_f32 v84, v84
  v_exp_f32 v85, v85
  v_mfma_f32_32x32x16_bf16 v[128:143], a[172:175], v[152:155], v[128:143]
  v_exp_f32 v86, v86
  v_exp_f32 v87, v87
  v_fma_f32 v84, v84, v195, v195
  v_fma_f32 v85, v85, v195, v195
  s_waitcnt lgkmcnt(3)
  v_mfma_f32_32x32x16_bf16 v[112:127], a[176:179], v[156:159], v[112:127]
  ds_read_b128 v[152:155], v2 offset:59392
  s_add_u32 m0, s82, 0
  s_add_u32 s54, s84, 344064
  buffer_load_dwordx4 v254, s[16:19], s54 offen lds
  v_fma_f32 v86, v86, v195, v195
  v_fma_f32 v87, v87, v195, v195
  v_mfma_f32_32x32x16_bf16 v[128:143], a[180:183], v[156:159], v[128:143]
  v_rcp_f32 v84, v84
  v_rcp_f32 v85, v85
  v_rcp_f32 v86, v86
  s_waitcnt lgkmcnt(3)
  v_mfma_f32_32x32x16_bf16 v[112:127], a[184:187], v[160:163], v[112:127]
  ds_read_b128 v[156:159], v2 offset:60416
  v_rcp_f32 v87, v87
  v_mul_f32 v100, v100, v84
  v_mul_f32 v101, v101, v85
  v_mfma_f32_32x32x16_bf16 v[128:143], a[188:191], v[160:163], v[128:143]
  s_add_u32 m0, s83, 1024
  s_add_u32 s54, s84, 417792
  buffer_load_dwordx4 v254, s[16:19], s54 offen lds
  v_mul_f32 v102, v102, v86
  v_mul_f32 v103, v103, v87
  v_mul_f32 v88, v194, v88
  v_mul_f32 v89, v194, v89
  s_waitcnt lgkmcnt(3)
  v_mfma_f32_32x32x16_bf16 v[112:127], a[192:195], v[144:147], v[112:127]
  ds_read_b128 v[160:163], v2 offset:61440
  v_mul_f32 v90, v194, v90
  v_mul_f32 v91, v194, v91
  v_cvt_pk_bf16_f32 v166, v100, v101
  v_cvt_pk_bf16_f32 v167, v102, v103
  v_mfma_f32_32x32x16_bf16 v[128:143], a[196:199], v[144:147], v[128:143]
  v_exp_f32 v88, v88
  v_exp_f32 v89, v89
  v_exp_f32 v90, v90
  s_waitcnt lgkmcnt(3)
  v_mfma_f32_32x32x16_bf16 v[112:127], a[200:203], v[148:151], v[112:127]
  ds_read_b128 v[144:147], v2 offset:62464
  s_add_u32 m0, s82, 1024
  s_add_u32 s54, s84, 352256
  buffer_load_dwordx4 v254, s[16:19], s54 offen lds
  v_exp_f32 v91, v91
  v_mfma_f32_32x32x16_bf16 v[128:143], a[204:207], v[148:151], v[128:143]
  s_cmp_eq_u32 s32, 0
  s_cbranch_scc1 Ls_81
  buffer_store_dwordx4 v[164:167], v2, s[20:23], s64 offen nt
Lb_82:
  v_fma_f32 v88, v88, v195, v195
  v_fma_f32 v89, v89, v195, v195
  v_fma_f32 v90, v90, v195, v195
  v_fma_f32 v91, v91, v195, v195
  s_waitcnt lgkmcnt(3)
  v_mfma_f32_32x32x16_bf16 v[112:127], a[208:211], v[152:155], v[112:127]
  ds_read_b128 v[148:151], v2 offset:63488
  v_rcp_f32 v88, v88
  v_rcp_f32 v89, v89
  v_mfma_f32_32x32x16_bf16 v[128:143], a[212:215], v[152:155], v[128:143]
  buffer_load_dwordx4 v[172:175], v2, s[20:23], s99 offen offset:0 sc1
  v_rcp_f32 v90, v90
  v_rcp_f32 v91, v91
  s_waitcnt lgkmcnt(3)
  v_mfma_f32_32x32x16_bf16 v[112:127], a[216:219], v[156:159], v[112:127]
  ds_read_b128 v[152:155], v2 offset:64512
  v_mul_f32 v104, v104, v88
  v_mul_f32 v105, v105, v89
  v_mul_f32 v106, v106, v90
  v_mul_f32 v107, v107, v91
  v_mfma_f32_32x32x16_bf16 v[128:143], a[220:223], v[156:159], v[128:143]
  v_mul_f32 v92, v194, v92
  v_mul_f32 v93, v194, v93
  v_mul_f32 v94, v194, v94
  v_mul_f32 v95, v194, v95
  v_cvt_pk_bf16_f32 v168, v104, v105
  v_cvt_pk_bf16_f32 v169, v106, v107
  s_waitcnt lgkmcnt(3)
  v_mfma_f32_32x32x16_bf16 v[112:127], a[224:227], v[160:163], v[112:127]
  s_add_u32 m0, s82, 2048
  s_add_u32 s54, s84, 360448
  buffer_load_dwordx4 v254, s[16:19], s54 offen lds
  v_exp_f32 v92, v92
  v_exp_f32 v93, v93
  v_mfma_f32_32x32x16_bf16 v[128:143], a[228:231], v[160:163], v[128:143]
  buffer_load_dword v13, v12, s[20:23], s90 offen sc1
  v_exp_f32 v94, v94
  v_exp_f32 v95, v95
  s_waitcnt lgkmcnt(2)
  v_mfma_f32_32x32x16_bf16 v[112:127], a[232:235], v[144:147], v[112:127]
  v_fma_f32 v92, v92, v195, v195
  v_fma_f32 v93, v93, v195, v195
  v_fma_f32 v94, v94, v195, v195
  v_fma_f32 v95, v95, v195, v195
  v_rcp_f32 v92, v92
  v_mfma_f32_32x32x16_bf16 v[128:143], a[236:239], v[144:147], v[128:143]
  buffer_load_dwordx4 v[176:179], v2, s[20:23], s99 offen offset:1024 sc1
  v_rcp_f32 v93, v93
  v_rcp_f32 v94, v94
  s_waitcnt lgkmcnt(1)
  v_mfma_f32_32x32x16_bf16 v[112:127], a[240:243], v[148:151], v[112:127]
  v_rcp_f32 v95, v95
  v_mul_f32 v108, v108, v92
  v_mul_f32 v109, v109, v93
  v_mul_f32 v110, v110, v94
  v_mul_f32 v111, v111, v95
  v_mfma_f32_32x32x16_bf16 v[128:143], a[244:247], v[148:151], v[128:143]
  v_cvt_pk_bf16_f32 v170, v108, v109
  v_cvt_pk_bf16_f32 v171, v110, v111
  s_cmp_eq_u32 s32, 0
  s_cbranch_scc1 Ls_83
  buffer_store_dwordx4 v[168:171], v2, s[20:23], s64 offen offset:1024 nt
Lb_84:
  s_waitcnt lgkmcnt(0)
  v_mfma_f32_32x32x16_bf16 v[112:127], a[248:251], v[152:155], v[112:127]
  v_mfma_f32_32x32x16_bf16 v[128:143], a[252:255], v[152:155], v[128:143]
  s_add_u32 m0, s82, 3072
  s_add_u32 s54, s84, 368640
  buffer_load_dwordx4 v254, s[16:19], s54 offen lds
  v_mfma_f32_32x32x16_bf16 v[112:127], v[4:7], v[186:189], v[112:127]
  v_mfma_f32_32x32x16_bf16 v[128:143], v[8:11], v[186:189], v[128:143]
  v_lshrrev_b32 v14, 5, v1
  v_bfe_u32 v15, v1, 2, 2
  v_lshl_add_u32 v14, v14, 3, v15
  v_lshlrev_b32 v14, 7, v14
  v_bfe_u32 v16, v1, 4, 1
  v_and_b32 v17, 1, v1
  v_lshl_add_u32 v16, v16, 1, v17
  v_bfe_u32 v15, v1, 3, 1
  v_xor_b32 v15, s52, v15
  v_lshl_add_u32 v16, v15, 2, v16
  v_lshl_add_u32 v14, v16, 4, v14
  v_bfe_u32 v17, v1, 1, 1
  v_lshl_add_u32 v14, v17, 3, v14
  v_xor_b32 v15, 64, v14
  v_add_u32 v180, s87, v14
  v_add_u32 v181, s81, v14
  v_add_u32 v182, s82, v14
  v_add_u32 v183, s83, v14
  v_add_u32 v184, s88, v14
  v_add_u32 v185, s87, v15
  v_add_u32 v186, s81, v15
  v_add_u32 v187, s82, v15
  v_add_u32 v188, s83, v15
  v_add_u32 v189, s88, v15
  s_mul_i32 s55, s30, 28672
  s_add_u32 s55, s55, s45
  s_mul_i32 s57, s33, 6144
  s_sub_u32 s58, 6144, s57
  s_mul_i32 s91, s51, 114688
  s_add_u32 s91, s91, s55
  s_add_u32 s92, s91, s57
  s_add_u32 s93, s91, s58
  s_mul_i32 s94, s53, 114688
  s_add_u32 s94, s94, s55
  s_add_u32 s95, s94, s57
  s_add_u32 s77, s94, s58
  v_mul_f32 v112, v196, v112
  s_waitcnt vmcnt(3)
  v_subrev_u32 v14, s31, v13
  v_cmp_lt_u32 vcc, 1, v14
  s_cbranch_vccnz Lpf_85
Lpb_86:
  buffer_load_dwordx4 v[144:147], v2, s[20:23], s92 offen offset:0 sc1
  v_mul_f32 v113, v196, v113
  v_mul_f32 v114, v196, v114
  v_mul_f32 v115, v196, v115
  v_exp_f32 v112, v112
  v_exp_f32 v113, v113
  v_exp_f32 v114, v114
  v_exp_f32 v115, v115
  v_fma_f32 v112, v112, v197, v197
  v_fma_f32 v113, v113, v197, v197
  buffer_load_dwordx4 v[148:151], v2, s[20:23], s92 offen offset:1024 sc1
  v_fma_f32 v114, v114, v197, v197
  v_fma_f32 v115, v115, v197, v197
  v_rcp_f32 v112, v112
  v_rcp_f32 v113, v113
  v_rcp_f32 v114, v114
  v_rcp_f32 v115, v115
  v_mul_f32 v128, v128, v112
  v_mul_f32 v129, v129, v113
  v_mul_f32 v130, v130, v114
  buffer_load_dwordx4 v[152:155], v2, s[20:23], s92 offen offset:2048 sc1
  v_mul_f32 v131, v131, v115
  v_mul_f32 v116, v196, v116
  v_mul_f32 v117, v196, v117
  v_mul_f32 v118, v196, v118
  v_mul_f32 v119, v196, v119
  v_cvt_pk_bf16_f32 v164, v128, v129
  v_cvt_pk_bf16_f32 v165, v130, v131
  v_exp_f32 v116, v116
  v_exp_f32 v117, v117
  buffer_load_dwordx4 v[156:159], v2, s[20:23], s92 offen offset:3072 sc1
  v_exp_f32 v118, v118
  v_exp_f32 v119, v119
  v_fma_f32 v116, v116, v197, v197
  v_fma_f32 v117, v117, v197, v197
  v_fma_f32 v118, v118, v197, v197
  v_fma_f32 v119, v119, v197, v197
  v_rcp_f32 v116, v116
  v_rcp_f32 v117, v117
  v_rcp_f32 v118, v118
  s_add_u32 s57, s92, 4096
  buffer_load_dwordx4 v[160:163], v2, s[20:23], s57 offen offset:0 sc1
  v_rcp_f32 v119, v119
  v_mul_f32 v132, v132, v116
  v_mul_f32 v133, v133, v117
  v_mul_f32 v134, v134, v118
  v_mul_f32 v135, v135, v119
  v_mul_f32 v120, v196, v120
  v_mul_f32 v121, v196, v121
  v_mul_f32 v122, v196, v122
  v_mul_f32 v123, v196, v123
  s_add_u32 s57, s92, 4096
  buffer_load_dwordx4 v[248:251], v2, s[20:23], s57 offen offset:1024 sc1
  v_cvt_pk_bf16_f32 v166, v132, v133
  v_cvt_pk_bf16_f32 v167, v134, v135
  v_exp_f32 v120, v120
  v_exp_f32 v121, v121
  v_exp_f32 v122, v122
  v_exp_f32 v123, v123
  s_cmp_eq_u32 s32, 0
  s_cbranch_scc1 Ls_89
  buffer_store_dwordx4 v[164:167], v2, s[20:23], s65 offen nt
Lb_90:
  v_fma_f32 v120, v120, v197, v197
  v_fma_f32 v121, v121, v197, v197
  s_add_u32 s57, s91, 12288
  buffer_load_dwordx4 v[80:83], v2, s[20:23], s57 offen offset:0 sc1
  v_fma_f32 v122, v122, v197, v197
  v_fma_f32 v123, v123, v197, v197
  v_rcp_f32 v120, v120
  v_rcp_f32 v121, v121
  v_rcp_f32 v122, v122
  v_rcp_f32 v123, v123
  v_mul_f32 v136, v136, v120
  v_mul_f32 v137, v137, v121
  v_mul_f32 v138, v138, v122
  s_add_u32 s57, s91, 12288
  buffer_load_dwordx4 v[84:87], v2, s[20:23], s57 offen offset:1024 sc1
  v_mul_f32 v139, v139, v123
  v_mul_f32 v124, v196, v124
  v_mul_f32 v125, v196, v125
  v_mul_f32 v126, v196, v126
  v_mul_f32 v127, v196, v127
  v_cvt_pk_bf16_f32 v168, v136, v137
  v_cvt_pk_bf16_f32 v169, v138, v139
  v_exp_f32 v124, v124
  v_exp_f32 v125, v125
  s_add_u32 s57, s91, 12288
  buffer_load_dwordx4 v[88:91], v2, s[20:23], s57 offen offset:2048 sc1
  v_exp_f32 v126, v126
  v_exp_f32 v127, v127
  v_fma_f32 v124, v124, v197, v197
  v_fma_f32 v125, v125, v197, v197
  v_fma_f32 v126, v126, v197, v197
  v_fma_f32 v127, v127, v197, v197
  v_rcp_f32 v124, v124
  v_rcp_f32 v125, v125
  v_rcp_f32 v126, v126
  s_add_u32 s57, s91, 12288
  buffer_load_dwordx4 v[92:95], v2, s[20:23], s57 offen offset:3072 sc1
  v_rcp_f32 v127, v127
  v_mul_f32 v140, v140, v124
  v_mul_f32 v141, v141, v125
  v_mul_f32 v142, v142, v126
  v_mul_f32 v143, v143, v127
  v_cvt_pk_bf16_f32 v170, v140, v141
  v_cvt_pk_bf16_f32 v171, v142, v143
  s_cmp_eq_u32 s32, 0
  s_cbranch_scc1 Ls_91
  buffer_store_dwordx4 v[168:171], v2, s[20:23], s65 offen offset:1024 nt
Lb_92:
  s_mov_b32 s89, s32
L_b1done:
Lc_48:
  s_cmp_ge_u32 s29, 14
  s_cbranch_scc0 Lc_93
  s_cmp_eq_u32 s33, 0
  s_cbranch_scc0 Lc_94
  v_lshrrev_b32 v14, 4, v1
  v_lshlrev_b32 v14, 16, v14
  v_and_b32 v15, 15, v1
  v_lshl_add_u32 v14, v15, 4, v14
  s_lshl_b32 s55, s34, 10
  s_lshl_b32 s56, s35, 8
  s_add_u32 s55, s55, s56
  s_lshl_b32 s56, s30, 19
  s_add_u32 s55, s55, s56
  v_mov_b32 v252, v14
  s_add_u32 s90, s55, 3145728
  s_add_u32 s91, s55, 3407872
  v_mov_b32 v244, -1
  v_mov_b32 v245, -1
  v_mov_b32 v246, -1
  v_mov_b32 v247, -1
  buffer_store_dwordx4 v[244:247], v252, s[20:23], s90 offen sc1
  buffer_store_dwordx4 v[244:247], v252, s[20:23], s91 offen sc1
Lc_94:
  s_cmp_eq_u32 s33, 0
  s_cbranch_scc0 Lc_95
  s_cmp_lg_u32 s30, 0
  s_cbranch_scc1 Lw_96
  s_add_u32 m0, s87, 0
  s_add_u32 s54, s84, 0
  buffer_load_dwordx4 v254, s[16:19], s54 offen lds
  s_add_u32 m0, s87, 1024
  s_add_u32 s54, s84, 8192
  buffer_load_dwordx4 v254, s[16:19], s54 offen lds
  s_add_u32 m0, s87, 2048
  s_add_u32 s54, s84, 16384
  buffer_load_dwordx4 v254, s[16:19], s54 offen lds
  s_add_u32 m0, s87, 3072
  s_add_u32 s54, s84, 24576
  buffer_load_dwordx4 v254, s[16:19], s54 offen lds
  s_add_u32 m0, s87, 4096
  s_add_u32 s54, s84, 32768
  buffer_load_dwordx4 v254, s[16:19], s54 offen lds
  s_add_u32 m0, s87, 5120
  s_add_u32 s54, s84, 40960
  buffer_load_dwordx4 v254, s[16:19], s54 offen lds
  s_add_u32 m0, s87, 6144
  s_add_u32 s54, s84, 49152
  buffer_load_dwordx4 v254, s[16:19], s54 offen lds
  s_add_u32 m0, s87, 7168
  s_add_u32 s54, s84, 57344
  buffer_load_dwordx4 v254, s[16:19], s54 offen lds
  s_add_u32 m0, s87, 32768
  s_add_u32 s54, s84, 65536
  buffer_load_dwordx4 v254, s[16:19], s54 offen lds
  s_add_u32 m0, s87, 33792
  s_add_u32 s54, s84, 73728
  buffer_load_dwordx4 v254, s[16:19], s54 offen lds
  s_add_u32 m0, s87, 34816
  s_add_u32 s54, s84, 81920
  buffer_load_dwordx4 v254, s[16:19], s54 offen lds
  s_add_u32 m0, s87, 35840
  s_add_u32 s54, s84, 90112
  buffer_load_dwordx4 v254, s[16:19], s54 offen lds
  s_add_u32 m0, s87, 36864
  s_add_u32 s54, s84, 196608
  buffer_load_dwordx4 v254, s[16:19], s54 offen lds
  s_add_u32 m0, s87, 37888
  s_add_u32 s54, s84, 204800
  buffer_load_dwordx4 v254, s[16:19], s54 offen lds
  s_add_u32 m0, s87, 38912
  s_add_u32 s54, s84, 212992
  buffer_load_dwordx4 v254, s[16:19], s54 offen lds
  s_add_u32 m0, s87, 39936
  s_add_u32 s54, s84, 221184
  buffer_load_dwordx4 v254, s[16:19], s54 offen lds
  s_add_u32 m0, s88, 0
  s_add_u32 s54, s84, 229376
  buffer_load_dwordx4 v254, s[16:19], s54 offen lds
  s_add_u32 m0, s88, 1024
  s_add_u32 s54, s84, 237568
  buffer_load_dwordx4 v254, s[16:19], s54 offen lds
  s_add_u32 m0, s88, 2048
  s_add_u32 s54, s84, 245760
  buffer_load_dwordx4 v254, s[16:19], s54 offen lds
  s_add_u32 m0, s88, 3072
  s_add_u32 s54, s84, 253952
  buffer_load_dwordx4 v254, s[16:19], s54 offen lds
  s_add_u32 m0, s88, 4096
  s_add_u32 s54, s84, 262144
  buffer_load_dwordx4 v254, s[16:19], s54 offen lds
  s_add_u32 m0, s88, 5120
  s_add_u32 s54, s84, 270336
  buffer_load_dwordx4 v254, s[16:19], s54 offen lds
Lw_96:
  s_waitcnt vmcnt(0)
  s_barrier
  s_lshl_b32 s55, s35, 6
  s_add_u32 s55, s55, s34
  s_lshl_b32 s54, s55, 7
  s_add_u32 s54, s54, s46
  s_add_u32 s54, s54, 163840
  v_mov_b32 v14, s31
  v_mov_b32 v15, 0
  s_mov_b64 exec, 1
  buffer_store_dword v14, v15, s[20:23], s54 offen sc1
  s_mov_b64 exec, -1
Lc_95:
  v_lshrrev_b32 v12, 5, v1
  v_bfe_u32 v13, v1, 2, 2
  v_lshl_add_u32 v12, v12, 3, v13
  v_lshlrev_b32 v12, 7, v12
  v_bfe_u32 v14, v1, 4, 1
  v_and_b32 v15, 1, v1
  v_lshl_add_u32 v14, v14, 1, v15
  v_bfe_u32 v13, v1, 3, 1
  v_xor_b32 v13, s52, v13
  v_lshl_add_u32 v14, v13, 2, v14
  v_lshl_add_u32 v12, v14, 4, v12
  v_bfe_u32 v15, v1, 1, 1
  v_lshl_add_u32 v12, v15, 3, v12
  v_xor_b32 v13, 64, v12
  v_add_u32 v249, s88, v12
  v_add_u32 v251, s88, v13
  v_add_u32 v248, s87, v12
  v_add_u32 v250, s87, v13
  ds_read_b64_tr_b16 v[200:201], v248 offset:0
  ds_read_b64_tr_b16 v[202:203], v248 offset:512
  ds_read_b64_tr_b16 v[204:205], v250 offset:0
  ds_read_b64_tr_b16 v[206:207], v250 offset:512
  ds_read_b64_tr_b16 v[208:209], v248 offset:2048
  ds_read_b64_tr_b16 v[210:211], v248 offset:2560
  ds_read_b64_tr_b16 v[212:213], v250 offset:2048
  ds_read_b64_tr_b16 v[214:215], v250 offset:2560
  ds_read_b64_tr_b16 v[216:217], v248 offset:4096
  ds_read_b64_tr_b16 v[218:219], v248 offset:4608
  ds_read_b64_tr_b16 v[220:221], v250 offset:4096
  ds_read_b64_tr_b16 v[222:223], v250 offset:4608
  ds_read_b64_tr_b16 v[224:225], v248 offset:6144
  ds_read_b64_tr_b16 v[226:227], v248 offset:6656
  ds_read_b64_tr_b16 v[228:229], v250 offset:6144
  ds_read_b64_tr_b16 v[230:231], v250 offset:6656
  ds_read_b64_tr_b16 v[232:233], v248 offset:32768
  ds_read_b64_tr_b16 v[234:235], v248 offset:33280
  ds_read_b64_tr_b16 v[236:237], v250 offset:32768
  ds_read_b64_tr_b16 v[238:239], v250 offset:33280
  ds_read_b64_tr_b16 v[240:241], v248 offset:34816
  ds_read_b64_tr_b16 v[242:243], v248 offset:35328
  ds_read_b64_tr_b16 v[244:245], v250 offset:34816
  ds_read_b64_tr_b16 v[246:247], v250 offset:35328
  ds_read_b64_tr_b16 a[0:1], v248 offset:36864
  ds_read_b64_tr_b16 a[2:3], v248 offset:37376
  ds_read_b64_tr_b16 a[4:5], v250 offset:36864
  ds_read_b64_tr_b16 a[6:7], v250 offset:37376
  ds_read_b64_tr_b16 a[8:9], v248 offset:38912
  ds_read_b64_tr_b16 a[10:11], v248 offset:39424
  ds_read_b64_tr_b16 a[12:13], v250 offset:38912
  ds_read_b64_tr_b16 a[14:15], v250 offset:39424
  ds_read_b64_tr_b16 a[16:17], v249 offset:0
  ds_read_b64_tr_b16 a[18:19], v249 offset:512
  ds_read_b64_tr_b16 a[20:21], v251 offset:0
  ds_read_b64_tr_b16 a[22:23], v251 offset:512
  ds_read_b64_tr_b16 a[24:25], v249 offset:2048
  ds_read_b64_tr_b16 a[26:27], v249 offset:2560
  ds_read_b64_tr_b16 a[28:29], v251 offset:2048
  ds_read_b64_tr_b16 a[30:31], v251 offset:2560
  s_waitcnt lgkmcnt(0)
  s_cmp_eq_u32 s33, 0
  s_cbranch_scc0 Lc_97
  s_add_u32 m0, s87, 0
  s_add_u32 s54, s84, 98304
  buffer_load_dwordx4 v254, s[16:19], s54 offen lds
  s_add_u32 m0, s87, 1024
  s_add_u32 s54, s84, 106496
  buffer_load_dwordx4 v254, s[16:19], s54 offen lds
  s_add_u32 m0, s87, 2048
  s_add_u32 s54, s84, 114688
  buffer_load_dwordx4 v254, s[16:19], s54 offen lds
  s_add_u32 m0, s87, 3072
  s_add_u32 s54, s84, 122880
  buffer_load_dwordx4 v254, s[16:19], s54 offen lds
  s_add_u32 m0, s87, 4096
  s_add_u32 s54, s84, 131072
  buffer_load_dwordx4 v254, s[16:19], s54 offen lds
  s_add_u32 m0, s87, 5120
  s_add_u32 s54, s84, 139264
  buffer_load_dwordx4 v254, s[16:19], s54 offen lds
  s_add_u32 m0, s87, 6144
  s_add_u32 s54, s84, 147456
  buffer_load_dwordx4 v254, s[16:19], s54 offen lds
  s_add_u32 m0, s87, 7168
  s_add_u32 s54, s84, 155648
  buffer_load_dwordx4 v254, s[16:19], s54 offen lds
  s_add_u32 m0, s87, 32768
  s_add_u32 s54, s84, 163840
  buffer_load_dwordx4 v254, s[16:19], s54 offen lds
  s_add_u32 m0, s87, 33792
  s_add_u32 s54, s84, 172032
  buffer_load_dwordx4 v254, s[16:19], s54 offen lds
  s_add_u32 m0, s87, 34816
  s_add_u32 s54, s84, 180224
  buffer_load_dwordx4 v254, s[16:19], s54 offen lds
  s_add_u32 m0, s87, 35840
  s_add_u32 s54, s84, 188416
  buffer_load_dwordx4 v254, s[16:19], s54 offen lds
Lc_97:
  s_cmp_lg_u32 s33, 0
  s_cbranch_scc0 Lc_98
  s_add_u32 m0, s87, 0
  s_add_u32 s54, s84, 0
  buffer_load_dwordx4 v254, s[16:19], s54 offen lds
  s_add_u32 m0, s87, 1024
  s_add_u32 s54, s84, 8192
  buffer_load_dwordx4 v254, s[16:19], s54 offen lds
  s_add_u32 m0, s87, 2048
  s_add_u32 s54, s84, 16384
  buffer_load_dwordx4 v254, s[16:19], s54 offen lds
  s_add_u32 m0, s87, 3072
  s_add_u32 s54, s84, 24576
  buffer_load_dwordx4 v254, s[16:19], s54 offen lds
  s_add_u32 m0, s87, 4096
  s_add_u32 s54, s84, 32768
  buffer_load_dwordx4 v254, s[16:19], s54 offen lds
  s_add_u32 m0, s87, 5120
  s_add_u32 s54, s84, 40960
  buffer_load_dwordx4 v254, s[16:19], s54 offen lds
  s_add_u32 m0, s87, 6144
  s_add_u32 s54, s84, 49152
  buffer_load_dwordx4 v254, s[16:19], s54 offen lds
  s_add_u32 m0, s87, 7168
  s_add_u32 s54, s84, 57344
  buffer_load_dwordx4 v254, s[16:19], s54 offen lds
  s_add_u32 m0, s87, 32768
  s_add_u32 s54, s84, 65536
  buffer_load_dwordx4 v254, s[16:19], s54 offen lds
  s_add_u32 m0, s87, 33792
  s_add_u32 s54, s84, 73728
  buffer_load_dwordx4 v254, s[16:19], s54 offen lds
  s_add_u32 m0, s87, 34816
  s_add_u32 s54, s84, 81920
  buffer_load_dwordx4 v254, s[16:19], s54 offen lds
  s_add_u32 m0, s87, 35840
  s_add_u32 s54, s84, 90112
  buffer_load_dwordx4 v254, s[16:19], s54 offen lds
  s_add_u32 m0, s87, 36864
  s_add_u32 s54, s84, 376832
  buffer_load_dwordx4 v254, s[16:19], s54 offen lds
  s_add_u32 m0, s87, 37888
  s_add_u32 s54, s84, 385024
  buffer_load_dwordx4 v254, s[16:19], s54 offen lds
  s_add_u32 m0, s87, 38912
  s_add_u32 s54, s84, 393216
  buffer_load_dwordx4 v254, s[16:19], s54 offen lds
  s_add_u32 m0, s87, 39936
  s_add_u32 s54, s84, 401408
  buffer_load_dwordx4 v254, s[16:19], s54 offen lds
  s_add_u32 m0, s88, 0
  s_add_u32 s54, s84, 425984
  buffer_load_dwordx4 v254, s[16:19], s54 offen lds
  s_add_u32 m0, s88, 1024
  s_add_u32 s54, s84, 434176
  buffer_load_dwordx4 v254, s[16:19], s54 offen lds
  s_add_u32 m0, s88, 2048
  s_add_u32 s54, s84, 442368
  buffer_load_dwordx4 v254, s[16:19], s54 offen lds
  s_add_u32 m0, s88, 3072
  s_add_u32 s54, s84, 450560
  buffer_load_dwordx4 v254, s[16:19], s54 offen lds
Lc_98:
  s_add_u32 m0, s81, 0
  s_add_u32 s54, s84, 278528
  buffer_load_dwordx4 v254, s[16:19], s54 offen lds
  s_add_u32 m0, s81, 1024
  s_add_u32 s54, s84, 286720
  buffer_load_dwordx4 v254, s[16:19], s54 offen lds
  s_add_u32 m0, s81, 2048
  s_add_u32 s54, s84, 294912
  buffer_load_dwordx4 v254, s[16:19], s54 offen lds
  s_add_u32 m0, s81, 3072
  s_add_u32 s54, s84, 303104
  buffer_load_dwordx4 v254, s[16:19], s54 offen lds
  s_add_u32 m0, s81, 4096
  s_add_u32 s54, s84, 311296
  buffer_load_dwordx4 v254, s[16:19], s54 offen lds
  s_add_u32 m0, s81, 5120
  s_add_u32 s54, s84, 319488
  buffer_load_dwordx4 v254, s[16:19], s54 offen lds
  s_add_u32 m0, s81, 6144
  s_add_u32 s54, s84, 327680
  buffer_load_dwordx4 v254, s[16:19], s54 offen lds
  s_add_u32 m0, s81, 7168
  s_add_u32 s54, s84, 335872
  buffer_load_dwordx4 v254, s[16:19], s54 offen lds
  s_add_u32 m0, s82, 0
  s_add_u32 s54, s84, 344064
  buffer_load_dwordx4 v254, s[16:19], s54 offen lds
  s_add_u32 m0, s82, 1024
  s_add_u32 s54, s84, 352256
  buffer_load_dwordx4 v254, s[16:19], s54 offen lds
  s_add_u32 m0, s82, 2048
  s_add_u32 s54, s84, 360448
  buffer_load_dwordx4 v254, s[16:19], s54 offen lds
  s_add_u32 m0, s82, 3072
  s_add_u32 s54, s84, 368640
  buffer_load_dwordx4 v254, s[16:19], s54 offen lds
  s_add_u32 m0, s83, 0
  s_add_u32 s54, s84, 409600
  buffer_load_dwordx4 v254, s[16:19], s54 offen lds
  s_add_u32 m0, s83, 1024
  s_add_u32 s54, s84, 417792
  buffer_load_dwordx4 v254, s[16:19], s54 offen lds
  buffer_load_dwordx4 v[172:175], v2, s[20:23], s99 offen offset:0 sc1
  buffer_load_dwordx4 v[176:179], v2, s[20:23], s99 offen offset:1024 sc1
  s_cmp_eq_u32 s33, 0
  s_cbranch_scc0 Lc_99
  v_lshlrev_b32 v12, 7, v1
  s_add_u32 s56, s30, 0
Lit_100:
  s_mul_i32 s54, s56, 37
  s_lshr_b32 s54, s54, 8
  s_mul_i32 s55, s54, 7
  s_sub_u32 s55, s56, s55
  s_cmp_ge_u32 s54, 2
  s_cselect_b32 s57, s37, s36
  s_and_b32 s54, s54, 1
  s_lshl_b32 s54, s54, 5
  s_add_u32 s57, s57, s54
  s_and_b32 s54, s29, 1
  s_mul_i32 s58, s54, 7
  s_add_u32 s58, s58, s55
  s_lshl_b32 s58, s58, 13
  s_mul_i32 s57, s57, 114688
  s_add_u32 s58, s58, s57
  s_add_u32 s58, s58, 11534336
  buffer_load_dword v255, v12, s[20:23], s58 offen sc1
  s_add_u32 s56, s56, 4
  s_cmp_lt_u32 s56, 28
  s_cbranch_scc1 Lit_100
Lc_99:
  v_lshrrev_b32 v14, 5, v1
  v_bfe_u32 v15, v1, 2, 2
  v_lshl_add_u32 v14, v14, 3, v15
  v_lshlrev_b32 v14, 7, v14
  v_bfe_u32 v16, v1, 4, 1
  v_and_b32 v17, 1, v1
  v_lshl_add_u32 v16, v16, 1, v17
  v_bfe_u32 v15, v1, 3, 1
  v_xor_b32 v15, s52, v15
  v_lshl_add_u32 v16, v15, 2, v16
  v_lshl_add_u32 v14, v16, 4, v14
  v_bfe_u32 v17, v1, 1, 1
  v_lshl_add_u32 v14, v17, 3, v14
  v_xor_b32 v15, 64, v14
  v_add_u32 v180, s87, v14
  v_add_u32 v181, s81, v14
  v_add_u32 v182, s82, v14
  v_add_u32 v183, s83, v14
  v_add_u32 v184, s88, v14
  v_add_u32 v185, s87, v15
  v_add_u32 v186, s81, v15
  v_add_u32 v187, s82, v15
  v_add_u32 v188, s83, v15
  v_add_u32 v189, s88, v15
  s_mul_i32 s55, s30, 28672
  s_add_u32 s55, s55, s45
  s_mul_i32 s57, s33, 6144
  s_sub_u32 s58, 6144, s57
  s_mul_i32 s91, s51, 114688
  s_add_u32 s91, s91, s55
  s_add_u32 s92, s91, s57
  s_add_u32 s93, s91, s58
  s_mul_i32 s94, s53, 114688
  s_add_u32 s94, s94, s55
  s_add_u32 s95, s94, s57
  s_add_u32 s77, s94, s58
  v_lshrrev_b32 v12, 2, v1
  v_min_u32 v12, 13, v12
  v_lshlrev_b32 v12, 7, v12
  v_and_b32 v15, 3, v1
  v_lshl_add_u32 v12, v15, 2, v12
  s_lshl_b32 s90, s28, 11
  s_add_u32 s90, s90, 196608
  s_mov_b32 s47, 40000
Lp_101:
  buffer_load_dword v13, v12, s[20:23], s90 offen sc1
  s_waitcnt vmcnt(0)
  v_subrev_u32 v14, s31, v13
  v_cmp_lt_u32 vcc, 1, v14
  s_cbranch_vccz Ld_102
  s_sub_u32 s47, s47, 1
  s_cbranch_scc0 Lp_101
Ld_102:
  s_cmp_eq_u32 s33, 0
  s_cbranch_scc0 Lc_103
  buffer_load_dwordx4 v[144:147], v2, s[20:23], s92 offen offset:0 sc1
  buffer_load_dwordx4 v[148:151], v2, s[20:23], s92 offen offset:1024 sc1
  buffer_load_dwordx4 v[152:155], v2, s[20:23], s92 offen offset:2048 sc1
  buffer_load_dwordx4 v[156:159], v2, s[20:23], s92 offen offset:3072 sc1
  s_add_u32 s57, s92, 4096
  buffer_load_dwordx4 v[160:163], v2, s[20:23], s57 offen offset:0 sc1
  s_add_u32 s57, s92, 4096
  buffer_load_dwordx4 v[248:251], v2, s[20:23], s57 offen offset:1024 sc1
  s_add_u32 s57, s91, 16384
  buffer_load_dwordx4 v[80:83], v2, s[20:23], s57 offen offset:1024 sc1
  s_add_u32 s57, s91, 16384
  buffer_load_dwordx4 v[84:87], v2, s[20:23], s57 offen offset:2048 sc1
  buffer_load_dwordx4 v[88:91], v2, s[20:23], s93 offen offset:0 sc1
  buffer_load_dwordx4 v[92:95], v2, s[20:23], s93 offen offset:1024 sc1
Lc_103:
  s_cmp_lg_u32 s33, 0
  s_cbranch_scc0 Lc_104
  buffer_load_dwordx4 v[144:147], v2, s[20:23], s92 offen offset:0 sc1
  buffer_load_dwordx4 v[148:151], v2, s[20:23], s92 offen offset:1024 sc1
  buffer_load_dwordx4 v[152:155], v2, s[20:23], s92 offen offset:2048 sc1
  buffer_load_dwordx4 v[156:159], v2, s[20:23], s92 offen offset:3072 sc1
  s_add_u32 s57, s92, 4096
  buffer_load_dwordx4 v[160:163], v2, s[20:23], s57 offen offset:0 sc1
  s_add_u32 s57, s92, 4096
  buffer_load_dwordx4 v[248:251], v2, s[20:23], s57 offen offset:1024 sc1
  s_add_u32 s57, s91, 12288
  buffer_load_dwordx4 v[80:83], v2, s[20:23], s57 offen offset:0 sc1
  s_add_u32 s57, s91, 12288
  buffer_load_dwordx4 v[84:87], v2, s[20:23], s57 offen offset:1024 sc1
  s_add_u32 s57, s91, 12288
  buffer_load_dwordx4 v[88:91], v2, s[20:23], s57 offen offset:2048 sc1
  s_add_u32 s57, s91, 12288
  buffer_load_dwordx4 v[92:95], v2, s[20:23], s57 offen offset:3072 sc1
Lc_104:
  s_mov_b32 s89, s32
  buffer_load_dword v255, v12, s[20:23], s90 offen sc1
Lc_93:
  s_cmp_lg_u32 s33, 0
  s_cbranch_scc1 L_b2l1
  v_lshrrev_b32 v12, 2, v1
  v_min_u32 v12, 13, v12
  v_lshlrev_b32 v12, 7, v12
  v_and_b32 v15, 3, v1
  v_lshl_add_u32 v12, v15, 2, v12
  s_lshl_b32 s90, s28, 11
  s_add_u32 s90, s90, 131072
  s_waitcnt vmcnt(10)
  v_mfma_f32_32x32x16_bf16 v[16:31], v[200:203], v[144:147], 0
  buffer_load_dwordx4 v[96:99], v2, s[20:23], s93 offen offset:2048 sc1
  buffer_load_dwordx4 v[100:103], v2, s[20:23], s93 offen offset:3072 sc1
  v_mfma_f32_32x32x16_bf16 v[32:47], v[204:207], v[144:147], 0
  s_waitcnt vmcnt(11)
  v_mfma_f32_32x32x16_bf16 v[16:31], v[208:211], v[148:151], v[16:31]
  s_add_u32 s57, s93, 4096
  buffer_load_dwordx4 v[104:107], v2, s[20:23], s57 offen offset:0 sc1
  s_add_u32 s57, s93, 4096
  buffer_load_dwordx4 v[108:111], v2, s[20:23], s57 offen offset:1024 sc1
  v_mfma_f32_32x32x16_bf16 v[32:47], v[212:215], v[148:151], v[32:47]
  s_waitcnt vmcnt(12)
  v_mfma_f32_32x32x16_bf16 v[16:31], v[216:219], v[152:155], v[16:31]
  s_add_u32 s57, s91, 12288
  buffer_load_dwordx4 v[144:147], v2, s[20:23], s57 offen offset:0 sc1
  s_add_u32 s57, s91, 12288
  buffer_load_dwordx4 v[148:151], v2, s[20:23], s57 offen offset:1024 sc1
  v_mfma_f32_32x32x16_bf16 v[32:47], v[220:223], v[152:155], v[32:47]
  s_waitcnt vmcnt(13)
  v_mfma_f32_32x32x16_bf16 v[16:31], v[224:227], v[156:159], v[16:31]
  ds_read_b64_tr_b16 v[190:191], v181 offset:0
  ds_read_b64_tr_b16 v[192:193], v181 offset:512
  s_add_u32 s57, s91, 12288
  buffer_load_dwordx4 v[152:155], v2, s[20:23], s57 offen offset:2048 sc1
  v_mfma_f32_32x32x16_bf16 v[32:47], v[228:231], v[156:159], v[32:47]
  ds_read_b64_tr_b16 v[194:195], v186 offset:0
  ds_read_b64_tr_b16 v[196:197], v186 offset:512
  s_waitcnt vmcnt(7)
  v_mov_b32 v14, s31
  v_mov_b32 v15, 0
  s_mov_b64 exec, 1
  s_cmp_eq_u32 s89, 0
  s_cbranch_scc1 Ls_105
  buffer_store_dword v14, v15, s[20:23], s80 offen
Lb_106:
  s_mov_b64 exec, -1
  s_barrier
  v_mfma_f32_32x32x16_bf16 v[16:31], v[232:235], v[160:163], v[16:31]
  ds_read_b64_tr_b16 v[164:165], v181 offset:2048
  ds_read_b64_tr_b16 v[166:167], v181 offset:2560
  s_add_u32 s57, s91, 12288
  buffer_load_dwordx4 v[156:159], v2, s[20:23], s57 offen offset:3072 sc1
  v_mfma_f32_32x32x16_bf16 v[32:47], v[236:239], v[160:163], v[32:47]
  ds_read_b64_tr_b16 v[168:169], v186 offset:2048
  ds_read_b64_tr_b16 v[170:171], v186 offset:2560
  v_mfma_f32_32x32x16_bf16 v[16:31], v[240:243], v[248:251], v[16:31]
  ds_read_b64_tr_b16 v[112:113], v180 offset:0
  ds_read_b64_tr_b16 v[114:115], v180 offset:512
  s_add_u32 s57, s91, 16384
  buffer_load_dwordx4 v[160:163], v2, s[20:23], s57 offen offset:0 sc1
  v_mfma_f32_32x32x16_bf16 v[32:47], v[244:247], v[248:251], v[32:47]
  ds_read_b64_tr_b16 v[116:117], v185 offset:0
  ds_read_b64_tr_b16 v[118:119], v185 offset:512
  s_waitcnt lgkmcnt(8)
  v_mfma_f32_32x32x16_bf16 v[16:31], v[190:193], v[80:83], v[16:31]
  ds_read_b64_tr_b16 v[120:121], v180 offset:2048
  ds_read_b64_tr_b16 v[122:123], v180 offset:2560
  s_add_u32 s57, s91, 16384
  buffer_load_dwordx4 v[248:251], v2, s[20:23], s57 offen offset:3072 sc1
  v_mfma_f32_32x32x16_bf16 v[32:47], v[194:197], v[80:83], v[32:47]
  ds_read_b64_tr_b16 v[124:125], v185 offset:2048
  ds_read_b64_tr_b16 v[126:127], v185 offset:2560
  s_waitcnt lgkmcnt(8)
  v_mfma_f32_32x32x16_bf16 v[16:31], v[164:167], v[84:87], v[16:31]
  ds_read_b64_tr_b16 v[128:129], v180 offset:4096
  ds_read_b64_tr_b16 v[130:131], v180 offset:4608
  s_add_u32 s57, s91, 20480
  buffer_load_dwordx4 v[80:83], v2, s[20:23], s57 offen offset:0 sc1
  v_mfma_f32_32x32x16_bf16 v[32:47], v[168:171], v[84:87], v[32:47]
  ds_read_b64_tr_b16 v[132:133], v185 offset:4096
  ds_read_b64_tr_b16 v[134:135], v185 offset:4608
  s_waitcnt lgkmcnt(8)
  v_mfma_f32_32x32x16_bf16 v[16:31], v[112:115], v[88:91], v[16:31]
  ds_read_b64_tr_b16 v[136:137], v180 offset:6144
  ds_read_b64_tr_b16 v[138:139], v180 offset:6656
  s_add_u32 s57, s91, 20480
  buffer_load_dwordx4 v[84:87], v2, s[20:23], s57 offen offset:1024 sc1
  v_mfma_f32_32x32x16_bf16 v[32:47], v[116:119], v[88:91], v[32:47]
  ds_read_b64_tr_b16 v[140:141], v185 offset:6144
  ds_read_b64_tr_b16 v[142:143], v185 offset:6656
  s_add_u32 m0, s82, 16384
  s_add_u32 s54, s84, 376832
  buffer_load_dwordx4 v254, s[16:19], s54 offen lds
  s_waitcnt lgkmcnt(8)
  v_mfma_f32_32x32x16_bf16 v[16:31], v[120:123], v[92:95], v[16:31]
  ds_read_b64_tr_b16 v[112:113], v180 offset:32768
  ds_read_b64_tr_b16 v[114:115], v180 offset:33280
  s_add_u32 s57, s91, 20480
  buffer_load_dwordx4 v[88:91], v2, s[20:23], s57 offen offset:2048 sc1
  v_mfma_f32_32x32x16_bf16 v[32:47], v[124:127], v[92:95], v[32:47]
  ds_read_b64_tr_b16 v[116:117], v185 offset:32768
  ds_read_b64_tr_b16 v[118:119], v185 offset:33280
  s_add_u32 m0, s82, 17408
  s_add_u32 s54, s84, 385024
  buffer_load_dwordx4 v254, s[16:19], s54 offen lds
  s_waitcnt lgkmcnt(8)
  s_waitcnt vmcnt(15)
  v_mfma_f32_32x32x16_bf16 v[16:31], v[128:131], v[96:99], v[16:31]
  ds_read_b64_tr_b16 v[120:121], v180 offset:34816
  ds_read_b64_tr_b16 v[122:123], v180 offset:35328
  buffer_load_dword v13, v12, s[20:23], s90 offen sc1
  s_add_u32 s57, s91, 20480
  buffer_load_dwordx4 v[92:95], v2, s[20:23], s57 offen offset:3072 sc1
  v_mfma_f32_32x32x16_bf16 v[32:47], v[132:135], v[96:99], v[32:47]
  ds_read_b64_tr_b16 v[124:125], v185 offset:34816
  ds_read_b64_tr_b16 v[126:127], v185 offset:35328
  s_add_u32 m0, s82, 18432
  s_add_u32 s54, s84, 393216
  buffer_load_dwordx4 v254, s[16:19], s54 offen lds
  s_waitcnt lgkmcnt(8)
  s_waitcnt vmcnt(17)
  v_mfma_f32_32x32x16_bf16 v[16:31], v[136:139], v[100:103], v[16:31]
  ds_read_b64_tr_b16 v[128:129], v180 offset:36864
  ds_read_b64_tr_b16 v[130:131], v180 offset:37376
  s_add_u32 s57, s91, 24576
  buffer_load_dwordx4 v[96:99], v2, s[20:23], s57 offen offset:0 sc1
  v_mfma_f32_32x32x16_bf16 v[32:47], v[140:143], v[100:103], v[32:47]
  ds_read_b64_tr_b16 v[132:133], v185 offset:36864
  ds_read_b64_tr_b16 v[134:135], v185 offset:37376
  s_add_u32 m0, s82, 19456
  s_add_u32 s54, s84, 401408
  buffer_load_dwordx4 v254, s[16:19], s54 offen lds
  s_waitcnt lgkmcnt(8)
  s_waitcnt vmcnt(18)
  v_mfma_f32_32x32x16_bf16 v[16:31], v[112:115], v[104:107], v[16:31]
  ds_read_b64_tr_b16 v[136:137], v180 offset:38912
  ds_read_b64_tr_b16 v[138:139], v180 offset:39424
  s_add_u32 s57, s91, 24576
  buffer_load_dwordx4 v[100:103], v2, s[20:23], s57 offen offset:1024 sc1
  v_mfma_f32_32x32x16_bf16 v[32:47], v[116:119], v[104:107], v[32:47]
  ds_read_b64_tr_b16 v[140:141], v185 offset:38912
  ds_read_b64_tr_b16 v[142:143], v185 offset:39424
  s_add_u32 m0, s81, 0
  s_add_u32 s54, s84, 425984
  buffer_load_dwordx4 v254, s[16:19], s54 offen lds
  s_waitcnt lgkmcnt(8)
  s_waitcnt vmcnt(19)
  v_mfma_f32_32x32x16_bf16 v[16:31], v[120:123], v[108:111], v[16:31]
  ds_read_b64_tr_b16 v[112:113], v184 offset:0
  ds_read_b64_tr_b16 v[114:115], v184 offset:512
  s_add_u32 s57, s91, 24576
  buffer_load_dwordx4 v[104:107], v2, s[20:23], s57 offen offset:2048 sc1
  v_mfma_f32_32x32x16_bf16 v[32:47], v[124:127], v[108:111], v[32:47]
  ds_read_b64_tr_b16 v[116:117], v189 offset:0
  ds_read_b64_tr_b16 v[118:119], v189 offset:512
  s_add_u32 m0, s81, 1024
  s_add_u32 s54, s84, 434176
  buffer_load_dwordx4 v254, s[16:19], s54 offen lds
  s_waitcnt lgkmcnt(8)
  s_waitcnt vmcnt(20)
  v_mfma_f32_32x32x16_bf16 v[16:31], v[128:131], v[144:147], v[16:31]
  ds_read_b64_tr_b16 v[120:121], v184 offset:2048
  ds_read_b64_tr_b16 v[122:123], v184 offset:2560
  s_waitcnt vmcnt(8)
  v_subrev_u32 v14, s31, v13
  v_cmp_lt_u32 vcc, 1, v14
  s_cbranch_vccnz Lpf_107
Lpb_108:
  s_add_u32 s57, s91, 24576
  buffer_load_dwordx4 v[108:111], v2, s[20:23], s57 offen offset:3072 sc1
  v_mfma_f32_32x32x16_bf16 v[32:47], v[132:135], v[144:147], v[32:47]
  ds_read_b64_tr_b16 v[124:125], v189 offset:2048
  ds_read_b64_tr_b16 v[126:127], v189 offset:2560
  s_add_u32 m0, s81, 2048
  s_add_u32 s54, s84, 442368
  buffer_load_dwordx4 v254, s[16:19], s54 offen lds
  s_waitcnt lgkmcnt(8)
  v_mfma_f32_32x32x16_bf16 v[16:31], v[136:139], v[148:151], v[16:31]
  ds_read_b64_tr_b16 v[128:129], v184 offset:4096
  ds_read_b64_tr_b16 v[130:131], v184 offset:4608
  s_add_u32 s57, s94, 24576
  buffer_load_dwordx4 v[144:147], v2, s[20:23], s57 offen offset:2048 sc1
  v_mfma_f32_32x32x16_bf16 v[32:47], v[140:143], v[148:151], v[32:47]
  ds_read_b64_tr_b16 v[132:133], v189 offset:4096
  ds_read_b64_tr_b16 v[134:135], v189 offset:4608
  s_add_u32 m0, s81, 3072
  s_add_u32 s54, s84, 450560
  buffer_load_dwordx4 v254, s[16:19], s54 offen lds
  s_waitcnt lgkmcnt(8)
  v_mfma_f32_32x32x16_bf16 v[16:31], v[112:115], v[152:155], v[16:31]
  ds_read_b64_tr_b16 v[136:137], v181 offset:4096
  ds_read_b64_tr_b16 v[138:139], v181 offset:4608
  s_add_u32 s57, s94, 24576
  buffer_load_dwordx4 v[148:151], v2, s[20:23], s57 offen offset:3072 sc1
  v_mfma_f32_32x32x16_bf16 v[32:47], v[116:119], v[152:155], v[32:47]
  ds_read_b64_tr_b16 v[140:141], v186 offset:4096
  ds_read_b64_tr_b16 v[142:143], v186 offset:4608
  s_waitcnt lgkmcnt(8)
  v_mfma_f32_32x32x16_bf16 v[16:31], v[120:123], v[156:159], v[16:31]
  ds_read_b64_tr_b16 v[112:113], v181 offset:6144
  ds_read_b64_tr_b16 v[114:115], v181 offset:6656
  s_add_u32 s57, s94, 16384
  buffer_load_dwordx4 v[152:155], v2, s[20:23], s57 offen offset:3072 sc1
  v_mfma_f32_32x32x16_bf16 v[32:47], v[124:127], v[156:159], v[32:47]
  ds_read_b64_tr_b16 v[116:117], v186 offset:6144
  ds_read_b64_tr_b16 v[118:119], v186 offset:6656
  s_waitcnt lgkmcnt(8)
  v_mfma_f32_32x32x16_bf16 v[16:31], v[128:131], v[160:163], v[16:31]
  ds_read_b64_tr_b16 v[120:121], v182 offset:0
  ds_read_b64_tr_b16 v[122:123], v182 offset:512
  s_add_u32 s57, s94, 20480
  buffer_load_dwordx4 v[156:159], v2, s[20:23], s57 offen offset:0 sc1
  v_mfma_f32_32x32x16_bf16 v[32:47], v[132:135], v[160:163], v[32:47]
  ds_read_b64_tr_b16 v[124:125], v187 offset:0
  ds_read_b64_tr_b16 v[126:127], v187 offset:512
  s_waitcnt lgkmcnt(8)
  v_mfma_f32_32x32x16_bf16 v[16:31], v[136:139], v[248:251], v[16:31]
  ds_read_b64_tr_b16 v[128:129], v182 offset:2048
  ds_read_b64_tr_b16 v[130:131], v182 offset:2560
  s_add_u32 s57, s94, 20480
  buffer_load_dwordx4 v[160:163], v2, s[20:23], s57 offen offset:1024 sc1
  v_mfma_f32_32x32x16_bf16 v[32:47], v[140:143], v[248:251], v[32:47]
  ds_read_b64_tr_b16 v[132:133], v187 offset:2048
  ds_read_b64_tr_b16 v[134:135], v187 offset:2560
  s_waitcnt lgkmcnt(8)
  v_mfma_f32_32x32x16_bf16 v[16:31], v[112:115], v[80:83], v[16:31]
  s_waitcnt vmcnt(12)
  ds_read_b64_tr_b16 v[136:137], v182 offset:16384
  ds_read_b64_tr_b16 v[138:139], v182 offset:16896
  s_add_u32 s57, s94, 20480
  buffer_load_dwordx4 v[248:251], v2, s[20:23], s57 offen offset:2048 sc1
  v_mfma_f32_32x32x16_bf16 v[32:47], v[116:119], v[80:83], v[32:47]
  ds_read_b64_tr_b16 v[140:141], v187 offset:16384
  ds_read_b64_tr_b16 v[142:143], v187 offset:16896
  s_waitcnt lgkmcnt(8)
  v_mfma_f32_32x32x16_bf16 v[16:31], v[120:123], v[84:87], v[16:31]
  ds_read_b64_tr_b16 v[112:113], v182 offset:18432
  ds_read_b64_tr_b16 v[114:115], v182 offset:18944
  s_add_u32 s57, s94, 20480
  buffer_load_dwordx4 v[80:83], v2, s[20:23], s57 offen offset:3072 sc1
  v_mfma_f32_32x32x16_bf16 v[32:47], v[124:127], v[84:87], v[32:47]
  ds_read_b64_tr_b16 v[116:117], v187 offset:18432
  ds_read_b64_tr_b16 v[118:119], v187 offset:18944
  s_waitcnt lgkmcnt(8)
  v_mfma_f32_32x32x16_bf16 v[16:31], v[128:131], v[88:91], v[16:31]
  ds_read_b64_tr_b16 v[120:121], v183 offset:0
  ds_read_b64_tr_b16 v[122:123], v183 offset:512
  s_add_u32 s57, s94, 24576
  buffer_load_dwordx4 v[84:87], v2, s[20:23], s57 offen offset:0 sc1
  v_mfma_f32_32x32x16_bf16 v[32:47], v[132:135], v[88:91], v[32:47]
  ds_read_b64_tr_b16 v[124:125], v188 offset:0
  ds_read_b64_tr_b16 v[126:127], v188 offset:512
  s_waitcnt lgkmcnt(8)
  v_mfma_f32_32x32x16_bf16 v[16:31], v[136:139], v[92:95], v[16:31]
  s_waitcnt vmcnt(11)
  ds_read_b64_tr_b16 v[128:129], v181 offset:0
  ds_read_b64_tr_b16 v[130:131], v181 offset:512
  s_add_u32 s57, s94, 24576
  buffer_load_dwordx4 v[88:91], v2, s[20:23], s57 offen offset:1024 sc1
  v_mfma_f32_32x32x16_bf16 v[32:47], v[140:143], v[92:95], v[32:47]
  ds_read_b64_tr_b16 v[132:133], v186 offset:0
  ds_read_b64_tr_b16 v[134:135], v186 offset:512
  s_waitcnt lgkmcnt(8)
  v_mfma_f32_32x32x16_bf16 v[16:31], v[112:115], v[96:99], v[16:31]
  s_waitcnt vmcnt(8)
  ds_read_b64_tr_b16 v[136:137], v181 offset:2048
  ds_read_b64_tr_b16 v[138:139], v181 offset:2560
  buffer_load_dwordx4 v[92:95], v2, s[20:23], s77 offen offset:0 sc1
  v_mfma_f32_32x32x16_bf16 v[32:47], v[116:119], v[96:99], v[32:47]
  ds_read_b64_tr_b16 v[140:141], v186 offset:2048
  ds_read_b64_tr_b16 v[142:143], v186 offset:2560
  s_waitcnt lgkmcnt(8)
  v_mfma_f32_32x32x16_bf16 v[16:31], v[120:123], v[100:103], v[16:31]
  ds_read_b64_tr_b16 v[112:113], v181 offset:0
  ds_read_b64_tr_b16 v[114:115], v181 offset:512
  buffer_load_dwordx4 v[96:99], v2, s[20:23], s77 offen offset:1024 sc1
  v_mfma_f32_32x32x16_bf16 v[32:47], v[124:127], v[100:103], v[32:47]
  ds_read_b64_tr_b16 v[116:117], v186 offset:0
  ds_read_b64_tr_b16 v[118:119], v186 offset:512
  s_waitcnt lgkmcnt(8)
  v_mfma_f32_32x32x16_bf16 v[16:31], v[128:131], v[104:107], v[16:31]
  ds_read_b64_tr_b16 v[120:121], v181 offset:2048
  ds_read_b64_tr_b16 v[122:123], v181 offset:2560
  buffer_load_dwordx4 v[100:103], v2, s[20:23], s77 offen offset:2048 sc1
  v_mfma_f32_32x32x16_bf16 v[32:47], v[132:135], v[104:107], v[32:47]
  ds_read_b64_tr_b16 v[124:125], v186 offset:2048
  ds_read_b64_tr_b16 v[126:127], v186 offset:2560
  s_waitcnt lgkmcnt(8)
  v_mfma_f32_32x32x16_bf16 v[16:31], v[136:139], v[108:111], v[16:31]
  ds_read_b64_tr_b16 v[128:129], v181 offset:4096
  ds_read_b64_tr_b16 v[130:131], v181 offset:4608
  buffer_load_dwordx4 v[104:107], v2, s[20:23], s77 offen offset:3072 sc1
  v_mfma_f32_32x32x16_bf16 v[32:47], v[140:143], v[108:111], v[32:47]
  ds_read_b64_tr_b16 v[132:133], v186 offset:4096
  ds_read_b64_tr_b16 v[134:135], v186 offset:4608
  s_waitcnt lgkmcnt(8)
  v_mfma_f32_32x32x16_bf16 v[48:63], v[112:115], v[144:147], 0
  ds_read_b64_tr_b16 v[136:137], v181 offset:6144
  ds_read_b64_tr_b16 v[138:139], v181 offset:6656
  s_add_u32 s57, s77, 4096
  buffer_load_dwordx4 v[108:111], v2, s[20:23], s57 offen offset:0 sc1
  v_mfma_f32_32x32x16_bf16 v[64:79], v[116:119], v[144:147], 0
  ds_read_b64_tr_b16 v[140:141], v186 offset:6144
  ds_read_b64_tr_b16 v[142:143], v186 offset:6656
  s_waitcnt lgkmcnt(8)
  s_waitcnt vmcnt(12)
  v_mfma_f32_32x32x16_bf16 v[48:63], v[120:123], v[148:151], v[48:63]
  ds_read_b64_tr_b16 v[112:113], v182 offset:0
  ds_read_b64_tr_b16 v[114:115], v182 offset:512
  s_add_u32 s57, s77, 4096
  buffer_load_dwordx4 v[144:147], v2, s[20:23], s57 offen offset:1024 sc1
  v_mfma_f32_32x32x16_bf16 v[64:79], v[124:127], v[148:151], v[64:79]
  ds_read_b64_tr_b16 v[116:117], v187 offset:0
  ds_read_b64_tr_b16 v[118:119], v187 offset:512
  s_waitcnt lgkmcnt(8)
  s_waitcnt vmcnt(12)
  v_mfma_f32_32x32x16_bf16 v[48:63], v[128:131], v[152:155], v[48:63]
  ds_read_b64_tr_b16 v[120:121], v182 offset:2048
  ds_read_b64_tr_b16 v[122:123], v182 offset:2560
  s_add_u32 s57, s94, 12288
  buffer_load_dwordx4 v[148:151], v2, s[20:23], s57 offen offset:0 sc1
  v_mfma_f32_32x32x16_bf16 v[64:79], v[132:135], v[152:155], v[64:79]
  ds_read_b64_tr_b16 v[124:125], v187 offset:2048
  ds_read_b64_tr_b16 v[126:127], v187 offset:2560
  s_waitcnt lgkmcnt(8)
  s_waitcnt vmcnt(12)
  v_mfma_f32_32x32x16_bf16 v[48:63], v[136:139], v[156:159], v[48:63]
  ds_read_b64_tr_b16 v[128:129], v182 offset:16384
  ds_read_b64_tr_b16 v[130:131], v182 offset:16896
  s_add_u32 s57, s94, 12288
  buffer_load_dwordx4 v[152:155], v2, s[20:23], s57 offen offset:1024 sc1
  v_mfma_f32_32x32x16_bf16 v[64:79], v[140:143], v[156:159], v[64:79]
  ds_read_b64_tr_b16 v[132:133], v187 offset:16384
  ds_read_b64_tr_b16 v[134:135], v187 offset:16896
  s_waitcnt lgkmcnt(8)
  s_waitcnt vmcnt(12)
  v_mfma_f32_32x32x16_bf16 v[48:63], v[112:115], v[160:163], v[48:63]
  ds_read_b64_tr_b16 v[136:137], v182 offset:18432
  ds_read_b64_tr_b16 v[138:139], v182 offset:18944
  s_add_u32 s57, s94, 12288
  buffer_load_dwordx4 v[156:159], v2, s[20:23], s57 offen offset:2048 sc1
  v_mfma_f32_32x32x16_bf16 v[64:79], v[116:119], v[160:163], v[64:79]
  ds_read_b64_tr_b16 v[140:141], v187 offset:18432
  ds_read_b64_tr_b16 v[142:143], v187 offset:18944
  s_waitcnt lgkmcnt(8)
  s_waitcnt vmcnt(12)
  v_mfma_f32_32x32x16_bf16 v[48:63], v[120:123], v[248:251], v[48:63]
  ds_read_b64_tr_b16 v[112:113], v183 offset:0
  ds_read_b64_tr_b16 v[114:115], v183 offset:512
  s_add_u32 s57, s94, 12288
  buffer_load_dwordx4 v[160:163], v2, s[20:23], s57 offen offset:3072 sc1
  v_mfma_f32_32x32x16_bf16 v[64:79], v[124:127], v[248:251], v[64:79]
  ds_read_b64_tr_b16 v[116:117], v188 offset:0
  ds_read_b64_tr_b16 v[118:119], v188 offset:512
  s_waitcnt lgkmcnt(8)
  s_waitcnt vmcnt(12)
  v_mfma_f32_32x32x16_bf16 v[48:63], v[128:131], v[80:83], v[48:63]
  ds_read_b64_tr_b16 v[120:121], v180 offset:0
  ds_read_b64_tr_b16 v[122:123], v180 offset:512
  s_add_u32 s57, s94, 16384
  buffer_load_dwordx4 v[248:251], v2, s[20:23], s57 offen offset:0 sc1
  v_mfma_f32_32x32x16_bf16 v[64:79], v[132:135], v[80:83], v[64:79]
  ds_read_b64_tr_b16 v[124:125], v185 offset:0
  ds_read_b64_tr_b16 v[126:127], v185 offset:512
  s_waitcnt lgkmcnt(8)
  s_waitcnt vmcnt(12)
  v_mfma_f32_32x32x16_bf16 v[48:63], v[136:139], v[84:87], v[48:63]
  ds_read_b64_tr_b16 v[128:129], v180 offset:2048
  ds_read_b64_tr_b16 v[130:131], v180 offset:2560
  s_add_u32 s57, s94, 16384
  buffer_load_dwordx4 v[80:83], v2, s[20:23], s57 offen offset:1024 sc1
  v_mfma_f32_32x32x16_bf16 v[64:79], v[140:143], v[84:87], v[64:79]
  ds_read_b64_tr_b16 v[132:133], v185 offset:2048
  ds_read_b64_tr_b16 v[134:135], v185 offset:2560
  s_waitcnt lgkmcnt(8)
  s_waitcnt vmcnt(12)
  v_mfma_f32_32x32x16_bf16 v[48:63], v[112:115], v[88:91], v[48:63]
  ds_read_b64_tr_b16 v[136:137], v180 offset:4096
  ds_read_b64_tr_b16 v[138:139], v180 offset:4608
  s_add_u32 s57, s94, 16384
  buffer_load_dwordx4 v[84:87], v2, s[20:23], s57 offen offset:2048 sc1
  v_mfma_f32_32x32x16_bf16 v[64:79], v[116:119], v[88:91], v[64:79]
  ds_read_b64_tr_b16 v[140:141], v185 offset:4096
  ds_read_b64_tr_b16 v[142:143], v185 offset:4608
  v_add_u32 v14, s81, v2
  v_add_u32 v15, s82, v2
  s_waitcnt lgkmcnt(8)
  s_waitcnt vmcnt(12)
  v_mfma_f32_32x32x16_bf16 v[48:63], v[120:123], v[92:95], v[48:63]
  ds_read_b64_tr_b16 v[112:113], v180 offset:6144
  ds_read_b64_tr_b16 v[114:115], v180 offset:6656
  buffer_load_dwordx4 v[88:91], v2, s[20:23], s95 offen offset:0 sc1
  v_mfma_f32_32x32x16_bf16 v[64:79], v[124:127], v[92:95], v[64:79]
  ds_read_b64_tr_b16 v[116:117], v185 offset:6144
  ds_read_b64_tr_b16 v[118:119], v185 offset:6656
  s_waitcnt lgkmcnt(8)
  s_waitcnt vmcnt(12)
  v_mfma_f32_32x32x16_bf16 v[48:63], v[128:131], v[96:99], v[48:63]
  ds_read_b64_tr_b16 v[120:121], v180 offset:32768
  ds_read_b64_tr_b16 v[122:123], v180 offset:33280
  buffer_load_dwordx4 v[92:95], v2, s[20:23], s95 offen offset:1024 sc1
  v_mfma_f32_32x32x16_bf16 v[64:79], v[132:135], v[96:99], v[64:79]
  ds_read_b64_tr_b16 v[124:125], v185 offset:32768
  ds_read_b64_tr_b16 v[126:127], v185 offset:33280
  ds_write_b128 v14, v[16:19] offset:0
  s_waitcnt lgkmcnt(9)
  s_waitcnt vmcnt(12)
  v_mfma_f32_32x32x16_bf16 v[48:63], v[136:139], v[100:103], v[48:63]
  ds_read_b64_tr_b16 v[128:129], v180 offset:34816
  ds_read_b64_tr_b16 v[130:131], v180 offset:35328
  buffer_load_dwordx4 v[96:99], v2, s[20:23], s95 offen offset:2048 sc1
  v_mfma_f32_32x32x16_bf16 v[64:79], v[140:143], v[100:103], v[64:79]
  ds_read_b64_tr_b16 v[132:133], v185 offset:34816
  ds_read_b64_tr_b16 v[134:135], v185 offset:35328
  ds_write_b128 v14, v[20:23] offset:1024
  s_waitcnt lgkmcnt(10)
  s_waitcnt vmcnt(12)
  v_mfma_f32_32x32x16_bf16 v[48:63], v[112:115], v[104:107], v[48:63]
  ds_read_b64_tr_b16 v[136:137], v180 offset:36864
  ds_read_b64_tr_b16 v[138:139], v180 offset:37376
  buffer_load_dwordx4 v[100:103], v2, s[20:23], s95 offen offset:3072 sc1
  v_mfma_f32_32x32x16_bf16 v[64:79], v[116:119], v[104:107], v[64:79]
  ds_read_b64_tr_b16 v[140:141], v185 offset:36864
  ds_read_b64_tr_b16 v[142:143], v185 offset:37376
  ds_write_b128 v14, v[24:27] offset:2048
  s_waitcnt lgkmcnt(11)
  s_waitcnt vmcnt(12)
  v_mfma_f32_32x32x16_bf16 v[48:63], v[120:123], v[108:111], v[48:63]
  ds_read_b64_tr_b16 v[112:113], v180 offset:38912
  ds_read_b64_tr_b16 v[114:115], v180 offset:39424
  s_add_u32 s57, s95, 4096
  buffer_load_dwordx4 v[104:107], v2, s[20:23], s57 offen offset:0 sc1
  v_mfma_f32_32x32x16_bf16 v[64:79], v[124:127], v[108:111], v[64:79]
  ds_read_b64_tr_b16 v[116:117], v185 offset:38912
  ds_read_b64_tr_b16 v[118:119], v185 offset:39424
  ds_write_b128 v14, v[28:31] offset:3072
  s_waitcnt lgkmcnt(11)
  s_waitcnt vmcnt(12)
  v_mfma_f32_32x32x16_bf16 v[48:63], v[128:131], v[144:147], v[48:63]
  ds_read_b64_tr_b16 v[120:121], v184 offset:0
  ds_read_b64_tr_b16 v[122:123], v184 offset:512
  s_add_u32 s57, s95, 4096
  buffer_load_dwordx4 v[108:111], v2, s[20:23], s57 offen offset:1024 sc1
  v_mfma_f32_32x32x16_bf16 v[64:79], v[132:135], v[144:147], v[64:79]
  ds_read_b64_tr_b16 v[124:125], v189 offset:0
  ds_read_b64_tr_b16 v[126:127], v189 offset:512
  ds_write_b128 v14, v[32:35] offset:4096
  s_waitcnt lgkmcnt(11)
  s_waitcnt vmcnt(12)
  v_mfma_f32_32x32x16_bf16 v[48:63], v[136:139], v[148:151], v[48:63]
  ds_read_b64_tr_b16 v[128:129], v184 offset:2048
  ds_read_b64_tr_b16 v[130:131], v184 offset:2560
  v_mfma_f32_32x32x16_bf16 v[64:79], v[140:143], v[148:151], v[64:79]
  ds_read_b64_tr_b16 v[132:133], v189 offset:2048
  ds_read_b64_tr_b16 v[134:135], v189 offset:2560
  ds_write_b128 v14, v[36:39] offset:5120
  s_waitcnt lgkmcnt(11)
  s_waitcnt vmcnt(11)
  v_mfma_f32_32x32x16_bf16 v[48:63], v[112:115], v[152:155], v[48:63]
  ds_read_b64_tr_b16 v[136:137], v184 offset:4096
  ds_read_b64_tr_b16 v[138:139], v184 offset:4608
  v_mfma_f32_32x32x16_bf16 v[64:79], v[116:119], v[152:155], v[64:79]
  ds_read_b64_tr_b16 v[140:141], v189 offset:4096
  ds_read_b64_tr_b16 v[142:143], v189 offset:4608
  ds_write_b128 v14, v[40:43] offset:6144
  s_waitcnt lgkmcnt(11)
  s_waitcnt vmcnt(10)
  v_mfma_f32_32x32x16_bf16 v[48:63], v[120:123], v[156:159], v[48:63]
  v_mfma_f32_32x32x16_bf16 v[64:79], v[124:127], v[156:159], v[64:79]
  ds_write_b128 v14, v[44:47] offset:7168
  s_waitcnt lgkmcnt(7)
  s_waitcnt vmcnt(9)
  v_mfma_f32_32x32x16_bf16 v[48:63], v[128:131], v[160:163], v[48:63]
  v_mfma_f32_32x32x16_bf16 v[64:79], v[132:135], v[160:163], v[64:79]
  s_lshr_b32 s54, s39, 1
  s_add_u32 s55, s39, 1
  s_lshr_b32 s55, s55, 1
  s_and_b32 s55, s55, 3
  s_lshl_b32 s54, s54, 13
  s_lshl_b32 s55, s55, 13
  v_lshlrev_b32 v12, 7, v1
  v_add_u32 v13, s55, v12
  v_add_u32 v12, s54, v12
  s_mov_b32 s90, 229376
  buffer_load_dword v252, v12, s[20:23], s90 offen sc1
  buffer_load_dword v253, v13, s[20:23], s90 offen sc1
  s_waitcnt lgkmcnt(2)
  s_waitcnt vmcnt(10)
  v_mfma_f32_32x32x16_bf16 v[48:63], v[136:139], v[248:251], v[48:63]
  v_mfma_f32_32x32x16_bf16 v[64:79], v[140:143], v[248:251], v[64:79]
  s_waitcnt vmcnt(9)
  v_mfma_f32_32x32x16_bf16 v[64:79], v[194:197], v[80:83], v[64:79]
  s_waitcnt vmcnt(8)
  v_mfma_f32_32x32x16_bf16 v[64:79], v[168:171], v[84:87], v[64:79]
  v_lshlrev_b32 v112, 16, v172
  v_and_b32 v113, 0xffff0000, v172
  v_lshlrev_b32 v114, 16, v173
  v_and_b32 v115, 0xffff0000, v173
  v_lshlrev_b32 v116, 16, v174
  v_and_b32 v117, 0xffff0000, v174
  v_lshlrev_b32 v118, 16, v175
  v_and_b32 v119, 0xffff0000, v175
  s_waitcnt vmcnt(7)
  v_mfma_f32_32x32x16_bf16 v[64:79], v[204:207], v[88:91], v[64:79]
  v_lshlrev_b32 v120, 16, v176
  v_and_b32 v121, 0xffff0000, v176
  v_lshlrev_b32 v122, 16, v177
  v_and_b32 v123, 0xffff0000, v177
  v_lshlrev_b32 v124, 16, v178
  v_and_b32 v125, 0xffff0000, v178
  v_lshlrev_b32 v126, 16, v179
  v_and_b32 v127, 0xffff0000, v179
  s_waitcnt vmcnt(6)
  v_mfma_f32_32x32x16_bf16 v[64:79], v[212:215], v[92:95], v[64:79]
  s_lshr_b32 s56, s30, 1
  s_sub_u32 s54, 13, s56
  s_lshl_b32 s55, s56, 1
  s_lshl_b32 s55, 4096, s55
  s_lshl_b32 s56, s56, 15
  s_xor_b32 s57, s30, 1
  s_lshl_b32 s57, s57, s54
  s_add_u32 s57, s57, s56
  s_waitcnt vmcnt(5)
  v_mfma_f32_32x32x16_bf16 v[64:79], v[220:223], v[96:99], v[64:79]
  s_add_u32 s57, s57, s55
  v_add_u32 v181, s57, v2
  s_xor_b32 s57, s30, 2
  s_lshl_b32 s57, s57, s54
  s_add_u32 s57, s57, s56
  v_add_u32 v182, s57, v2
  s_xor_b32 s57, s30, 3
  s_lshl_b32 s57, s57, s54
  s_waitcnt vmcnt(4)
  v_mfma_f32_32x32x16_bf16 v[64:79], v[228:231], v[100:103], v[64:79]
  s_add_u32 s57, s57, s56
  s_add_u32 s57, s57, s55
  v_add_u32 v183, s57, v2
  s_waitcnt vmcnt(3)
  v_mfma_f32_32x32x16_bf16 v[64:79], v[236:239], v[104:107], v[64:79]
  s_waitcnt vmcnt(2)
  v_mfma_f32_32x32x16_bf16 v[64:79], v[244:247], v[108:111], v[64:79]
  v_mfma_f32_32x32x16_bf16 v[48:63], v[190:193], v[80:83], v[48:63]
  v_mfma_f32_32x32x16_bf16 v[48:63], v[164:167], v[84:87], v[48:63]
  v_mfma_f32_32x32x16_bf16 v[48:63], v[200:203], v[88:91], v[48:63]
  s_nop 8
  ds_write_b128 v15, v[64:67] offset:16384
  v_mfma_f32_32x32x16_bf16 v[48:63], v[208:211], v[92:95], v[48:63]
  v_mfma_f32_32x32x16_bf16 v[48:63], v[216:219], v[96:99], v[48:63]
  ds_write_b128 v15, v[68:71] offset:17408
  v_mfma_f32_32x32x16_bf16 v[48:63], v[224:227], v[100:103], v[48:63]
  ds_write_b128 v15, v[72:75] offset:18432
  v_mfma_f32_32x32x16_bf16 v[48:63], v[232:235], v[104:107], v[48:63]
  v_mfma_f32_32x32x16_bf16 v[48:63], v[240:243], v[108:111], v[48:63]
  ds_write_b128 v15, v[76:79] offset:19456
  s_nop 7
  s_cmp_lt_u32 s30, 2
  s_cbranch_scc0 Lc_111
  s_nop 0
  ds_write_b128 v15, v[48:51] offset:0
  ds_write_b128 v15, v[52:55] offset:1024
  ds_write_b128 v15, v[56:59] offset:2048
  ds_write_b128 v15, v[60:63] offset:3072
  v_add_f32 v112, v112, v16
  v_add_f32 v113, v113, v17
  v_add_f32 v114, v114, v18
  v_add_f32 v115, v115, v19
  v_add_f32 v116, v116, v20
  v_add_f32 v117, v117, v21
  v_add_f32 v118, v118, v22
  v_add_f32 v119, v119, v23
  v_add_f32 v120, v120, v24
  v_add_f32 v121, v121, v25
  v_add_f32 v122, v122, v26
  v_add_f32 v123, v123, v27
  v_add_f32 v124, v124, v28
  v_add_f32 v125, v125, v29
  v_add_f32 v126, v126, v30
  v_add_f32 v127, v127, v31
Lc_111:
  s_cmp_ge_u32 s30, 2
  s_cbranch_scc0 Lc_112
  s_nop 7
  v_add_f32 v112, v112, v48
  v_add_f32 v113, v113, v49
  v_add_f32 v114, v114, v50
  v_add_f32 v115, v115, v51
  v_add_f32 v116, v116, v52
  v_add_f32 v117, v117, v53
  v_add_f32 v118, v118, v54
  v_add_f32 v119, v119, v55
  v_add_f32 v120, v120, v56
  v_add_f32 v121, v121, v57
  v_add_f32 v122, v122, v58
  v_add_f32 v123, v123, v59
  v_add_f32 v124, v124, v60
  v_add_f32 v125, v125, v61
  v_add_f32 v126, v126, v62
  v_add_f32 v127, v127, v63
Lc_112:
  s_waitcnt lgkmcnt(0)
  s_barrier
  ds_read_b128 v[32:35], v181 offset:0
  ds_read_b128 v[48:51], v182 offset:0
  ds_read_b128 v[64:67], v183 offset:0
  ds_read_b128 v[36:39], v181 offset:1024
  ds_read_b128 v[52:55], v182 offset:1024
  ds_read_b128 v[68:71], v183 offset:1024
  ds_read_b128 v[40:43], v181 offset:2048
  ds_read_b128 v[56:59], v182 offset:2048
  ds_read_b128 v[72:75], v183 offset:2048
  ds_read_b128 v[44:47], v181 offset:3072
  ds_read_b128 v[60:63], v182 offset:3072
  ds_read_b128 v[76:79], v183 offset:3072
  s_waitcnt lgkmcnt(9)
  v_add_f32 v112, v112, v32
  v_add_f32 v113, v113, v33
  v_add_f32 v114, v114, v34
  v_add_f32 v115, v115, v35
  v_add_f32 v112, v112, v48
  v_add_f32 v113, v113, v49
  v_add_f32 v114, v114, v50
  v_add_f32 v115, v115, v51
  v_add_f32 v112, v112, v64
  v_add_f32 v113, v113, v65
  v_add_f32 v114, v114, v66
  v_add_f32 v115, v115, v67
  v_cvt_pk_bf16_f32 v96, v112, v113
  v_cvt_pk_bf16_f32 v97, v114, v115
  s_waitcnt lgkmcnt(6)
  v_add_f32 v116, v116, v36
  v_add_f32 v117, v117, v37
  v_add_f32 v118, v118, v38
  v_add_f32 v119, v119, v39
  v_add_f32 v116, v116, v52
  v_add_f32 v117, v117, v53
  v_add_f32 v118, v118, v54
  v_add_f32 v119, v119, v55
  v_add_f32 v116, v116, v68
  v_add_f32 v117, v117, v69
  v_add_f32 v118, v118, v70
  v_add_f32 v119, v119, v71
  v_cvt_pk_bf16_f32 v98, v116, v117
  v_cvt_pk_bf16_f32 v99, v118, v119
  s_cmp_eq_u32 s32, 0
  s_cbranch_scc1 Ls_113
  buffer_store_dwordx4 v[96:99], v2, s[20:23], s99 offen nt
Lb_114:
  s_waitcnt lgkmcnt(3)
  v_add_f32 v120, v120, v40
  v_add_f32 v121, v121, v41
  v_add_f32 v122, v122, v42
  v_add_f32 v123, v123, v43
  v_add_f32 v120, v120, v56
  v_add_f32 v121, v121, v57
  v_add_f32 v122, v122, v58
  v_add_f32 v123, v123, v59
  v_add_f32 v120, v120, v72
  v_add_f32 v121, v121, v73
  v_add_f32 v122, v122, v74
  v_add_f32 v123, v123, v75
  v_cvt_pk_bf16_f32 v100, v120, v121
  v_cvt_pk_bf16_f32 v101, v122, v123
  s_waitcnt lgkmcnt(0)
  v_add_f32 v124, v124, v44
  v_add_f32 v125, v125, v45
  v_add_f32 v126, v126, v46
  v_add_f32 v127, v127, v47
  v_add_f32 v124, v124, v60
  v_add_f32 v125, v125, v61
  v_add_f32 v126, v126, v62
  v_add_f32 v127, v127, v63
  v_add_f32 v124, v124, v76
  v_add_f32 v125, v125, v77
  v_add_f32 v126, v126, v78
  v_add_f32 v127, v127, v79
  v_cvt_pk_bf16_f32 v102, v124, v125
  v_cvt_pk_bf16_f32 v103, v126, v127
  s_cmp_eq_u32 s32, 0
  s_cbranch_scc1 Ls_115
  buffer_store_dwordx4 v[100:103], v2, s[20:23], s99 offen offset:1024 nt
Lb_116:
  s_mov_b32 s55, s99
  v_pk_add_f32 v[16:17], v[112:113], v[114:115]
  v_pk_mul_f32 v[18:19], v[112:113], v[112:113]
  v_pk_fma_f32 v[18:19], v[114:115], v[114:115], v[18:19]
  v_pk_add_f32 v[16:17], v[16:17], v[116:117]
  v_pk_fma_f32 v[18:19], v[116:117], v[116:117], v[18:19]
  v_pk_add_f32 v[16:17], v[16:17], v[118:119]
  v_pk_fma_f32 v[18:19], v[118:119], v[118:119], v[18:19]
  v_pk_add_f32 v[16:17], v[16:17], v[120:121]
  v_pk_fma_f32 v[18:19], v[120:121], v[120:121], v[18:19]
  v_pk_add_f32 v[16:17], v[16:17], v[122:123]
  v_pk_fma_f32 v[18:19], v[122:123], v[122:123], v[18:19]
  v_pk_add_f32 v[16:17], v[16:17], v[124:125]
  v_pk_fma_f32 v[18:19], v[124:125], v[124:125], v[18:19]
  v_pk_add_f32 v[16:17], v[16:17], v[126:127]
  v_pk_fma_f32 v[18:19], v[126:127], v[126:127], v[18:19]
  v_add_f32 v16, v16, v17
  v_add_f32 v18, v18, v19
  v_lshlrev_b32 v17, 2, v1
  s_sub_u32 s55, s55, 5242880
  s_lshr_b32 s55, s55, 3
  s_add_u32 s55, s55, s74
  v_permlane32_swap_b32 v16, v18
  v_add_f32 v16, v16, v18
  s_cmp_eq_u32 s32, 0
  s_cbranch_scc1 Ls_117
  buffer_store_dword v16, v17, s[20:23], s55 offen
Lb_118:
  v_mov_b32 v250, v12
  v_mov_b32 v251, v13
  s_cmp_eq_u32 s30, 3
  s_cbranch_scc0 Lc_119
  v_lshlrev_b32 v12, 7, v1
  v_add_u32 v12, L_b1l1-interleave_layers__spectral_fnet__glu_gated_glu__prompt_kernel, v12
  global_load_dword v255, v12, s[60:61]
  v_add_u32 v12, 8192, v12
  global_load_dword v255, v12, s[60:61]
  v_add_u32 v12, L_b2l1-L_b1l1-8192, v12
  v_min_u32 v12, L_codeend-interleave_layers__spectral_fnet__glu_gated_glu__prompt_kernel, v12
  global_load_dword v255, v12, s[60:61]
Lc_119:
  v_and_b32 v12, 15, v1
  v_lshrrev_b32 v13, 4, v1
  s_lshl_b32 s56, s30, 1
  v_lshlrev_b32 v14, 9, v13
  v_lshl_add_u32 v14, v12, 4, v14
  s_add_u32 s54, s56, 0
  s_lshl_b32 s54, s54, 11
  v_add_u32 v168, s54, v14
  v_xor_b32 v176, 0x4000, v168
  s_add_u32 s54, s56, 1
  s_lshl_b32 s54, s54, 11
  v_add_u32 v169, s54, v14
  v_xor_b32 v177, 0x4000, v169
  s_add_u32 s54, s56, 2
  s_lshl_b32 s54, s54, 11
  v_add_u32 v170, s54, v14
  v_xor_b32 v178, 0x4000, v170
  s_add_u32 s54, s56, 3
  s_lshl_b32 s54, s54, 11
  v_add_u32 v171, s54, v14
  v_xor_b32 v179, 0x4000, v171
  s_add_u32 s54, s56, 4
  s_lshl_b32 s54, s54, 11
  v_add_u32 v172, s54, v14
  v_xor_b32 v180, 0x4000, v172
  s_add_u32 s54, s56, 5
  s_lshl_b32 s54, s54, 11
  v_add_u32 v173, s54, v14
  v_xor_b32 v181, 0x4000, v173
  s_add_u32 s54, s56, 6
  s_lshl_b32 s54, s54, 11
  v_add_u32 v174, s54, v14
  v_xor_b32 v182, 0x4000, v174
  s_add_u32 s54, s56, 7
  s_lshl_b32 s54, s54, 11
  v_add_u32 v175, s54, v14
  v_xor_b32 v183, 0x4000, v175
  s_lshl_b32 s54, s28, 4
  s_add_u32 s54, s54, s29
  s_lshl_b32 s54, s54, 5
  s_add_u32 s54, s54, s30
  s_lshl_b32 s54, s54, 2
  v_mov_b32 v14, s31
  v_mov_b32 v15, 163840
  s_waitcnt vmcnt(0)
  s_mov_b64 exec, 1
  s_cmp_eq_u32 s32, 0
  s_cbranch_scc1 Ls_120
  buffer_store_dword v14, v15, s[20:23], s54 offen
Lb_121:
  s_mov_b64 exec, -1
  v_subrev_u32 v14, s31, v252
  v_subrev_u32 v15, s31, v253
  v_max_u32 v14, v14, v15
  v_cmp_lt_u32 vcc, 1, v14
  s_cbranch_vccnz Lpz_122
Lpzb_123:
  v_and_b32 v12, 15, v1
  s_lshl_b32 s54, s35, 6
  s_lshl_b32 s55, s30, 4
  s_add_u32 s54, s54, s55
  v_add_u32 v12, s54, v12
  v_mov_b32 v13, 256
  v_cmp_eq_u32 vcc, 0, v12
  s_nop 1
  v_cndmask_b32 v12, v12, v13, vcc
  v_and_b32 v13, 1, v12
  v_lshlrev_b32 v13, 31, v13
  v_or_b32 v184, 1.0, v13
  v_cvt_f32_u32 v12, v12
  v_mul_f32 v12, 0x3b000000, v12
  v_lshrrev_b32 v13, 4, v1
  s_lshl_b32 s54, s30, 3
  v_add_u32 v13, s54, v13
  v_cvt_f32_u32 v13, v13
  v_mul_f32 v13, 0x41000000, v13
  v_mul_f32 v13, v13, v12
  v_mul_f32 v14, 0x42000000, v12
  v_mul_f32 v15, 0x43000000, v12
  v_cos_f32 v136, v13
  v_sin_f32 v137, v13
  v_cos_f32 v188, v14
  v_sin_f32 v189, v14
  v_cos_f32 v186, v12
  v_sin_f32 v187, v12
  v_cos_f32 v190, v15
  v_sin_f32 v191, v15
  v_pk_mul_f32 v[196:197], v[136:137], v[188:189] op_sel:[0,0] op_sel_hi:[1,0]
  v_pk_fma_f32 v[144:145], v[136:137], v[188:189], v[196:197] op_sel:[1,1,0] op_sel_hi:[0,1,1] neg_lo:[1,0,0]
  v_add_f32 v192, v188, v188
  v_add_f32 v198, v186, v186
  v_pk_fma_f32 v[152:153], v[144:145], v[192:193], v[136:137] op_sel_hi:[1,0,1] neg_lo:[0,0,1] neg_hi:[0,0,1]
  v_pk_fma_f32 v[160:161], v[152:153], v[192:193], v[144:145] op_sel_hi:[1,0,1] neg_lo:[0,0,1] neg_hi:[0,0,1]
  v_pk_mul_f32 v[142:143], v[136:137], v[186:187] op_sel:[0,0] op_sel_hi:[1,0]
  v_pk_mul_f32 v[150:151], v[144:145], v[186:187] op_sel:[0,0] op_sel_hi:[1,0]
  v_pk_mul_f32 v[158:159], v[152:153], v[186:187] op_sel:[0,0] op_sel_hi:[1,0]
  v_pk_mul_f32 v[166:167], v[160:161], v[186:187] op_sel:[0,0] op_sel_hi:[1,0]
  v_pk_fma_f32 v[138:139], v[136:137], v[186:187], v[142:143] op_sel:[1,1,0] op_sel_hi:[0,1,1] neg_lo:[1,0,0]
  v_pk_fma_f32 v[146:147], v[144:145], v[186:187], v[150:151] op_sel:[1,1,0] op_sel_hi:[0,1,1] neg_lo:[1,0,0]
  v_pk_fma_f32 v[154:155], v[152:153], v[186:187], v[158:159] op_sel:[1,1,0] op_sel_hi:[0,1,1] neg_lo:[1,0,0]
  v_pk_fma_f32 v[162:163], v[160:161], v[186:187], v[166:167] op_sel:[1,1,0] op_sel_hi:[0,1,1] neg_lo:[1,0,0]
  v_cvt_pk_bf16_f32 v16, v136, v138
  v_cvt_pk_bf16_f32 v20, v137, v139
  v_cvt_pk_bf16_f32 v24, v144, v146
  v_cvt_pk_bf16_f32 v28, v145, v147
  v_cvt_pk_bf16_f32 v32, v152, v154
  v_cvt_pk_bf16_f32 v36, v153, v155
  v_cvt_pk_bf16_f32 v40, v160, v162
  v_cvt_pk_bf16_f32 v44, v161, v163
  v_pk_fma_f32 v[140:141], v[138:139], v[198:199], v[136:137] op_sel_hi:[1,0,1] neg_lo:[0,0,1] neg_hi:[0,0,1]
  v_pk_fma_f32 v[148:149], v[146:147], v[198:199], v[144:145] op_sel_hi:[1,0,1] neg_lo:[0,0,1] neg_hi:[0,0,1]
  v_pk_fma_f32 v[156:157], v[154:155], v[198:199], v[152:153] op_sel_hi:[1,0,1] neg_lo:[0,0,1] neg_hi:[0,0,1]
  v_pk_fma_f32 v[164:165], v[162:163], v[198:199], v[160:161] op_sel_hi:[1,0,1] neg_lo:[0,0,1] neg_hi:[0,0,1]
  v_pk_fma_f32 v[138:139], v[140:141], v[198:199], v[138:139] op_sel_hi:[1,0,1] neg_lo:[0,0,1] neg_hi:[0,0,1]
  v_pk_fma_f32 v[146:147], v[148:149], v[198:199], v[146:147] op_sel_hi:[1,0,1] neg_lo:[0,0,1] neg_hi:[0,0,1]
  v_pk_fma_f32 v[154:155], v[156:157], v[198:199], v[154:155] op_sel_hi:[1,0,1] neg_lo:[0,0,1] neg_hi:[0,0,1]
  v_pk_fma_f32 v[162:163], v[164:165], v[198:199], v[162:163] op_sel_hi:[1,0,1] neg_lo:[0,0,1] neg_hi:[0,0,1]
  v_cvt_pk_bf16_f32 v17, v140, v138
  v_cvt_pk_bf16_f32 v21, v141, v139
  v_cvt_pk_bf16_f32 v25, v148, v146
  v_cvt_pk_bf16_f32 v29, v149, v147
  v_cvt_pk_bf16_f32 v33, v156, v154
  v_cvt_pk_bf16_f32 v37, v157, v155
  v_cvt_pk_bf16_f32 v41, v164, v162
  v_cvt_pk_bf16_f32 v45, v165, v163
  v_pk_fma_f32 v[142:143], v[138:139], v[198:199], v[140:141] op_sel_hi:[1,0,1] neg_lo:[0,0,1] neg_hi:[0,0,1]
  v_pk_fma_f32 v[150:151], v[146:147], v[198:199], v[148:149] op_sel_hi:[1,0,1] neg_lo:[0,0,1] neg_hi:[0,0,1]
  v_pk_fma_f32 v[158:159], v[154:155], v[198:199], v[156:157] op_sel_hi:[1,0,1] neg_lo:[0,0,1] neg_hi:[0,0,1]
  v_pk_fma_f32 v[166:167], v[162:163], v[198:199], v[164:165] op_sel_hi:[1,0,1] neg_lo:[0,0,1] neg_hi:[0,0,1]
  v_pk_fma_f32 v[138:139], v[142:143], v[198:199], v[138:139] op_sel_hi:[1,0,1] neg_lo:[0,0,1] neg_hi:[0,0,1]
  v_pk_fma_f32 v[146:147], v[150:151], v[198:199], v[146:147] op_sel_hi:[1,0,1] neg_lo:[0,0,1] neg_hi:[0,0,1]
  v_pk_fma_f32 v[154:155], v[158:159], v[198:199], v[154:155] op_sel_hi:[1,0,1] neg_lo:[0,0,1] neg_hi:[0,0,1]
  v_pk_fma_f32 v[162:163], v[166:167], v[198:199], v[162:163] op_sel_hi:[1,0,1] neg_lo:[0,0,1] neg_hi:[0,0,1]
  v_cvt_pk_bf16_f32 v18, v142, v138
  v_cvt_pk_bf16_f32 v22, v143, v139
  v_cvt_pk_bf16_f32 v26, v150, v146
  v_cvt_pk_bf16_f32 v30, v151, v147
  v_cvt_pk_bf16_f32 v34, v158, v154
  v_cvt_pk_bf16_f32 v38, v159, v155
  v_cvt_pk_bf16_f32 v42, v166, v162
  v_cvt_pk_bf16_f32 v46, v167, v163
  v_pk_fma_f32 v[140:141], v[138:139], v[198:199], v[142:143] op_sel_hi:[1,0,1] neg_lo:[0,0,1] neg_hi:[0,0,1]
  v_pk_fma_f32 v[148:149], v[146:147], v[198:199], v[150:151] op_sel_hi:[1,0,1] neg_lo:[0,0,1] neg_hi:[0,0,1]
  v_pk_fma_f32 v[156:157], v[154:155], v[198:199], v[158:159] op_sel_hi:[1,0,1] neg_lo:[0,0,1] neg_hi:[0,0,1]
  v_pk_fma_f32 v[164:165], v[162:163], v[198:199], v[166:167] op_sel_hi:[1,0,1] neg_lo:[0,0,1] neg_hi:[0,0,1]
  v_pk_fma_f32 v[138:139], v[140:141], v[198:199], v[138:139] op_sel_hi:[1,0,1] neg_lo:[0,0,1] neg_hi:[0,0,1]
  v_pk_fma_f32 v[146:147], v[148:149], v[198:199], v[146:147] op_sel_hi:[1,0,1] neg_lo:[0,0,1] neg_hi:[0,0,1]
  v_pk_fma_f32 v[154:155], v[156:157], v[198:199], v[154:155] op_sel_hi:[1,0,1] neg_lo:[0,0,1] neg_hi:[0,0,1]
  v_pk_fma_f32 v[162:163], v[164:165], v[198:199], v[162:163] op_sel_hi:[1,0,1] neg_lo:[0,0,1] neg_hi:[0,0,1]
  v_cvt_pk_bf16_f32 v19, v140, v138
  v_cvt_pk_bf16_f32 v23, v141, v139
  v_cvt_pk_bf16_f32 v27, v148, v146
  v_cvt_pk_bf16_f32 v31, v149, v147
  v_cvt_pk_bf16_f32 v35, v156, v154
  v_cvt_pk_bf16_f32 v39, v157, v155
  v_cvt_pk_bf16_f32 v43, v164, v162
  v_cvt_pk_bf16_f32 v47, v165, v163
  v_pk_mul_f32 v[142:143], v[136:137], v[190:191] op_sel:[0,0] op_sel_hi:[1,0]
  v_pk_mul_f32 v[150:151], v[144:145], v[190:191] op_sel:[0,0] op_sel_hi:[1,0]
  v_pk_mul_f32 v[158:159], v[152:153], v[190:191] op_sel:[0,0] op_sel_hi:[1,0]
  v_pk_mul_f32 v[166:167], v[160:161], v[190:191] op_sel:[0,0] op_sel_hi:[1,0]
  v_pk_fma_f32 v[136:137], v[136:137], v[190:191], v[142:143] op_sel:[1,1,0] op_sel_hi:[0,1,1] neg_lo:[1,0,0]
  v_pk_fma_f32 v[144:145], v[144:145], v[190:191], v[150:151] op_sel:[1,1,0] op_sel_hi:[0,1,1] neg_lo:[1,0,0]
  v_pk_fma_f32 v[152:153], v[152:153], v[190:191], v[158:159] op_sel:[1,1,0] op_sel_hi:[0,1,1] neg_lo:[1,0,0]
  v_pk_fma_f32 v[160:161], v[160:161], v[190:191], v[166:167] op_sel:[1,1,0] op_sel_hi:[0,1,1] neg_lo:[1,0,0]
  v_lshrrev_b32 v248, 2, v1
  v_lshlrev_b32 v248, 7, v248
  v_and_b32 v15, 3, v1
  v_lshl_add_u32 v248, v15, 2, v248
  s_lshl_b32 s90, s28, 11
  s_add_u32 s90, s90, 163840
  buffer_load_dword v249, v248, s[20:23], s90 offen sc1
  v_lshrrev_b32 v13, 4, v1
  v_lshlrev_b32 v13, 8, v13
  v_add_u32 v13, s34, v13
  v_cvt_f32_u32 v13, v13
  v_and_b32 v12, 15, v1
  v_cvt_f32_u32 v12, v12
  v_mul_f32 v12, 0x3a000000, v12
  v_mul_f32 v14, v13, v12
  v_mul_f32 v15, 0x42800000, v12
  v_cos_f32 v108, v14
  v_sin_f32 v109, v14
  v_cos_f32 v104, v15
  v_sin_f32 v105, v15
  s_nop 0
  v_pk_mul_f32 v[112:113], v[108:109], v[104:105] op_sel:[0,0] op_sel_hi:[1,0]
  v_pk_fma_f32 v[110:111], v[108:109], v[104:105], v[112:113] op_sel:[1,1,0] op_sel_hi:[0,1,1] neg_lo:[1,0,0]
  v_cvt_pk_bf16_f32 v80, v108, v110
  v_cvt_pk_bf16_f32 v84, v109, v111
  v_pk_mul_f32 v[112:113], v[110:111], v[104:105] op_sel:[0,0] op_sel_hi:[1,0]
  v_pk_fma_f32 v[108:109], v[110:111], v[104:105], v[112:113] op_sel:[1,1,0] op_sel_hi:[0,1,1] neg_lo:[1,0,0]
  v_pk_mul_f32 v[112:113], v[108:109], v[104:105] op_sel:[0,0] op_sel_hi:[1,0]
  v_pk_fma_f32 v[110:111], v[108:109], v[104:105], v[112:113] op_sel:[1,1,0] op_sel_hi:[0,1,1] neg_lo:[1,0,0]
  v_cvt_pk_bf16_f32 v81, v108, v110
  v_cvt_pk_bf16_f32 v85, v109, v111
  v_and_b32 v106, 1, v1
  v_mul_u32_u24 v106, 0x8000, v106
  v_lshl_or_b32 v106, v106, 16, v106
  v_xor_b32 v82, v106, v80
  v_xor_b32 v86, v106, v84
  v_xor_b32 v83, v106, v81
  v_xor_b32 v87, v106, v85
  v_xor_b32 v88, 0x80008000, v84
  v_xor_b32 v89, 0x80008000, v85
  v_xor_b32 v90, 0x80008000, v86
  v_xor_b32 v91, 0x80008000, v87
  v_and_b32 v12, 15, v1
  v_add_u32 v12, 16, v12
  v_cvt_f32_u32 v12, v12
  v_mul_f32 v12, 0x3a000000, v12
  v_mul_f32 v14, v13, v12
  v_mul_f32 v15, 0x42800000, v12
  v_cos_f32 v108, v14
  v_sin_f32 v109, v14
  v_cos_f32 v104, v15
  v_sin_f32 v105, v15
  s_nop 0
  v_pk_mul_f32 v[112:113], v[108:109], v[104:105] op_sel:[0,0] op_sel_hi:[1,0]
  v_pk_fma_f32 v[110:111], v[108:109], v[104:105], v[112:113] op_sel:[1,1,0] op_sel_hi:[0,1,1] neg_lo:[1,0,0]
  v_cvt_pk_bf16_f32 v92, v108, v110
  v_cvt_pk_bf16_f32 v96, v109, v111
  v_pk_mul_f32 v[112:113], v[110:111], v[104:105] op_sel:[0,0] op_sel_hi:[1,0]
  v_pk_fma_f32 v[108:109], v[110:111], v[104:105], v[112:113] op_sel:[1,1,0] op_sel_hi:[0,1,1] neg_lo:[1,0,0]
  v_pk_mul_f32 v[112:113], v[108:109], v[104:105] op_sel:[0,0] op_sel_hi:[1,0]
  v_pk_fma_f32 v[110:111], v[108:109], v[104:105], v[112:113] op_sel:[1,1,0] op_sel_hi:[0,1,1] neg_lo:[1,0,0]
  v_cvt_pk_bf16_f32 v93, v108, v110
  v_cvt_pk_bf16_f32 v97, v109, v111
  v_xor_b32 v94, v106, v92
  v_xor_b32 v98, v106, v96
  v_xor_b32 v95, v106, v93
  v_xor_b32 v99, v106, v97
  v_xor_b32 v100, 0x80008000, v96
  v_xor_b32 v101, 0x80008000, v97
  v_xor_b32 v102, 0x80008000, v98
  v_xor_b32 v103, 0x80008000, v99
  s_waitcnt vmcnt(0)
  v_subrev_u32 v14, s31, v249
  v_cmp_lt_u32 vcc, 1, v14
  s_cbranch_vccnz Lpf_126
Lpb_127:
  s_lshl_b32 s54, s34, 15
  s_lshl_b32 s55, s30, 13
  s_add_u32 s54, s54, s55
  s_add_u32 s54, s54, 5242880
  s_mov_b32 m0, s55
  s_lshl_b32 s56, s34, 12
  s_add_u32 s56, s56, s74
  buffer_load_dwordx4 v[208:211], v2, s[20:23], s56 offen offset:0 sc1
  buffer_load_dwordx4 v[212:215], v2, s[20:23], s56 offen offset:1024 sc1
  buffer_load_dwordx4 v[216:219], v2, s[20:23], s56 offen offset:2048 sc1
  buffer_load_dwordx4 v[220:223], v2, s[20:23], s56 offen offset:3072 sc1
  buffer_load_dwordx4 v2, s[20:23], s54 offen offset:0 sc1 lds
  buffer_load_dwordx4 v2, s[20:23], s54 offen offset:1024 sc1 lds
  buffer_load_dwordx4 v2, s[20:23], s54 offen offset:2048 sc1 lds
  buffer_load_dwordx4 v2, s[20:23], s54 offen offset:3072 sc1 lds
  s_add_u32 m0, m0, 4096
  s_add_u32 s54, s54, 4096
  buffer_load_dwordx4 v2, s[20:23], s54 offen offset:0 sc1 lds
  buffer_load_dwordx4 v2, s[20:23], s54 offen offset:1024 sc1 lds
  buffer_load_dwordx4 v2, s[20:23], s54 offen offset:2048 sc1 lds
  buffer_load_dwordx4 v2, s[20:23], s54 offen offset:3072 sc1 lds
  s_lshl_b32 s54, s40, 15
  s_lshl_b32 s55, s41, 11
  s_add_u32 s54, s54, s55
  s_add_u32 s54, s54, 5242880
  buffer_load_dwordx4 v[200:203], v2, s[20:23], s54 offen sc1
  buffer_load_dwordx4 v[204:207], v2, s[20:23], s54 offen offset:1024 sc1
  v_pk_mul_f32 v[142:143], v[136:137], v[186:187] op_sel:[0,0] op_sel_hi:[1,0]
  v_pk_mul_f32 v[150:151], v[144:145], v[186:187] op_sel:[0,0] op_sel_hi:[1,0]
  v_pk_mul_f32 v[158:159], v[152:153], v[186:187] op_sel:[0,0] op_sel_hi:[1,0]
  v_pk_mul_f32 v[166:167], v[160:161], v[186:187] op_sel:[0,0] op_sel_hi:[1,0]
  v_pk_fma_f32 v[138:139], v[136:137], v[186:187], v[142:143] op_sel:[1,1,0] op_sel_hi:[0,1,1] neg_lo:[1,0,0]
  v_pk_fma_f32 v[146:147], v[144:145], v[186:187], v[150:151] op_sel:[1,1,0] op_sel_hi:[0,1,1] neg_lo:[1,0,0]
  v_pk_fma_f32 v[154:155], v[152:153], v[186:187], v[158:159] op_sel:[1,1,0] op_sel_hi:[0,1,1] neg_lo:[1,0,0]
  v_pk_fma_f32 v[162:163], v[160:161], v[186:187], v[166:167] op_sel:[1,1,0] op_sel_hi:[0,1,1] neg_lo:[1,0,0]
  v_cvt_pk_bf16_f32 v48, v136, v138
  v_cvt_pk_bf16_f32 v52, v137, v139
  v_cvt_pk_bf16_f32 v56, v144, v146
  v_cvt_pk_bf16_f32 v60, v145, v147
  v_cvt_pk_bf16_f32 v64, v152, v154
  v_cvt_pk_bf16_f32 v68, v153, v155
  v_cvt_pk_bf16_f32 v72, v160, v162
  v_cvt_pk_bf16_f32 v76, v161, v163
  v_pk_fma_f32 v[140:141], v[138:139], v[198:199], v[136:137] op_sel_hi:[1,0,1] neg_lo:[0,0,1] neg_hi:[0,0,1]
  v_pk_fma_f32 v[148:149], v[146:147], v[198:199], v[144:145] op_sel_hi:[1,0,1] neg_lo:[0,0,1] neg_hi:[0,0,1]
  v_pk_fma_f32 v[156:157], v[154:155], v[198:199], v[152:153] op_sel_hi:[1,0,1] neg_lo:[0,0,1] neg_hi:[0,0,1]
  v_pk_fma_f32 v[164:165], v[162:163], v[198:199], v[160:161] op_sel_hi:[1,0,1] neg_lo:[0,0,1] neg_hi:[0,0,1]
  v_pk_fma_f32 v[138:139], v[140:141], v[198:199], v[138:139] op_sel_hi:[1,0,1] neg_lo:[0,0,1] neg_hi:[0,0,1]
  v_pk_fma_f32 v[146:147], v[148:149], v[198:199], v[146:147] op_sel_hi:[1,0,1] neg_lo:[0,0,1] neg_hi:[0,0,1]
  v_pk_fma_f32 v[154:155], v[156:157], v[198:199], v[154:155] op_sel_hi:[1,0,1] neg_lo:[0,0,1] neg_hi:[0,0,1]
  v_pk_fma_f32 v[162:163], v[164:165], v[198:199], v[162:163] op_sel_hi:[1,0,1] neg_lo:[0,0,1] neg_hi:[0,0,1]
  v_cvt_pk_bf16_f32 v49, v140, v138
  v_cvt_pk_bf16_f32 v53, v141, v139
  v_cvt_pk_bf16_f32 v57, v148, v146
  v_cvt_pk_bf16_f32 v61, v149, v147
  v_cvt_pk_bf16_f32 v65, v156, v154
  v_cvt_pk_bf16_f32 v69, v157, v155
  v_cvt_pk_bf16_f32 v73, v164, v162
  v_cvt_pk_bf16_f32 v77, v165, v163
  v_pk_fma_f32 v[142:143], v[138:139], v[198:199], v[140:141] op_sel_hi:[1,0,1] neg_lo:[0,0,1] neg_hi:[0,0,1]
  v_pk_fma_f32 v[150:151], v[146:147], v[198:199], v[148:149] op_sel_hi:[1,0,1] neg_lo:[0,0,1] neg_hi:[0,0,1]
  v_pk_fma_f32 v[158:159], v[154:155], v[198:199], v[156:157] op_sel_hi:[1,0,1] neg_lo:[0,0,1] neg_hi:[0,0,1]
  v_pk_fma_f32 v[166:167], v[162:163], v[198:199], v[164:165] op_sel_hi:[1,0,1] neg_lo:[0,0,1] neg_hi:[0,0,1]
  v_pk_fma_f32 v[138:139], v[142:143], v[198:199], v[138:139] op_sel_hi:[1,0,1] neg_lo:[0,0,1] neg_hi:[0,0,1]
  v_pk_fma_f32 v[146:147], v[150:151], v[198:199], v[146:147] op_sel_hi:[1,0,1] neg_lo:[0,0,1] neg_hi:[0,0,1]
  v_pk_fma_f32 v[154:155], v[158:159], v[198:199], v[154:155] op_sel_hi:[1,0,1] neg_lo:[0,0,1] neg_hi:[0,0,1]
  v_pk_fma_f32 v[162:163], v[166:167], v[198:199], v[162:163] op_sel_hi:[1,0,1] neg_lo:[0,0,1] neg_hi:[0,0,1]
  v_cvt_pk_bf16_f32 v50, v142, v138
  v_cvt_pk_bf16_f32 v54, v143, v139
  v_cvt_pk_bf16_f32 v58, v150, v146
  v_cvt_pk_bf16_f32 v62, v151, v147
  v_cvt_pk_bf16_f32 v66, v158, v154
  v_cvt_pk_bf16_f32 v70, v159, v155
  v_cvt_pk_bf16_f32 v74, v166, v162
  v_cvt_pk_bf16_f32 v78, v167, v163
  v_pk_fma_f32 v[140:141], v[138:139], v[198:199], v[142:143] op_sel_hi:[1,0,1] neg_lo:[0,0,1] neg_hi:[0,0,1]
  v_pk_fma_f32 v[148:149], v[146:147], v[198:199], v[150:151] op_sel_hi:[1,0,1] neg_lo:[0,0,1] neg_hi:[0,0,1]
  v_pk_fma_f32 v[156:157], v[154:155], v[198:199], v[158:159] op_sel_hi:[1,0,1] neg_lo:[0,0,1] neg_hi:[0,0,1]
  v_pk_fma_f32 v[164:165], v[162:163], v[198:199], v[166:167] op_sel_hi:[1,0,1] neg_lo:[0,0,1] neg_hi:[0,0,1]
  v_pk_fma_f32 v[138:139], v[140:141], v[198:199], v[138:139] op_sel_hi:[1,0,1] neg_lo:[0,0,1] neg_hi:[0,0,1]
  v_pk_fma_f32 v[146:147], v[148:149], v[198:199], v[146:147] op_sel_hi:[1,0,1] neg_lo:[0,0,1] neg_hi:[0,0,1]
  v_pk_fma_f32 v[154:155], v[156:157], v[198:199], v[154:155] op_sel_hi:[1,0,1] neg_lo:[0,0,1] neg_hi:[0,0,1]
  v_pk_fma_f32 v[162:163], v[164:165], v[198:199], v[162:163] op_sel_hi:[1,0,1] neg_lo:[0,0,1] neg_hi:[0,0,1]
  v_cvt_pk_bf16_f32 v51, v140, v138
  v_cvt_pk_bf16_f32 v55, v141, v139
  v_cvt_pk_bf16_f32 v59, v148, v146
  v_cvt_pk_bf16_f32 v63, v149, v147
  v_cvt_pk_bf16_f32 v67, v156, v154
  v_cvt_pk_bf16_f32 v71, v157, v155
  v_cvt_pk_bf16_f32 v75, v164, v162
  v_cvt_pk_bf16_f32 v79, v165, v163
  s_waitcnt vmcnt(10)
  v_add_f32 v208, v208, v216
  v_add_f32 v209, v209, v217
  v_add_f32 v210, v210, v218
  v_add_f32 v211, v211, v219
  v_add_f32 v212, v212, v220
  v_add_f32 v213, v213, v221
  v_add_f32 v214, v214, v222
  v_add_f32 v215, v215, v223
  v_add_f32 v208, v208, v212
  v_add_f32 v209, v209, v213
  v_add_f32 v210, v210, v214
  v_add_f32 v211, v211, v215
  v_permlane32_swap_b32 v208, v209
  s_nop 0
  v_permlane32_swap_b32 v210, v211
  v_add_f32 v208, v208, v209
  v_add_f32 v210, v210, v211
  s_nop 1
  v_permlane16_swap_b32 v208, v210
  v_add_f32 v208, v208, v210
  s_nop 1
  v_mov_b32_dpp v209, v208 row_ror:8 row_mask:0xf bank_mask:0xf
  v_mul_f32 v208, 0x3b000000, v208
  v_mul_f32 v209, 0x3b000000, v209
  v_fma_f32 v209, -v208, v208, v209
  v_max_f32 v209, 0, v209
  v_add_f32 v209, 0x3727c5ac, v209
  v_rsq_f32 v209, v209
  v_and_b32 v12, 15, v1
  v_lshlrev_b32 v12, 4, v12
  v_lshrrev_b32 v13, 5, v1
  v_lshl_add_u32 v12, v13, 2, v12
  v_bfe_u32 v13, v1, 4, 1
  v_lshl_add_u32 v12, v13, 3, v12
  s_lshl_b32 s54, s30, 8
  s_add_u32 s54, s54, 155648
  v_add_u32 v12, s54, v12
  ds_write_b32 v12, v209
  v_lshrrev_b32 v12, 4, v1
  v_lshlrev_b32 v12, 4, v12
  v_add_u32 v12, s54, v12
  s_waitcnt lgkmcnt(0)
  ds_read_b128 v[188:191], v12
  ds_read_b128 v[192:195], v12 offset:64
  s_mov_b32 s33, 1
  s_mov_b32 s43, 3145728
  s_mov_b32 s44, 5242880
  s_mov_b32 s45, 11534336
  s_add_u32 s31, s31, 1
  s_waitcnt vmcnt(2)
  s_branch L_layer
L_b2l1:
  v_lshrrev_b32 v12, 2, v1
  v_min_u32 v12, 13, v12
  v_lshlrev_b32 v12, 7, v12
  v_and_b32 v15, 3, v1
  v_lshl_add_u32 v12, v15, 2, v12
  s_lshl_b32 s90, s28, 11
  s_add_u32 s90, s90, 131072
  s_waitcnt vmcnt(10)
  v_mfma_f32_32x32x16_bf16 v[16:31], v[200:203], v[144:147], 0
  s_add_u32 s57, s91, 16384
  buffer_load_dwordx4 v[96:99], v2, s[20:23], s57 offen offset:1024 sc1
  s_add_u32 s57, s91, 16384
  buffer_load_dwordx4 v[100:103], v2, s[20:23], s57 offen offset:2048 sc1
  v_mfma_f32_32x32x16_bf16 v[32:47], v[204:207], v[144:147], 0
  s_waitcnt vmcnt(11)
  v_mfma_f32_32x32x16_bf16 v[16:31], v[208:211], v[148:151], v[16:31]
  s_add_u32 s57, s91, 16384
  buffer_load_dwordx4 v[104:107], v2, s[20:23], s57 offen offset:3072 sc1
  s_add_u32 s57, s91, 20480
  buffer_load_dwordx4 v[108:111], v2, s[20:23], s57 offen offset:0 sc1
  v_mfma_f32_32x32x16_bf16 v[32:47], v[212:215], v[148:151], v[32:47]
  s_waitcnt vmcnt(12)
  v_mfma_f32_32x32x16_bf16 v[16:31], v[216:219], v[152:155], v[16:31]
  s_add_u32 s57, s91, 20480
  buffer_load_dwordx4 v[144:147], v2, s[20:23], s57 offen offset:1024 sc1
  s_add_u32 s57, s91, 20480
  buffer_load_dwordx4 v[148:151], v2, s[20:23], s57 offen offset:2048 sc1
  v_mfma_f32_32x32x16_bf16 v[32:47], v[220:223], v[152:155], v[32:47]
  s_waitcnt vmcnt(13)
  v_mfma_f32_32x32x16_bf16 v[16:31], v[224:227], v[156:159], v[16:31]
  s_add_u32 s57, s91, 24576
  buffer_load_dwordx4 v[152:155], v2, s[20:23], s57 offen offset:1024 sc1
  v_mfma_f32_32x32x16_bf16 v[32:47], v[228:231], v[156:159], v[32:47]
  s_waitcnt vmcnt(7)
  v_mov_b32 v14, s31
  v_mov_b32 v15, 0
  s_mov_b64 exec, 1
  s_cmp_eq_u32 s89, 0
  s_cbranch_scc1 Ls_130
  buffer_store_dword v14, v15, s[20:23], s80 offen
Lb_131:
  s_mov_b64 exec, -1
  v_mfma_f32_32x32x16_bf16 v[16:31], v[232:235], v[160:163], v[16:31]
  buffer_load_dwordx4 v[156:159], v2, s[20:23], s93 offen offset:0 sc1
  v_mfma_f32_32x32x16_bf16 v[32:47], v[236:239], v[160:163], v[32:47]
  v_mfma_f32_32x32x16_bf16 v[16:31], v[240:243], v[248:251], v[16:31]
  buffer_load_dwordx4 v[160:163], v2, s[20:23], s93 offen offset:1024 sc1
  v_mfma_f32_32x32x16_bf16 v[32:47], v[244:247], v[248:251], v[32:47]
  v_mfma_f32_32x32x16_bf16 v[16:31], a[0:3], v[80:83], v[16:31]
  buffer_load_dwordx4 v[248:251], v2, s[20:23], s93 offen offset:2048 sc1
  v_mfma_f32_32x32x16_bf16 v[32:47], a[4:7], v[80:83], v[32:47]
  v_mfma_f32_32x32x16_bf16 v[16:31], a[8:11], v[84:87], v[16:31]
  ds_read_b64_tr_b16 v[112:113], v181 offset:0
  ds_read_b64_tr_b16 v[114:115], v181 offset:512
  buffer_load_dwordx4 v[80:83], v2, s[20:23], s93 offen offset:3072 sc1
  v_mfma_f32_32x32x16_bf16 v[32:47], a[12:15], v[84:87], v[32:47]
  ds_read_b64_tr_b16 v[116:117], v186 offset:0
  ds_read_b64_tr_b16 v[118:119], v186 offset:512
  v_mfma_f32_32x32x16_bf16 v[16:31], a[16:19], v[88:91], v[16:31]
  ds_read_b64_tr_b16 v[120:121], v181 offset:2048
  ds_read_b64_tr_b16 v[122:123], v181 offset:2560
  s_add_u32 s57, s93, 4096
  buffer_load_dwordx4 v[84:87], v2, s[20:23], s57 offen offset:0 sc1
  v_mfma_f32_32x32x16_bf16 v[32:47], a[20:23], v[88:91], v[32:47]
  ds_read_b64_tr_b16 v[124:125], v186 offset:2048
  ds_read_b64_tr_b16 v[126:127], v186 offset:2560
  v_mfma_f32_32x32x16_bf16 v[16:31], a[24:27], v[92:95], v[16:31]
  ds_read_b64_tr_b16 v[128:129], v181 offset:4096
  ds_read_b64_tr_b16 v[130:131], v181 offset:4608
  s_add_u32 s57, s93, 4096
  buffer_load_dwordx4 v[88:91], v2, s[20:23], s57 offen offset:1024 sc1
  v_mfma_f32_32x32x16_bf16 v[32:47], a[28:31], v[92:95], v[32:47]
  ds_read_b64_tr_b16 v[132:133], v186 offset:4096
  ds_read_b64_tr_b16 v[134:135], v186 offset:4608
  s_waitcnt lgkmcnt(8)
  s_waitcnt vmcnt(13)
  v_mfma_f32_32x32x16_bf16 v[16:31], v[112:115], v[96:99], v[16:31]
  ds_read_b64_tr_b16 v[136:137], v181 offset:6144
  ds_read_b64_tr_b16 v[138:139], v181 offset:6656
  buffer_load_dword v13, v12, s[20:23], s90 offen sc1
  s_add_u32 s57, s91, 20480
  buffer_load_dwordx4 v[92:95], v2, s[20:23], s57 offen offset:3072 sc1
  v_mfma_f32_32x32x16_bf16 v[32:47], v[116:119], v[96:99], v[32:47]
  ds_read_b64_tr_b16 v[140:141], v186 offset:6144
  ds_read_b64_tr_b16 v[142:143], v186 offset:6656
  s_waitcnt lgkmcnt(8)
  s_waitcnt vmcnt(14)
  v_mfma_f32_32x32x16_bf16 v[16:31], v[120:123], v[100:103], v[16:31]
  ds_read_b64_tr_b16 v[112:113], v182 offset:0
  ds_read_b64_tr_b16 v[114:115], v182 offset:512
  s_add_u32 s57, s91, 24576
  buffer_load_dwordx4 v[96:99], v2, s[20:23], s57 offen offset:0 sc1
  v_mfma_f32_32x32x16_bf16 v[32:47], v[124:127], v[100:103], v[32:47]
  ds_read_b64_tr_b16 v[116:117], v187 offset:0
  ds_read_b64_tr_b16 v[118:119], v187 offset:512
  s_waitcnt lgkmcnt(8)
  s_waitcnt vmcnt(14)
  v_mfma_f32_32x32x16_bf16 v[16:31], v[128:131], v[104:107], v[16:31]
  ds_read_b64_tr_b16 v[120:121], v182 offset:2048
  ds_read_b64_tr_b16 v[122:123], v182 offset:2560
  s_add_u32 s57, s91, 24576
  buffer_load_dwordx4 v[100:103], v2, s[20:23], s57 offen offset:2048 sc1
  v_mfma_f32_32x32x16_bf16 v[32:47], v[132:135], v[104:107], v[32:47]
  ds_read_b64_tr_b16 v[124:125], v187 offset:2048
  ds_read_b64_tr_b16 v[126:127], v187 offset:2560
  s_waitcnt lgkmcnt(8)
  s_waitcnt vmcnt(14)
  v_mfma_f32_32x32x16_bf16 v[16:31], v[136:139], v[108:111], v[16:31]
  ds_read_b64_tr_b16 v[128:129], v183 offset:0
  ds_read_b64_tr_b16 v[130:131], v183 offset:512
  s_add_u32 s57, s91, 24576
  buffer_load_dwordx4 v[104:107], v2, s[20:23], s57 offen offset:3072 sc1
  v_mfma_f32_32x32x16_bf16 v[32:47], v[140:143], v[108:111], v[32:47]
  ds_read_b64_tr_b16 v[132:133], v188 offset:0
  ds_read_b64_tr_b16 v[134:135], v188 offset:512
  s_waitcnt lgkmcnt(8)
  s_waitcnt vmcnt(14)
  v_mfma_f32_32x32x16_bf16 v[16:31], v[112:115], v[144:147], v[16:31]
  ds_read_b64_tr_b16 v[136:137], v180 offset:0
  ds_read_b64_tr_b16 v[138:139], v180 offset:512
  s_waitcnt vmcnt(4)
  v_subrev_u32 v14, s31, v13
  v_cmp_lt_u32 vcc, 1, v14
  s_cbranch_vccnz Lpf_132
Lpb_133:
  s_add_u32 s57, s91, 16384
  buffer_load_dwordx4 v[108:111], v2, s[20:23], s57 offen offset:0 sc1
  v_mfma_f32_32x32x16_bf16 v[32:47], v[116:119], v[144:147], v[32:47]
  ds_read_b64_tr_b16 v[140:141], v185 offset:0
  ds_read_b64_tr_b16 v[142:143], v185 offset:512
  s_waitcnt lgkmcnt(8)
  v_mfma_f32_32x32x16_bf16 v[16:31], v[120:123], v[148:151], v[16:31]
  ds_read_b64_tr_b16 v[112:113], v180 offset:2048
  ds_read_b64_tr_b16 v[114:115], v180 offset:2560
  s_add_u32 s57, s94, 16384
  buffer_load_dwordx4 v[144:147], v2, s[20:23], s57 offen offset:1024 sc1
  v_mfma_f32_32x32x16_bf16 v[32:47], v[124:127], v[148:151], v[32:47]
  ds_read_b64_tr_b16 v[116:117], v185 offset:2048
  ds_read_b64_tr_b16 v[118:119], v185 offset:2560
  s_waitcnt lgkmcnt(8)
  v_mfma_f32_32x32x16_bf16 v[16:31], v[128:131], v[152:155], v[16:31]
  ds_read_b64_tr_b16 v[120:121], v180 offset:4096
  ds_read_b64_tr_b16 v[122:123], v180 offset:4608
  s_add_u32 s57, s94, 16384
  buffer_load_dwordx4 v[148:151], v2, s[20:23], s57 offen offset:2048 sc1
  v_mfma_f32_32x32x16_bf16 v[32:47], v[132:135], v[152:155], v[32:47]
  ds_read_b64_tr_b16 v[124:125], v185 offset:4096
  ds_read_b64_tr_b16 v[126:127], v185 offset:4608
  s_waitcnt lgkmcnt(8)
  v_mfma_f32_32x32x16_bf16 v[16:31], v[136:139], v[156:159], v[16:31]
  ds_read_b64_tr_b16 v[128:129], v180 offset:6144
  ds_read_b64_tr_b16 v[130:131], v180 offset:6656
  s_add_u32 s57, s94, 16384
  buffer_load_dwordx4 v[152:155], v2, s[20:23], s57 offen offset:3072 sc1
  v_mfma_f32_32x32x16_bf16 v[32:47], v[140:143], v[156:159], v[32:47]
  ds_read_b64_tr_b16 v[132:133], v185 offset:6144
  ds_read_b64_tr_b16 v[134:135], v185 offset:6656
  s_waitcnt lgkmcnt(8)
  v_mfma_f32_32x32x16_bf16 v[16:31], v[112:115], v[160:163], v[16:31]
  ds_read_b64_tr_b16 v[136:137], v180 offset:32768
  ds_read_b64_tr_b16 v[138:139], v180 offset:33280
  s_add_u32 s57, s94, 20480
  buffer_load_dwordx4 v[156:159], v2, s[20:23], s57 offen offset:0 sc1
  v_mfma_f32_32x32x16_bf16 v[32:47], v[116:119], v[160:163], v[32:47]
  ds_read_b64_tr_b16 v[140:141], v185 offset:32768
  ds_read_b64_tr_b16 v[142:143], v185 offset:33280
  s_waitcnt lgkmcnt(8)
  v_mfma_f32_32x32x16_bf16 v[16:31], v[120:123], v[248:251], v[16:31]
  ds_read_b64_tr_b16 v[112:113], v180 offset:34816
  ds_read_b64_tr_b16 v[114:115], v180 offset:35328
  s_add_u32 s57, s94, 20480
  buffer_load_dwordx4 v[160:163], v2, s[20:23], s57 offen offset:1024 sc1
  v_mfma_f32_32x32x16_bf16 v[32:47], v[124:127], v[248:251], v[32:47]
  ds_read_b64_tr_b16 v[116:117], v185 offset:34816
  ds_read_b64_tr_b16 v[118:119], v185 offset:35328
  s_waitcnt lgkmcnt(8)
  v_mfma_f32_32x32x16_bf16 v[16:31], v[128:131], v[80:83], v[16:31]
  ds_read_b64_tr_b16 v[120:121], v180 offset:36864
  ds_read_b64_tr_b16 v[122:123], v180 offset:37376
  s_add_u32 s57, s94, 20480
  buffer_load_dwordx4 v[248:251], v2, s[20:23], s57 offen offset:2048 sc1
  v_mfma_f32_32x32x16_bf16 v[32:47], v[132:135], v[80:83], v[32:47]
  ds_read_b64_tr_b16 v[124:125], v185 offset:36864
  ds_read_b64_tr_b16 v[126:127], v185 offset:37376
  s_waitcnt lgkmcnt(8)
  v_mfma_f32_32x32x16_bf16 v[16:31], v[136:139], v[84:87], v[16:31]
  ds_read_b64_tr_b16 v[128:129], v180 offset:38912
  ds_read_b64_tr_b16 v[130:131], v180 offset:39424
  s_add_u32 s57, s94, 24576
  buffer_load_dwordx4 v[80:83], v2, s[20:23], s57 offen offset:1024 sc1
  v_mfma_f32_32x32x16_bf16 v[32:47], v[140:143], v[84:87], v[32:47]
  ds_read_b64_tr_b16 v[132:133], v185 offset:38912
  ds_read_b64_tr_b16 v[134:135], v185 offset:39424
  s_waitcnt lgkmcnt(8)
  v_mfma_f32_32x32x16_bf16 v[16:31], v[112:115], v[88:91], v[16:31]
  ds_read_b64_tr_b16 v[136:137], v184 offset:0
  ds_read_b64_tr_b16 v[138:139], v184 offset:512
  buffer_load_dwordx4 v[84:87], v2, s[20:23], s77 offen offset:0 sc1
  v_mfma_f32_32x32x16_bf16 v[32:47], v[116:119], v[88:91], v[32:47]
  ds_read_b64_tr_b16 v[140:141], v189 offset:0
  ds_read_b64_tr_b16 v[142:143], v189 offset:512
  s_waitcnt lgkmcnt(8)
  s_waitcnt vmcnt(12)
  v_mfma_f32_32x32x16_bf16 v[16:31], v[120:123], v[92:95], v[16:31]
  ds_read_b64_tr_b16 v[112:113], v184 offset:2048
  ds_read_b64_tr_b16 v[114:115], v184 offset:2560
  buffer_load_dwordx4 v[88:91], v2, s[20:23], s77 offen offset:1024 sc1
  v_mfma_f32_32x32x16_bf16 v[32:47], v[124:127], v[92:95], v[32:47]
  ds_read_b64_tr_b16 v[116:117], v189 offset:2048
  ds_read_b64_tr_b16 v[118:119], v189 offset:2560
  s_waitcnt lgkmcnt(8)
  s_waitcnt vmcnt(12)
  v_mfma_f32_32x32x16_bf16 v[16:31], v[128:131], v[96:99], v[16:31]
  ds_read_b64_tr_b16 v[120:121], v184 offset:4096
  ds_read_b64_tr_b16 v[122:123], v184 offset:4608
  buffer_load_dwordx4 v[92:95], v2, s[20:23], s77 offen offset:2048 sc1
  v_mfma_f32_32x32x16_bf16 v[32:47], v[132:135], v[96:99], v[32:47]
  ds_read_b64_tr_b16 v[124:125], v189 offset:4096
  ds_read_b64_tr_b16 v[126:127], v189 offset:4608
  s_waitcnt lgkmcnt(8)
  s_waitcnt vmcnt(12)
  v_mfma_f32_32x32x16_bf16 v[16:31], v[136:139], v[100:103], v[16:31]
  ds_read_b64_tr_b16 v[128:129], v181 offset:0
  ds_read_b64_tr_b16 v[130:131], v181 offset:512
  buffer_load_dwordx4 v[96:99], v2, s[20:23], s77 offen offset:3072 sc1
  v_mfma_f32_32x32x16_bf16 v[32:47], v[140:143], v[100:103], v[32:47]
  ds_read_b64_tr_b16 v[132:133], v186 offset:0
  ds_read_b64_tr_b16 v[134:135], v186 offset:512
  s_waitcnt lgkmcnt(8)
  s_waitcnt vmcnt(12)
  v_mfma_f32_32x32x16_bf16 v[16:31], v[112:115], v[104:107], v[16:31]
  ds_read_b64_tr_b16 v[136:137], v181 offset:2048
  ds_read_b64_tr_b16 v[138:139], v181 offset:2560
  s_add_u32 s57, s77, 4096
  buffer_load_dwordx4 v[100:103], v2, s[20:23], s57 offen offset:0 sc1
  v_mfma_f32_32x32x16_bf16 v[32:47], v[116:119], v[104:107], v[32:47]
  ds_read_b64_tr_b16 v[140:141], v186 offset:2048
  ds_read_b64_tr_b16 v[142:143], v186 offset:2560
  s_waitcnt lgkmcnt(8)
  s_waitcnt vmcnt(12)
  v_mfma_f32_32x32x16_bf16 v[16:31], v[120:123], v[108:111], v[16:31]
  ds_read_b64_tr_b16 v[112:113], v181 offset:4096
  ds_read_b64_tr_b16 v[114:115], v181 offset:4608
  s_add_u32 s57, s77, 4096
  buffer_load_dwordx4 v[104:107], v2, s[20:23], s57 offen offset:1024 sc1
  v_mfma_f32_32x32x16_bf16 v[32:47], v[124:127], v[108:111], v[32:47]
  ds_read_b64_tr_b16 v[116:117], v186 offset:4096
  ds_read_b64_tr_b16 v[118:119], v186 offset:4608
  s_waitcnt lgkmcnt(8)
  s_waitcnt vmcnt(12)
  v_mfma_f32_32x32x16_bf16 v[48:63], v[128:131], v[144:147], 0
  ds_read_b64_tr_b16 v[120:121], v181 offset:6144
  ds_read_b64_tr_b16 v[122:123], v181 offset:6656
  s_add_u32 s57, s94, 20480
  buffer_load_dwordx4 v[108:111], v2, s[20:23], s57 offen offset:3072 sc1
  v_mfma_f32_32x32x16_bf16 v[64:79], v[132:135], v[144:147], 0
  ds_read_b64_tr_b16 v[124:125], v186 offset:6144
  ds_read_b64_tr_b16 v[126:127], v186 offset:6656
  s_waitcnt lgkmcnt(8)
  s_waitcnt vmcnt(12)
  v_mfma_f32_32x32x16_bf16 v[48:63], v[136:139], v[148:151], v[48:63]
  ds_read_b64_tr_b16 v[128:129], v182 offset:0
  ds_read_b64_tr_b16 v[130:131], v182 offset:512
  s_add_u32 s57, s94, 24576
  buffer_load_dwordx4 v[144:147], v2, s[20:23], s57 offen offset:0 sc1
  v_mfma_f32_32x32x16_bf16 v[64:79], v[140:143], v[148:151], v[64:79]
  ds_read_b64_tr_b16 v[132:133], v187 offset:0
  ds_read_b64_tr_b16 v[134:135], v187 offset:512
  s_waitcnt lgkmcnt(8)
  s_waitcnt vmcnt(12)
  v_mfma_f32_32x32x16_bf16 v[48:63], v[112:115], v[152:155], v[48:63]
  ds_read_b64_tr_b16 v[136:137], v182 offset:2048
  ds_read_b64_tr_b16 v[138:139], v182 offset:2560
  s_add_u32 s57, s94, 24576
  buffer_load_dwordx4 v[148:151], v2, s[20:23], s57 offen offset:2048 sc1
  v_mfma_f32_32x32x16_bf16 v[64:79], v[116:119], v[152:155], v[64:79]
  ds_read_b64_tr_b16 v[140:141], v187 offset:2048
  ds_read_b64_tr_b16 v[142:143], v187 offset:2560
  s_waitcnt lgkmcnt(8)
  s_waitcnt vmcnt(12)
  v_mfma_f32_32x32x16_bf16 v[48:63], v[120:123], v[156:159], v[48:63]
  ds_read_b64_tr_b16 v[112:113], v183 offset:0
  ds_read_b64_tr_b16 v[114:115], v183 offset:512
  s_add_u32 s57, s94, 24576
  buffer_load_dwordx4 v[152:155], v2, s[20:23], s57 offen offset:3072 sc1
  v_mfma_f32_32x32x16_bf16 v[64:79], v[124:127], v[156:159], v[64:79]
  ds_read_b64_tr_b16 v[116:117], v188 offset:0
  ds_read_b64_tr_b16 v[118:119], v188 offset:512
  s_waitcnt lgkmcnt(8)
  s_waitcnt vmcnt(12)
  v_mfma_f32_32x32x16_bf16 v[48:63], v[128:131], v[160:163], v[48:63]
  ds_read_b64_tr_b16 v[120:121], v180 offset:0
  ds_read_b64_tr_b16 v[122:123], v180 offset:512
  s_add_u32 s57, s94, 16384
  buffer_load_dwordx4 v[156:159], v2, s[20:23], s57 offen offset:0 sc1
  v_mfma_f32_32x32x16_bf16 v[64:79], v[132:135], v[160:163], v[64:79]
  ds_read_b64_tr_b16 v[124:125], v185 offset:0
  ds_read_b64_tr_b16 v[126:127], v185 offset:512
  s_waitcnt lgkmcnt(8)
  s_waitcnt vmcnt(12)
  v_mfma_f32_32x32x16_bf16 v[48:63], v[136:139], v[248:251], v[48:63]
  ds_read_b64_tr_b16 v[128:129], v180 offset:2048
  ds_read_b64_tr_b16 v[130:131], v180 offset:2560
  s_add_u32 s57, s94, 12288
  buffer_load_dwordx4 v[160:163], v2, s[20:23], s57 offen offset:0 sc1
  v_mfma_f32_32x32x16_bf16 v[64:79], v[140:143], v[248:251], v[64:79]
  ds_read_b64_tr_b16 v[132:133], v185 offset:2048
  ds_read_b64_tr_b16 v[134:135], v185 offset:2560
  s_waitcnt lgkmcnt(8)
  s_waitcnt vmcnt(12)
  v_mfma_f32_32x32x16_bf16 v[48:63], v[112:115], v[80:83], v[48:63]
  ds_read_b64_tr_b16 v[136:137], v180 offset:4096
  ds_read_b64_tr_b16 v[138:139], v180 offset:4608
  s_add_u32 s57, s94, 12288
  buffer_load_dwordx4 v[248:251], v2, s[20:23], s57 offen offset:1024 sc1
  v_mfma_f32_32x32x16_bf16 v[64:79], v[116:119], v[80:83], v[64:79]
  ds_read_b64_tr_b16 v[140:141], v185 offset:4096
  ds_read_b64_tr_b16 v[142:143], v185 offset:4608
  s_waitcnt lgkmcnt(8)
  s_waitcnt vmcnt(12)
  v_mfma_f32_32x32x16_bf16 v[48:63], v[120:123], v[84:87], v[48:63]
  ds_read_b64_tr_b16 v[112:113], v180 offset:6144
  ds_read_b64_tr_b16 v[114:115], v180 offset:6656
  s_add_u32 s57, s94, 12288
  buffer_load_dwordx4 v[80:83], v2, s[20:23], s57 offen offset:2048 sc1
  v_mfma_f32_32x32x16_bf16 v[64:79], v[124:127], v[84:87], v[64:79]
  ds_read_b64_tr_b16 v[116:117], v185 offset:6144
  ds_read_b64_tr_b16 v[118:119], v185 offset:6656
  s_waitcnt lgkmcnt(8)
  s_waitcnt vmcnt(12)
  v_mfma_f32_32x32x16_bf16 v[48:63], v[128:131], v[88:91], v[48:63]
  ds_read_b64_tr_b16 v[120:121], v180 offset:32768
  ds_read_b64_tr_b16 v[122:123], v180 offset:33280
  s_add_u32 s57, s94, 12288
  buffer_load_dwordx4 v[84:87], v2, s[20:23], s57 offen offset:3072 sc1
  v_mfma_f32_32x32x16_bf16 v[64:79], v[132:135], v[88:91], v[64:79]
  ds_read_b64_tr_b16 v[124:125], v185 offset:32768
  ds_read_b64_tr_b16 v[126:127], v185 offset:33280
  v_add_u32 v14, s81, v2
  v_add_u32 v15, s82, v2
  s_waitcnt lgkmcnt(8)
  s_waitcnt vmcnt(12)
  v_mfma_f32_32x32x16_bf16 v[48:63], v[136:139], v[92:95], v[48:63]
  ds_read_b64_tr_b16 v[128:129], v180 offset:34816
  ds_read_b64_tr_b16 v[130:131], v180 offset:35328
  buffer_load_dwordx4 v[88:91], v2, s[20:23], s95 offen offset:0 sc1
  v_mfma_f32_32x32x16_bf16 v[64:79], v[140:143], v[92:95], v[64:79]
  ds_read_b64_tr_b16 v[132:133], v185 offset:34816
  ds_read_b64_tr_b16 v[134:135], v185 offset:35328
  s_waitcnt lgkmcnt(8)
  s_waitcnt vmcnt(12)
  v_mfma_f32_32x32x16_bf16 v[48:63], v[112:115], v[96:99], v[48:63]
  ds_read_b64_tr_b16 v[136:137], v180 offset:36864
  ds_read_b64_tr_b16 v[138:139], v180 offset:37376
  buffer_load_dwordx4 v[92:95], v2, s[20:23], s95 offen offset:1024 sc1
  v_mfma_f32_32x32x16_bf16 v[64:79], v[116:119], v[96:99], v[64:79]
  ds_read_b64_tr_b16 v[140:141], v185 offset:36864
  ds_read_b64_tr_b16 v[142:143], v185 offset:37376
  ds_write_b128 v14, v[16:19] offset:0
  s_waitcnt lgkmcnt(9)
  s_waitcnt vmcnt(12)
  v_mfma_f32_32x32x16_bf16 v[48:63], v[120:123], v[100:103], v[48:63]
  ds_read_b64_tr_b16 v[112:113], v180 offset:38912
  ds_read_b64_tr_b16 v[114:115], v180 offset:39424
  buffer_load_dwordx4 v[96:99], v2, s[20:23], s95 offen offset:2048 sc1
  v_mfma_f32_32x32x16_bf16 v[64:79], v[124:127], v[100:103], v[64:79]
  ds_read_b64_tr_b16 v[116:117], v185 offset:38912
  ds_read_b64_tr_b16 v[118:119], v185 offset:39424
  ds_write_b128 v14, v[20:23] offset:1024
  s_waitcnt lgkmcnt(10)
  s_waitcnt vmcnt(12)
  v_mfma_f32_32x32x16_bf16 v[48:63], v[128:131], v[104:107], v[48:63]
  ds_read_b64_tr_b16 v[120:121], v184 offset:0
  ds_read_b64_tr_b16 v[122:123], v184 offset:512
  buffer_load_dwordx4 v[100:103], v2, s[20:23], s95 offen offset:3072 sc1
  v_mfma_f32_32x32x16_bf16 v[64:79], v[132:135], v[104:107], v[64:79]
  ds_read_b64_tr_b16 v[124:125], v189 offset:0
  ds_read_b64_tr_b16 v[126:127], v189 offset:512
  ds_write_b128 v14, v[24:27] offset:2048
  s_waitcnt lgkmcnt(11)
  s_waitcnt vmcnt(12)
  v_mfma_f32_32x32x16_bf16 v[48:63], v[136:139], v[108:111], v[48:63]
  ds_read_b64_tr_b16 v[128:129], v184 offset:2048
  ds_read_b64_tr_b16 v[130:131], v184 offset:2560
  s_add_u32 s57, s95, 4096
  buffer_load_dwordx4 v[104:107], v2, s[20:23], s57 offen offset:0 sc1
  v_mfma_f32_32x32x16_bf16 v[64:79], v[140:143], v[108:111], v[64:79]
  ds_read_b64_tr_b16 v[132:133], v189 offset:2048
  ds_read_b64_tr_b16 v[134:135], v189 offset:2560
  ds_write_b128 v14, v[28:31] offset:3072
  s_waitcnt lgkmcnt(11)
  s_waitcnt vmcnt(12)
  v_mfma_f32_32x32x16_bf16 v[48:63], v[112:115], v[144:147], v[48:63]
  ds_read_b64_tr_b16 v[136:137], v184 offset:4096
  ds_read_b64_tr_b16 v[138:139], v184 offset:4608
  s_add_u32 s57, s95, 4096
  buffer_load_dwordx4 v[108:111], v2, s[20:23], s57 offen offset:1024 sc1
  v_mfma_f32_32x32x16_bf16 v[64:79], v[116:119], v[144:147], v[64:79]
  ds_read_b64_tr_b16 v[140:141], v189 offset:4096
  ds_read_b64_tr_b16 v[142:143], v189 offset:4608
  ds_write_b128 v14, v[32:35] offset:4096
  s_waitcnt lgkmcnt(11)
  s_waitcnt vmcnt(12)
  v_mfma_f32_32x32x16_bf16 v[48:63], v[120:123], v[148:151], v[48:63]
  v_mfma_f32_32x32x16_bf16 v[64:79], v[124:127], v[148:151], v[64:79]
  ds_write_b128 v14, v[36:39] offset:5120
  s_waitcnt lgkmcnt(7)
  s_waitcnt vmcnt(11)
  v_mfma_f32_32x32x16_bf16 v[48:63], v[128:131], v[152:155], v[48:63]
  v_mfma_f32_32x32x16_bf16 v[64:79], v[132:135], v[152:155], v[64:79]
  ds_write_b128 v14, v[40:43] offset:6144
  s_waitcnt lgkmcnt(3)
  s_waitcnt vmcnt(10)
  v_mfma_f32_32x32x16_bf16 v[48:63], v[136:139], v[156:159], v[48:63]
  v_mfma_f32_32x32x16_bf16 v[64:79], v[140:143], v[156:159], v[64:79]
  ds_write_b128 v14, v[44:47] offset:7168
  s_waitcnt vmcnt(9)
  v_mfma_f32_32x32x16_bf16 v[48:63], a[0:3], v[160:163], v[48:63]
  v_mfma_f32_32x32x16_bf16 v[64:79], a[4:7], v[160:163], v[64:79]
  s_waitcnt vmcnt(8)
  v_mfma_f32_32x32x16_bf16 v[48:63], a[8:11], v[248:251], v[48:63]
  v_mfma_f32_32x32x16_bf16 v[64:79], a[12:15], v[248:251], v[64:79]
  s_waitcnt vmcnt(7)
  v_mfma_f32_32x32x16_bf16 v[64:79], a[20:23], v[80:83], v[64:79]
  s_waitcnt vmcnt(6)
  v_mfma_f32_32x32x16_bf16 v[64:79], a[28:31], v[84:87], v[64:79]
  v_lshlrev_b32 v112, 16, v172
  v_and_b32 v113, 0xffff0000, v172
  v_lshlrev_b32 v114, 16, v173
  v_and_b32 v115, 0xffff0000, v173
  v_lshlrev_b32 v116, 16, v174
  v_and_b32 v117, 0xffff0000, v174
  v_lshlrev_b32 v118, 16, v175
  v_and_b32 v119, 0xffff0000, v175
  s_waitcnt vmcnt(5)
  v_mfma_f32_32x32x16_bf16 v[64:79], v[204:207], v[88:91], v[64:79]
  v_lshlrev_b32 v120, 16, v176
  v_and_b32 v121, 0xffff0000, v176
  v_lshlrev_b32 v122, 16, v177
  v_and_b32 v123, 0xffff0000, v177
  v_lshlrev_b32 v124, 16, v178
  v_and_b32 v125, 0xffff0000, v178
  v_lshlrev_b32 v126, 16, v179
  v_and_b32 v127, 0xffff0000, v179
  s_waitcnt vmcnt(4)
  v_mfma_f32_32x32x16_bf16 v[64:79], v[212:215], v[92:95], v[64:79]
  s_lshr_b32 s56, s30, 1
  s_sub_u32 s54, 13, s56
  s_lshl_b32 s55, s56, 1
  s_lshl_b32 s55, 4096, s55
  s_lshl_b32 s56, s56, 15
  s_xor_b32 s57, s30, 1
  s_lshl_b32 s57, s57, s54
  s_add_u32 s57, s57, s56
  s_waitcnt vmcnt(3)
  v_mfma_f32_32x32x16_bf16 v[64:79], v[220:223], v[96:99], v[64:79]
  s_add_u32 s57, s57, s55
  v_add_u32 v181, s57, v2
  s_xor_b32 s57, s30, 2
  s_lshl_b32 s57, s57, s54
  s_add_u32 s57, s57, s56
  v_add_u32 v182, s57, v2
  s_xor_b32 s57, s30, 3
  s_lshl_b32 s57, s57, s54
  s_waitcnt vmcnt(2)
  v_mfma_f32_32x32x16_bf16 v[64:79], v[228:231], v[100:103], v[64:79]
  s_add_u32 s57, s57, s56
  s_add_u32 s57, s57, s55
  v_add_u32 v183, s57, v2
  v_and_b32 v184, 31, v1
  v_lshlrev_b32 v184, 16, v184
  v_lshrrev_b32 v185, 5, v1
  v_lshl_add_u32 v184, v185, 4, v184
  s_lshl_b32 s57, s49, 1
  s_waitcnt vmcnt(1)
  v_mfma_f32_32x32x16_bf16 v[64:79], v[236:239], v[104:107], v[64:79]
  s_add_u32 s57, s57, s52
  s_lshl_b32 s57, s57, 6
  s_lshl_b32 s90, s50, 10
  s_add_u32 s90, s90, s57
  s_waitcnt vmcnt(0)
  v_mfma_f32_32x32x16_bf16 v[64:79], v[244:247], v[108:111], v[64:79]
  v_mfma_f32_32x32x16_bf16 v[48:63], a[16:19], v[80:83], v[48:63]
  v_mfma_f32_32x32x16_bf16 v[48:63], a[24:27], v[84:87], v[48:63]
  v_mfma_f32_32x32x16_bf16 v[48:63], v[200:203], v[88:91], v[48:63]
  s_nop 8
  ds_write_b128 v15, v[64:67] offset:16384
  v_mfma_f32_32x32x16_bf16 v[48:63], v[208:211], v[92:95], v[48:63]
  v_mfma_f32_32x32x16_bf16 v[48:63], v[216:219], v[96:99], v[48:63]
  ds_write_b128 v15, v[68:71] offset:17408
  v_mfma_f32_32x32x16_bf16 v[48:63], v[224:227], v[100:103], v[48:63]
  ds_write_b128 v15, v[72:75] offset:18432
  v_mfma_f32_32x32x16_bf16 v[48:63], v[232:235], v[104:107], v[48:63]
  v_mfma_f32_32x32x16_bf16 v[48:63], v[240:243], v[108:111], v[48:63]
  ds_write_b128 v15, v[76:79] offset:19456
  s_nop 7
  s_cmp_lt_u32 s30, 2
  s_cbranch_scc0 Lc_136
  s_nop 0
  ds_write_b128 v15, v[48:51] offset:0
  ds_write_b128 v15, v[52:55] offset:1024
  ds_write_b128 v15, v[56:59] offset:2048
  ds_write_b128 v15, v[60:63] offset:3072
  v_add_f32 v112, v112, v16
  v_add_f32 v113, v113, v17
  v_add_f32 v114, v114, v18
  v_add_f32 v115, v115, v19
  v_add_f32 v116, v116, v20
  v_add_f32 v117, v117, v21
  v_add_f32 v118, v118, v22
  v_add_f32 v119, v119, v23
  v_add_f32 v120, v120, v24
  v_add_f32 v121, v121, v25
  v_add_f32 v122, v122, v26
  v_add_f32 v123, v123, v27
  v_add_f32 v124, v124, v28
  v_add_f32 v125, v125, v29
  v_add_f32 v126, v126, v30
  v_add_f32 v127, v127, v31
Lc_136:
  s_cmp_ge_u32 s30, 2
  s_cbranch_scc0 Lc_137
  s_nop 7
  v_add_f32 v112, v112, v48
  v_add_f32 v113, v113, v49
  v_add_f32 v114, v114, v50
  v_add_f32 v115, v115, v51
  v_add_f32 v116, v116, v52
  v_add_f32 v117, v117, v53
  v_add_f32 v118, v118, v54
  v_add_f32 v119, v119, v55
  v_add_f32 v120, v120, v56
  v_add_f32 v121, v121, v57
  v_add_f32 v122, v122, v58
  v_add_f32 v123, v123, v59
  v_add_f32 v124, v124, v60
  v_add_f32 v125, v125, v61
  v_add_f32 v126, v126, v62
  v_add_f32 v127, v127, v63
Lc_137:
  s_waitcnt lgkmcnt(0)
  s_barrier
  ds_read_b128 v[32:35], v181 offset:0
  ds_read_b128 v[48:51], v182 offset:0
  ds_read_b128 v[64:67], v183 offset:0
  ds_read_b128 v[36:39], v181 offset:1024
  ds_read_b128 v[52:55], v182 offset:1024
  ds_read_b128 v[68:71], v183 offset:1024
  ds_read_b128 v[40:43], v181 offset:2048
  ds_read_b128 v[56:59], v182 offset:2048
  ds_read_b128 v[72:75], v183 offset:2048
  ds_read_b128 v[44:47], v181 offset:3072
  ds_read_b128 v[60:63], v182 offset:3072
  ds_read_b128 v[76:79], v183 offset:3072
  s_waitcnt lgkmcnt(9)
  v_add_f32 v112, v112, v32
  v_add_f32 v113, v113, v33
  v_add_f32 v114, v114, v34
  v_add_f32 v115, v115, v35
  v_add_f32 v112, v112, v48
  v_add_f32 v113, v113, v49
  v_add_f32 v114, v114, v50
  v_add_f32 v115, v115, v51
  v_add_f32 v112, v112, v64
  v_add_f32 v113, v113, v65
  v_add_f32 v114, v114, v66
  v_add_f32 v115, v115, v67
  v_cvt_pk_bf16_f32 v96, v112, v113
  v_cvt_pk_bf16_f32 v97, v114, v115
  s_waitcnt lgkmcnt(6)
  v_add_f32 v116, v116, v36
  v_add_f32 v117, v117, v37
  v_add_f32 v118, v118, v38
  v_add_f32 v119, v119, v39
  v_add_f32 v116, v116, v52
  v_add_f32 v117, v117, v53
  v_add_f32 v118, v118, v54
  v_add_f32 v119, v119, v55
  v_add_f32 v116, v116, v68
  v_add_f32 v117, v117, v69
  v_add_f32 v118, v118, v70
  v_add_f32 v119, v119, v71
  v_cvt_pk_bf16_f32 v98, v116, v117
  v_cvt_pk_bf16_f32 v99, v118, v119
  buffer_store_dwordx4 v[96:99], v184, s[24:27], s90 offen offset:0
  s_waitcnt lgkmcnt(3)
  v_add_f32 v120, v120, v40
  v_add_f32 v121, v121, v41
  v_add_f32 v122, v122, v42
  v_add_f32 v123, v123, v43
  v_add_f32 v120, v120, v56
  v_add_f32 v121, v121, v57
  v_add_f32 v122, v122, v58
  v_add_f32 v123, v123, v59
  v_add_f32 v120, v120, v72
  v_add_f32 v121, v121, v73
  v_add_f32 v122, v122, v74
  v_add_f32 v123, v123, v75
  v_cvt_pk_bf16_f32 v100, v120, v121
  v_cvt_pk_bf16_f32 v101, v122, v123
  s_waitcnt lgkmcnt(0)
  v_add_f32 v124, v124, v44
  v_add_f32 v125, v125, v45
  v_add_f32 v126, v126, v46
  v_add_f32 v127, v127, v47
  v_add_f32 v124, v124, v60
  v_add_f32 v125, v125, v61
  v_add_f32 v126, v126, v62
  v_add_f32 v127, v127, v63
  v_add_f32 v124, v124, v76
  v_add_f32 v125, v125, v77
  v_add_f32 v126, v126, v78
  v_add_f32 v127, v127, v79
  v_cvt_pk_bf16_f32 v102, v124, v125
  v_cvt_pk_bf16_f32 v103, v126, v127
  buffer_store_dwordx4 v[100:103], v184, s[24:27], s90 offen offset:32
L_fin:
  s_cmp_eq_u32 s2, 0
  s_cbranch_scc0 Lc_138
  s_cmp_lg_u32 s30, 0
  s_cbranch_scc1 Lw_139
  v_mov_b32 v14, s31
  v_mov_b32 v15, 0
  s_mov_b64 exec, 1
  buffer_store_dword v14, v15, s[20:23], 0 offen sc1
  s_mov_b64 exec, -1
Lw_139:
Lc_138:
L_end:
  s_endpgm
Lo_4:
  s_nop 1
  s_cmp_lg_u32 s30, 0
  s_cbranch_scc1 Lw_6
  v_and_b32 v234, 15, v1
  v_lshlrev_b32 v234, 7, v234
  s_lshl_b32 s95, s28, 11
  s_add_u32 s95, s95, 4096
  buffer_load_dwordx2 v[134:135], v234, s[20:23], s95 offen sc1
Lw_6:
  s_nop 1
  s_branch Lob_5
Lo_30:
  s_nop 1
  s_waitcnt lgkmcnt(14)
  v_mfma_f32_32x32x16_bf16 v[96:111], v[48:51], v[16:19], v[96:111]
  s_add_u32 m0, s76, 32768
  s_add_u32 s54, s101, 229376
  buffer_load_dwordx4 v253, s[8:11], s54 offen lds
  s_waitcnt lgkmcnt(12)
  v_mfma_f32_32x32x16_bf16 v[96:111], v[52:55], v[20:23], v[96:111]
  s_add_u32 m0, s76, 33792
  s_add_u32 s54, s101, 243712
  buffer_load_dwordx4 v253, s[8:11], s54 offen lds
  s_waitcnt lgkmcnt(10)
  v_mfma_f32_32x32x16_bf16 v[96:111], v[56:59], v[24:27], v[96:111]
  s_add_u32 m0, s76, 34816
  s_add_u32 s54, s101, 258048
  buffer_load_dwordx4 v253, s[8:11], s54 offen lds
  s_waitcnt lgkmcnt(8)
  v_mfma_f32_32x32x16_bf16 v[96:111], v[60:63], v[28:31], v[96:111]
  s_add_u32 m0, s76, 35840
  s_add_u32 s54, s101, 272384
  buffer_load_dwordx4 v253, s[8:11], s54 offen lds
  s_waitcnt lgkmcnt(6)
  v_mfma_f32_32x32x16_bf16 v[96:111], v[64:67], v[32:35], v[96:111]
  s_add_u32 m0, s76, 36864
  s_add_u32 s54, s101, 229376
  buffer_load_dwordx4 v253, s[12:15], s54 offen lds
  s_waitcnt lgkmcnt(4)
  v_mfma_f32_32x32x16_bf16 v[96:111], v[68:71], v[36:39], v[96:111]
  s_add_u32 m0, s76, 37888
  s_add_u32 s54, s101, 243712
  buffer_load_dwordx4 v253, s[12:15], s54 offen lds
  s_waitcnt lgkmcnt(2)
  v_mfma_f32_32x32x16_bf16 v[96:111], v[72:75], v[40:43], v[96:111]
  s_add_u32 m0, s76, 38912
  s_add_u32 s54, s101, 258048
  buffer_load_dwordx4 v253, s[12:15], s54 offen lds
  s_waitcnt lgkmcnt(0)
  v_mfma_f32_32x32x16_bf16 v[96:111], v[76:79], v[44:47], v[96:111]
  s_add_u32 m0, s76, 39936
  s_add_u32 s54, s101, 272384
  buffer_load_dwordx4 v253, s[12:15], s54 offen lds
  s_branch Lm_29
  s_nop 1
  s_branch Lob_31
Ls_33:
  buffer_store_dwordx4 v[48:51], v2, s[20:23], s55 offen sc1
  s_branch Lb_34
Ls_35:
  buffer_store_dwordx4 v[52:55], v2, s[20:23], s55 offen offset:1024 sc1
  s_branch Lb_36
Ls_37:
  buffer_store_dword v56, v13, s[20:23], s56 offen sc1
  s_branch Lb_38
Ls_39:
  buffer_store_dword v14, v15, s[20:23], s54 offen sc1
  s_branch Lb_40
Lo_41:
  s_nop 1
  s_barrier
  ds_read_b64_tr_b16 a[96:97], v248 offset:32768
  ds_read_b64_tr_b16 a[98:99], v248 offset:33792
  ds_read_b64_tr_b16 a[100:101], v248 offset:36864
  ds_read_b64_tr_b16 a[102:103], v248 offset:37888
  ds_read_b64_tr_b16 a[104:105], v248 offset:40960
  ds_read_b64_tr_b16 a[106:107], v248 offset:41984
  ds_read_b64_tr_b16 a[108:109], v248 offset:45056
  ds_read_b64_tr_b16 a[110:111], v248 offset:46080
  ds_read_b64_tr_b16 a[112:113], v250 offset:0
  ds_read_b64_tr_b16 a[114:115], v250 offset:1024
  ds_read_b64_tr_b16 a[116:117], v250 offset:4096
  ds_read_b64_tr_b16 a[118:119], v250 offset:5120
  ds_read_b64_tr_b16 a[120:121], v250 offset:8192
  ds_read_b64_tr_b16 a[122:123], v250 offset:9216
  ds_read_b64_tr_b16 a[124:125], v250 offset:12288
  ds_read_b64_tr_b16 a[126:127], v250 offset:13312
  v_mfma_f32_16x16x32_bf16 v[4:7], a[0:3], v[240:243], v[4:7]
  v_mfma_f32_16x16x32_bf16 v[8:11], a[4:7], v[240:243], v[8:11]
  v_mfma_f32_16x16x32_bf16 v[4:7], a[8:11], v[240:243], v[4:7]
  v_mfma_f32_16x16x32_bf16 v[8:11], a[12:15], v[240:243], v[8:11]
  v_mfma_f32_16x16x32_bf16 v[4:7], a[16:19], v[240:243], v[4:7]
  v_mfma_f32_16x16x32_bf16 v[8:11], a[20:23], v[240:243], v[8:11]
  v_mfma_f32_16x16x32_bf16 v[4:7], a[24:27], v[240:243], v[4:7]
  v_mfma_f32_16x16x32_bf16 v[8:11], a[28:31], v[240:243], v[8:11]
  s_waitcnt lgkmcnt(0)
  s_barrier
  s_nop 1
  s_branch Lob_42
Lo_46:
  s_nop 1
  v_mfma_f32_16x16x32_bf16 v[4:7], a[32:35], v[240:243], v[4:7]
  v_mfma_f32_16x16x32_bf16 v[8:11], a[36:39], v[240:243], v[8:11]
  v_mfma_f32_16x16x32_bf16 v[4:7], a[40:43], v[240:243], v[4:7]
  v_mfma_f32_16x16x32_bf16 v[8:11], a[44:47], v[240:243], v[8:11]
  v_mfma_f32_16x16x32_bf16 v[4:7], a[48:51], v[240:243], v[4:7]
  v_mfma_f32_16x16x32_bf16 v[8:11], a[52:55], v[240:243], v[8:11]
  v_mfma_f32_16x16x32_bf16 v[4:7], a[56:59], v[240:243], v[4:7]
  v_mfma_f32_16x16x32_bf16 v[8:11], a[60:63], v[240:243], v[8:11]
  v_mfma_f32_16x16x32_bf16 v[4:7], a[64:67], v[240:243], v[4:7]
  v_mfma_f32_16x16x32_bf16 v[8:11], a[68:71], v[240:243], v[8:11]
  v_mfma_f32_16x16x32_bf16 v[4:7], a[72:75], v[240:243], v[4:7]
  v_mfma_f32_16x16x32_bf16 v[8:11], a[76:79], v[240:243], v[8:11]
  v_mfma_f32_16x16x32_bf16 v[4:7], a[80:83], v[240:243], v[4:7]
  v_mfma_f32_16x16x32_bf16 v[8:11], a[84:87], v[240:243], v[8:11]
  v_mfma_f32_16x16x32_bf16 v[4:7], a[88:91], v[240:243], v[4:7]
  v_mfma_f32_16x16x32_bf16 v[8:11], a[92:95], v[240:243], v[8:11]
  v_mfma_f32_16x16x32_bf16 v[4:7], a[96:99], v[240:243], v[4:7]
  v_mfma_f32_16x16x32_bf16 v[8:11], a[100:103], v[240:243], v[8:11]
  v_mfma_f32_16x16x32_bf16 v[4:7], a[104:107], v[240:243], v[4:7]
  v_mfma_f32_16x16x32_bf16 v[8:11], a[108:111], v[240:243], v[8:11]
  v_mfma_f32_16x16x32_bf16 v[4:7], a[112:115], v[240:243], v[4:7]
  v_mfma_f32_16x16x32_bf16 v[8:11], a[116:119], v[240:243], v[8:11]
  v_mfma_f32_16x16x32_bf16 v[4:7], a[120:123], v[240:243], v[4:7]
  v_mfma_f32_16x16x32_bf16 v[8:11], a[124:127], v[240:243], v[8:11]
  s_nop 1
  s_branch Lob_47
Ls_49:
  buffer_store_dwordx4 v[164:167], v2, s[20:23], s62 offen sc1
  s_branch Lb_50
Ls_51:
  buffer_store_dwordx4 v[168:171], v2, s[20:23], s62 offen offset:1024 sc1
  s_branch Lb_52
Ls_53:
  buffer_store_dwordx4 v[164:167], v2, s[20:23], s63 offen sc1
  s_branch Lb_54
Ls_55:
  buffer_store_dwordx4 v[168:171], v2, s[20:23], s63 offen offset:1024 sc1
  s_branch Lb_56
Ls_57:
  buffer_store_dwordx4 v[164:167], v2, s[20:23], s64 offen sc1
  s_branch Lb_58
Ls_59:
  buffer_store_dword v14, v15, s[20:23], s80 offen sc1
  s_branch Lb_60
Ls_61:
  buffer_store_dwordx4 v[168:171], v2, s[20:23], s64 offen offset:1024 sc1
  s_branch Lb_62
Lpf_63:
  s_mov_b32 s47, 40000
Lp_65:
  buffer_load_dword v13, v12, s[20:23], s90 offen sc1
  s_waitcnt vmcnt(0)
  v_subrev_u32 v14, s31, v13
  v_cmp_lt_u32 vcc, 1, v14
  s_cbranch_vccz Ld_66
  s_sub_u32 s47, s47, 1
  s_cbranch_scc0 Lp_65
Ld_66:
  s_branch Lpb_64
Ls_67:
  buffer_store_dwordx4 v[164:167], v2, s[20:23], s65 offen sc1
  s_branch Lb_68
Ls_69:
  buffer_store_dwordx4 v[168:171], v2, s[20:23], s65 offen offset:1024 sc1
  s_branch Lb_70
Ls_71:
  buffer_store_dwordx4 v[164:167], v2, s[20:23], s62 offen sc1
  s_branch Lb_72
Ls_73:
  buffer_store_dwordx4 v[168:171], v2, s[20:23], s62 offen offset:1024 sc1
  s_branch Lb_74
Ls_75:
  buffer_store_dwordx4 v[164:167], v2, s[20:23], s63 offen sc1
  s_branch Lb_76
Ls_77:
  buffer_store_dwordx4 v[168:171], v2, s[20:23], s63 offen offset:1024 sc1
  s_branch Lb_78
Ls_79:
  buffer_store_dword v14, v15, s[20:23], s80 offen sc1
  s_branch Lb_80
Ls_81:
  buffer_store_dwordx4 v[164:167], v2, s[20:23], s64 offen sc1
  s_branch Lb_82
Ls_83:
  buffer_store_dwordx4 v[168:171], v2, s[20:23], s64 offen offset:1024 sc1
  s_branch Lb_84
Lpf_85:
  s_mov_b32 s47, 40000
Lp_87:
  buffer_load_dword v13, v12, s[20:23], s90 offen sc1
  s_waitcnt vmcnt(0)
  v_subrev_u32 v14, s31, v13
  v_cmp_lt_u32 vcc, 1, v14
  s_cbranch_vccz Ld_88
  s_sub_u32 s47, s47, 1
  s_cbranch_scc0 Lp_87
Ld_88:
  s_branch Lpb_86
Ls_89:
  buffer_store_dwordx4 v[164:167], v2, s[20:23], s65 offen sc1
  s_branch Lb_90
Ls_91:
  buffer_store_dwordx4 v[168:171], v2, s[20:23], s65 offen offset:1024 sc1
  s_branch Lb_92
Ls_105:
  buffer_store_dword v14, v15, s[20:23], s80 offen sc1
  s_branch Lb_106
Lpf_107:
  s_mov_b32 s47, 40000
Lp_109:
  buffer_load_dword v13, v12, s[20:23], s90 offen sc1
  s_waitcnt vmcnt(0)
  v_subrev_u32 v14, s31, v13
  v_cmp_lt_u32 vcc, 1, v14
  s_cbranch_vccz Ld_110
  s_sub_u32 s47, s47, 1
  s_cbranch_scc0 Lp_109
Ld_110:
  s_branch Lpb_108
Ls_113:
  buffer_store_dwordx4 v[96:99], v2, s[20:23], s99 offen sc1
  s_branch Lb_114
Ls_115:
  buffer_store_dwordx4 v[100:103], v2, s[20:23], s99 offen offset:1024 sc1
  s_branch Lb_116
Ls_117:
  buffer_store_dword v16, v17, s[20:23], s55 offen sc1
  s_branch Lb_118
Ls_120:
  buffer_store_dword v14, v15, s[20:23], s54 offen sc1
  s_branch Lb_121
Lpz_122:
  s_mov_b32 s47, 40000
Lp_124:
  buffer_load_dword v252, v250, s[20:23], s90 offen sc1
  buffer_load_dword v253, v251, s[20:23], s90 offen sc1
  s_waitcnt vmcnt(0)
  v_subrev_u32 v14, s31, v252
  v_subrev_u32 v15, s31, v253
  v_max_u32 v14, v14, v15
  v_cmp_lt_u32 vcc, 1, v14
  s_cbranch_vccz Ld_125
  s_sub_u32 s47, s47, 1
  s_cbranch_scc0 Lp_124
Ld_125:
  s_branch Lpzb_123
Lpf_126:
  s_mov_b32 s47, 40000
Lp_128:
  buffer_load_dword v249, v248, s[20:23], s90 offen sc1
  s_waitcnt vmcnt(0)
  v_subrev_u32 v14, s31, v249
  v_cmp_lt_u32 vcc, 1, v14
  s_cbranch_vccz Ld_129
  s_sub_u32 s47, s47, 1
  s_cbranch_scc0 Lp_128
Ld_129:
  s_branch Lpb_127
Ls_130:
  buffer_store_dword v14, v15, s[20:23], s80 offen sc1
  s_branch Lb_131
Lpf_132:
  s_mov_b32 s47, 40000
Lp_134:
  buffer_load_dword v13, v12, s[20:23], s90 offen sc1
  s_waitcnt vmcnt(0)
  v_subrev_u32 v14, s31, v13
  v_cmp_lt_u32 vcc, 1, v14
  s_cbranch_vccz Ld_135
  s_sub_u32 s47, s47, 1
  s_cbranch_scc0 Lp_134
Ld_135:
  s_branch Lpb_133
L_codeend:
  s_endpgm
.section .rodata,"a"
.p2align 6
.amdhsa_kernel interleave_layers__spectral_fnet__glu_gated_glu__prompt_kernel
  .amdhsa_next_free_vgpr 512
  .amdhsa_next_free_sgpr 102
  .amdhsa_accum_offset 256
  .amdhsa_group_segment_fixed_size 0
  .amdhsa_kernarg_size 96
  .amdhsa_user_sgpr_count 2
  .amdhsa_user_sgpr_kernarg_segment_ptr 1
  .amdhsa_system_sgpr_workgroup_id_x 1
  .amdhsa_float_denorm_mode_32 3
.end_amdhsa_kernel
```
